```python
import torch

def _softmax(x, axis=-1):
    return torch.softmax(x, dim=axis)
def _gelu(x):
    return torch.nn.functional.gelu(x, approximate="tanh")
def _silu(x):
    return torch.nn.functional.silu(x)
def _sigmoid(x):
    return torch.sigmoid(x)
def _layernorm(x, axis=-1, eps=1e-5):
    m = x.mean(dim=axis, keepdim=True)
    v = x.var(dim=axis, keepdim=True, unbiased=False)
    return (x - m) / torch.sqrt(v + eps)
def _scatter_add(tgt, idx, src, axis=0):
    return tgt.clone().index_add_(axis, idx, src)
def _segment_sum(src, seg, n):
    out = torch.zeros((n,) + src.shape[1:], dtype=src.dtype)
    return out.index_add_(0, seg, src)
def _pad(x, pw):
    flat = tuple(v for pair in reversed(pw) for v in pair)
    return torch.nn.functional.pad(x, flat)

kernel_name = 'parallel_sum__ssm_conv_s5__dense_activation_gelu__prompt'

def setup_inputs():

    _w = (lambda a: (lambda t: t.to(torch.bfloat16) if t.is_floating_point() else t)(torch.as_tensor(a)))
    def _A_setup():
        B, S, D = 1, 2048, 512
        P = D
        Lambda_re = -0.5 * (lambda _x: torch.exp(torch.as_tensor(_x)))((lambda *s: torch.randn(*s, dtype=torch.bfloat16) * 0.2)(P))
        Lambda_im = (lambda *s: torch.randn(*s, dtype=torch.bfloat16) * 0.8)(P) * 1.0
        B_re = (lambda *s: torch.randn(*s, dtype=torch.bfloat16) * 0.4)(P, D) * (D ** -0.5)
        B_im = (lambda *s: torch.randn(*s, dtype=torch.bfloat16) * 0.4)(P, D) * (D ** -0.5)
        C_re = (lambda *s: torch.randn(*s, dtype=torch.bfloat16) * 0.4)(D, P) * (P ** -0.5)
        C_im = (lambda *s: torch.randn(*s, dtype=torch.bfloat16) * 0.4)(D, P) * (P ** -0.5)
        log_dt = (lambda *s: torch.randn(*s, dtype=torch.bfloat16) * 0.2)(P) * 0.3 - 2.0
        Dskip = (lambda *s: torch.randn(*s, dtype=torch.bfloat16) * 0.05)(D)
        return {
            "x": _w((lambda *s: torch.randn(*s, dtype=torch.bfloat16) * 0.05)(B, S, D)),
            "Lambda_re": _w(Lambda_re),
            "Lambda_im": _w(Lambda_im),
            "B_re": _w(B_re),
            "B_im": _w(B_im),
            "C_re": _w(C_re),
            "C_im": _w(C_im),
            "log_dt": _w(log_dt),
            "Dskip": _w(Dskip),
        }
    _A_in = _A_setup()

    def _B_setup():
        B, S, D, F = 1, 2048, 512, 1792
        return {
            "x": _w((lambda *s: torch.randn(*s, dtype=torch.bfloat16) * 0.05)(B, S, D)),
            "w1": _w((lambda *s: torch.randn(*s, dtype=torch.bfloat16) * 0.8)(D, F) * (D ** -0.5)),
            "b1": _w((lambda *s: torch.randn(*s, dtype=torch.bfloat16) * 12.8)(F) * 0.01),
            "w2": _w((lambda *s: torch.randn(*s, dtype=torch.bfloat16) * 0.8)(F, D) * (F ** -0.5)),
            "b2": _w((lambda *s: torch.randn(*s, dtype=torch.bfloat16) * 12.8)(D) * 0.01),
        }
    _B_in = _B_setup()

    return {
        "A_x": _A_in["x"],
        "A_Lambda_re": _A_in["Lambda_re"],
        "A_Lambda_im": _A_in["Lambda_im"],
        "A_B_re": _A_in["B_re"],
        "A_B_im": _A_in["B_im"],
        "A_C_re": _A_in["C_re"],
        "A_C_im": _A_in["C_im"],
        "A_log_dt": _A_in["log_dt"],
        "A_Dskip": _A_in["Dskip"],
        "B_x": _B_in["x"],
        "B_w1": _B_in["w1"],
        "B_b1": _B_in["b1"],
        "B_w2": _B_in["w2"],
        "B_b2": _B_in["b2"],
    }

def reference(A_x, A_Lambda_re, A_Lambda_im, A_B_re, A_B_im, A_C_re, A_C_im, A_log_dt, A_Dskip, B_x, B_w1, B_b1, B_w2, B_b2):
    def _A_ref(x, Lambda_re, Lambda_im, B_re, B_im, C_re, C_im, log_dt, Dskip):
        Bsz, L, H = x.shape
        Lam = Lambda_re + 1j * Lambda_im
        Bmat = B_re + 1j * B_im
        Cmat = C_re + 1j * C_im
        dt = torch.exp(log_dt)
        Lam_bar = torch.exp(dt * Lam)
        B_bar = ((Lam_bar - 1.0) / Lam)[:, None] * Bmat
        Bu = torch.einsum("bld,pd->blp", x + 0j, B_bar)
        h = torch.zeros_like(Bu[:, 0, :])
        hs = []
        for t in range(L):
            h = Lam_bar[None, :] * h + Bu[:, t, :]
            hs.append(h)
        hseq = torch.stack(hs, 1)
        y = 2.0 * torch.einsum("blp,dp->bld", hseq, Cmat).real + x * Dskip[None, None, :]
        return y

    def _B_ref(x, w1, b1, w2, b2):
        h = torch.einsum("bsd,df->bsf", x, w1) + b1
        h = _gelu(h)
        return torch.einsum("bsf,fd->bsd", h, w2) + b2

    x = A_x
    xn = _layernorm(x, axis=-1)
    return x + _A_ref(xn, A_Lambda_re, A_Lambda_im, A_B_re, A_B_im, A_C_re, A_C_im, A_log_dt, A_Dskip) + _B_ref(xn, B_w1, B_b1, B_w2, B_b2)
```

```asm
; @launch grid=(256,1,1) block=(256,1,1) lds=163840
.amdgcn_target "amdgcn-amd-amdhsa--gfx950"
.text
.globl parallel_sum__ssm_conv_s5__dense_activation_gelu__prompt_kernel
.p2align 8
.type parallel_sum__ssm_conv_s5__dense_activation_gelu__prompt_kernel,@function
parallel_sum__ssm_conv_s5__dense_activation_gelu__prompt_kernel:
  s_cmp_ge_u32 s2, 256
  s_cbranch_scc1 L_END
  s_load_dwordx16 s[16:31], s[0:1], 0
  s_load_dwordx16 s[32:47], s[0:1], 64
  s_load_dwordx2 s[48:49], s[0:1], 128
  s_getpc_b64 s[50:51]
L_PC:
  s_lshr_b32 s9, s2, 3
  v_lshrrev_b32 v2, 6, v0
  v_and_b32 v0, 63, v0
  v_readfirstlane_b32 s3, v2
  s_and_b32 s10, s9, 1
  s_lshl_b32 s10, s10, 2
  s_nop 1
  s_add_u32 s10, s10, s3
  s_lshl_b32 s10, s10, 13
  v_lshlrev_b32 v1, 7, v0
  v_add_u32 v1, s10, v1
  v_min_u32 v1, (L_CODE_END - L_PC - 16), v1
  global_load_dword v255, v1, s[50:51]
  s_and_b32 s10, s2, 7
  s_lshr_b32 s11, s10, 1
  s_lshl_b32 s11, s11, 2
  s_and_b32 s12, s9, 3
  s_add_u32 s4, s11, s12
  s_and_b32 s11, s10, 1
  s_lshl_b32 s11, s11, 3
  s_lshr_b32 s12, s9, 2
  s_add_u32 s5, s11, s12
  s_and_b32 s6, s3, 1
  s_and_b32 s7, s5, 1
  s_lshl_b32 s84, s3, 12
  s_lshl_b32 s85, s3, 11
  s_lshl_b32 s86, s3, 13
  s_xor_b32 s89, s3, s7
  s_lshl_b32 s89, s89, 12
  s_lshr_b32 s10, s5, 1
  s_mul_i32 s10, s10, 224
  s_mul_i32 s11, s7, 96
  s_add_u32 s88, s10, s11
  v_lshrrev_b32 v24, 3, v0
  v_and_b32 v25, 7, v0
  v_lshrrev_b32 v26, 1, v24
  v_xor_b32 v26, v25, v26
  v_lshlrev_b32 v26, 4, v26
  v_lshrrev_b32 v27, 2, v24
  v_lshlrev_b32 v27, 4, v27
  v_and_b32 v28, 3, v24
  v_add_u32 v27, v27, v28
  s_lshl_b32 s10, s4, 7
  s_lshl_b32 s11, s3, 5
  s_add_u32 s10, s10, s11
  v_add_u32 v27, s10, v27
  v_lshl_add_u32 v1, v27, 10, v26
  v_xor_b32 v2, 64, v1
  s_lshl_b32 s10, s5, 5
  s_lshl_b32 s11, s6, 4
  s_add_u32 s10, s10, s11
  v_add_u32 v27, s10, v24
  v_lshl_add_u32 v3, v27, 10, v26
  v_xor_b32 v4, 64, v3
  v_add_u32 v4, 8192, v4
  v_lshrrev_b32 v27, 4, v0
  v_and_b32 v28, 15, v0
  v_lshrrev_b32 v29, 2, v28
  v_xor_b32 v29, v29, v27
  v_lshlrev_b32 v29, 2, v29
  v_and_b32 v28, 3, v28
  v_or_b32 v29, v29, v28
  v_lshlrev_b32 v29, 4, v29
  s_lshl_b32 s10, s3, 4
  v_add_u32 v27, s10, v27
  s_movk_i32 s11, 3584
  v_mul_lo_u32 v27, v27, s11
  s_lshl_b32 s10, s88, 1
  v_add3_u32 v5, v27, v29, s10
  s_waitcnt lgkmcnt(0)
  s_load_dword s8, s[48:49], 0
  s_mov_b32 s52, s16
  s_and_b32 s53, s17, 0xffff
  s_mov_b32 s54, 2097152
  s_mov_b32 s55, 0x20000
  s_cmp_ge_u32 s3, 2
  s_cselect_b32 s56, s24, s22
  s_cselect_b32 s57, s25, s23
  s_and_b32 s57, s57, 0xffff
  s_mov_b32 s58, 524288
  s_mov_b32 s59, 0x20000
  s_mov_b32 s60, s36
  s_and_b32 s61, s37, 0xffff
  s_mov_b32 s62, 1835008
  s_mov_b32 s63, 0x20000
  s_mov_b32 s64, s48
  s_and_b32 s65, s49, 0xffff
  s_mov_b32 s66, 12582912
  s_mov_b32 s67, 0x20000
  v_mov_b32 v238, s16
  v_mov_b32 v239, s17
  v_writelane_b32 v238, s36, 1
  v_writelane_b32 v239, s37, 1
  v_writelane_b32 v238, s22, 2
  v_writelane_b32 v239, s23, 2
  v_writelane_b32 v238, s24, 3
  v_writelane_b32 v239, s25, 3
  v_writelane_b32 v238, s48, 4
  v_writelane_b32 v239, s49, 4
  s_mov_b32 exec_lo, 31
  s_mov_b32 exec_hi, 0
  global_load_dword v255, v[238:239], off
  s_mov_b64 exec, -1
  s_add_u32 m0, s89, 0
  s_mov_b32 s13, 0
  buffer_load_dwordx4 v1, s[52:55], s13 offen lds
  s_add_u32 m0, s85, 16384
  s_mov_b32 s13, 0
  buffer_load_dwordx4 v3, s[56:59], s13 offen lds
  s_add_u32 m0, s84, 24576
  s_mov_b32 s13, 0
  buffer_load_dwordx4 v5, s[60:63], s13 offen lds
  s_add_u32 m0, s89, 1024
  s_mov_b32 s13, 4096
  buffer_load_dwordx4 v2, s[52:55], s13 offen lds
  s_add_u32 m0, s84, 25600
  s_mov_b32 s13, 14336
  buffer_load_dwordx4 v5, s[60:63], s13 offen lds
  s_add_u32 m0, s89, 2048
  s_mov_b32 s13, 8192
  buffer_load_dwordx4 v1, s[52:55], s13 offen lds
  s_add_u32 m0, s85, 17408
  s_mov_b32 s13, 0
  buffer_load_dwordx4 v4, s[56:59], s13 offen lds
  s_add_u32 m0, s84, 26624
  s_mov_b32 s13, 28672
  buffer_load_dwordx4 v5, s[60:63], s13 offen lds
  s_add_u32 m0, s89, 3072
  s_mov_b32 s13, 12288
  buffer_load_dwordx4 v2, s[52:55], s13 offen lds
  s_add_u32 m0, s84, 27648
  s_mov_b32 s13, 43008
  buffer_load_dwordx4 v5, s[60:63], s13 offen lds
  v_and_b32 v24, 31, v0
  v_lshrrev_b32 v25, 5, v0
  v_lshrrev_b32 v26, 1, v24
  v_and_b32 v26, 7, v26
  v_xor_b32 v26, v26, v25
  v_lshlrev_b32 v26, 4, v26
  v_lshl_add_u32 v26, v24, 7, v26
  s_lshl_b32 s10, s6, 13
  v_xor_b32 v27, 0, v26
  v_add_u32 v6, s10, v27
  v_add_u32 v10, 81920, v6
  v_xor_b32 v27, 32, v26
  v_add_u32 v7, s10, v27
  v_add_u32 v11, 81920, v7
  v_xor_b32 v27, 64, v26
  v_add_u32 v8, s10, v27
  v_add_u32 v12, 81920, v8
  v_xor_b32 v27, 96, v26
  v_add_u32 v9, s10, v27
  v_add_u32 v13, 81920, v9
  v_lshrrev_b32 v27, 4, v0
  v_bfe_u32 v28, v0, 2, 2
  v_and_b32 v29, 3, v0
  v_lshrrev_b32 v30, 1, v27
  v_lshl_add_u32 v30, v30, 3, v28
  v_lshlrev_b32 v30, 8, v30
  v_and_b32 v27, 1, v27
  v_lshl_add_u32 v30, v27, 5, v30
  v_lshl_add_u32 v30, v29, 3, v30
  v_add_u32 v30, 24576, v30
  s_cmp_ge_u32 s3, 2
  s_cbranch_scc1 L_BADDR
  v_xor_b32 v27, 0, v26
  v_add_u32 v14, 16384, v27
  v_add_u32 v18, 98304, v27
  v_xor_b32 v27, 32, v26
  v_add_u32 v15, 16384, v27
  v_add_u32 v19, 98304, v27
  v_xor_b32 v27, 64, v26
  v_add_u32 v16, 16384, v27
  v_add_u32 v20, 98304, v27
  v_xor_b32 v27, 96, v26
  v_add_u32 v17, 16384, v27
  v_add_u32 v21, 98304, v27
  s_cmp_eq_u32 s7, 0
  s_cselect_b32 s10, 3, 0
  v_xor_b32 v31, s10, v28
  v_lshl_add_u32 v22, v31, 6, v30
  v_add_u32 v23, 81920, v22
  s_branch L_ADDRJ
L_BADDR:
  s_add_u32 s10, s7, 0
  v_xor_b32 v31, s10, v28
  v_lshl_add_u32 v14, v31, 6, v30
  v_add_u32 v18, 81920, v14
  s_add_u32 s10, s7, 1
  v_xor_b32 v31, s10, v28
  v_lshl_add_u32 v15, v31, 6, v30
  v_add_u32 v19, 81920, v15
  s_add_u32 s10, s7, 2
  v_xor_b32 v31, s10, v28
  v_lshl_add_u32 v16, v31, 6, v30
  v_add_u32 v20, 81920, v16
L_ADDRJ:
  s_add_u32 m0, s89, 40960
  s_mov_b32 s13, 128
  buffer_load_dwordx4 v1, s[52:55], s13 offen lds
  s_add_u32 m0, s85, 57344
  s_mov_b32 s13, 128
  buffer_load_dwordx4 v3, s[56:59], s13 offen lds
  s_add_u32 m0, s84, 65536
  s_mov_b32 s13, 229376
  buffer_load_dwordx4 v5, s[60:63], s13 offen lds
  s_add_u32 m0, s89, 41984
  s_mov_b32 s13, 4224
  buffer_load_dwordx4 v2, s[52:55], s13 offen lds
  s_add_u32 m0, s84, 66560
  s_mov_b32 s13, 243712
  buffer_load_dwordx4 v5, s[60:63], s13 offen lds
  s_add_u32 m0, s89, 43008
  s_mov_b32 s13, 8320
  buffer_load_dwordx4 v1, s[52:55], s13 offen lds
  s_add_u32 m0, s85, 58368
  s_mov_b32 s13, 128
  buffer_load_dwordx4 v4, s[56:59], s13 offen lds
  s_add_u32 m0, s84, 67584
  s_mov_b32 s13, 258048
  buffer_load_dwordx4 v5, s[60:63], s13 offen lds
  s_add_u32 m0, s89, 44032
  s_mov_b32 s13, 12416
  buffer_load_dwordx4 v2, s[52:55], s13 offen lds
  s_add_u32 m0, s84, 68608
  s_mov_b32 s13, 272384
  buffer_load_dwordx4 v5, s[60:63], s13 offen lds
  s_lshl_b32 s10, s2, 2
  s_add_u32 s10, s10, s3
  s_mul_i32 s11, s10, 1792
  v_lshl_add_u32 v237, v0, 7, s11
  v_mov_b32 v238, s40
  v_mov_b32 v239, s41
  s_mul_i32 s11, s10, 512
  v_cmp_le_u32 vcc, 14, v0
  v_subrev_u32 v235, 14, v0
  v_lshl_add_u32 v235, v235, 7, s11
  v_mov_b32 v234, s26
  v_cndmask_b32 v238, v238, v234, vcc
  v_mov_b32 v234, s27
  v_cndmask_b32 v239, v239, v234, vcc
  v_cndmask_b32 v237, v237, v235, vcc
  s_mul_i32 s11, s10, 512
  v_cmp_le_u32 vcc, 18, v0
  v_subrev_u32 v235, 18, v0
  v_lshl_add_u32 v235, v235, 7, s11
  v_mov_b32 v234, s28
  v_cndmask_b32 v238, v238, v234, vcc
  v_mov_b32 v234, s29
  v_cndmask_b32 v239, v239, v234, vcc
  v_cndmask_b32 v237, v237, v235, vcc
  v_add_co_u32 v238, vcc, v238, v237
  s_nop 1
  v_addc_co_u32 v239, vcc, 0, v239, vcc
  s_mov_b32 exec_lo, 0x3fffff
  s_mov_b32 exec_hi, 0x0
  global_load_dword v255, v[238:239], off
  s_mov_b64 exec, -1
  s_waitcnt vmcnt(11)
  s_barrier
  s_cmp_ge_u32 s3, 2
  s_cbranch_scc1 L_BWAVE
  ds_read_b128 v[24:27], v6 offset:0
  ds_read_b128 v[32:35], v14 offset:0
  ds_read_b128 v[36:39], v14 offset:4096
  ds_read_b64_tr_b16 v[40:41], v22 offset:0
  ds_read_b64_tr_b16 v[42:43], v22 offset:1024
  ds_read_b128 v[28:31], v6 offset:4096
  s_waitcnt lgkmcnt(0)
  v_mfma_f32_32x32x16_bf16 v[64:79], v[24:27], v[32:35], 0
  ds_read_b128 v[44:47], v7 offset:0
  ds_read_b128 v[52:55], v15 offset:0
  ds_read_b128 v[56:59], v15 offset:4096
  v_mfma_f32_32x32x16_bf16 v[96:111], v[24:27], v[36:39], 0
  ds_read_b64_tr_b16 v[60:61], v22 offset:4096
  ds_read_b64_tr_b16 v[62:63], v22 offset:5120
  ds_read_b128 v[48:51], v7 offset:4096
  s_add_u32 m0, s89, 81920
  s_mov_b32 s13, 256
  buffer_load_dwordx4 v1, s[52:55], s13 offen lds
  s_add_u32 m0, s85, 98304
  s_mov_b32 s13, 256
  buffer_load_dwordx4 v3, s[56:59], s13 offen lds
  s_lshl_b32 s97, s4, 7
  s_lshl_b32 s98, s5, 3
  s_add_u32 s97, s97, s98
  v_mfma_f32_32x32x16_bf16 v[128:143], v[40:43], v[24:27], 0
  s_lshl_b32 s98, s3, 1
  s_add_u32 s97, s97, s98
  v_lshrrev_b32 v216, 5, v0
  v_add_u32 v216, s97, v216
  v_mfma_f32_32x32x16_bf16 v[80:95], v[28:31], v[32:35], 0
  v_and_b32 v217, 31, v0
  v_lshlrev_b32 v217, 4, v217
  v_lshl_add_u32 v216, v216, 10, v217
  buffer_load_dwordx4 v[160:163], v216, s[52:55], 0 offen
  buffer_load_dwordx4 v[164:167], v216, s[52:55], 0 offen offset:512
  v_mfma_f32_32x32x16_bf16 v[112:127], v[28:31], v[36:39], 0
  v_lshrrev_b32 v217, 2, v0
  s_lshl_b32 s97, s4, 5
  v_add_u32 v218, s97, v217
  s_movk_i32 s98, 3584
  s_waitcnt lgkmcnt(0)
  v_mfma_f32_32x32x16_bf16 v[64:79], v[44:47], v[52:55], v[64:79]
  ds_read_b128 v[24:27], v8 offset:0
  ds_read_b128 v[32:35], v16 offset:0
  ds_read_b128 v[36:39], v16 offset:4096
  v_mfma_f32_32x32x16_bf16 v[96:111], v[44:47], v[56:59], v[96:111]
  ds_read_b64_tr_b16 v[40:41], v22 offset:8192
  ds_read_b64_tr_b16 v[42:43], v22 offset:9216
  ds_read_b128 v[28:31], v8 offset:4096
  s_add_u32 m0, s84, 106496
  s_mov_b32 s13, 458752
  buffer_load_dwordx4 v5, s[60:63], s13 offen lds
  s_add_u32 m0, s89, 82944
  s_mov_b32 s13, 4352
  buffer_load_dwordx4 v2, s[52:55], s13 offen lds
  s_add_u32 m0, s84, 107520
  s_mov_b32 s13, 473088
  buffer_load_dwordx4 v5, s[60:63], s13 offen lds
  v_mul_lo_u32 v218, v218, s98
  v_and_b32 v219, 3, v0
  v_mfma_f32_32x32x16_bf16 v[128:143], v[60:63], v[44:47], v[128:143]
  v_lshlrev_b32 v219, 4, v219
  s_lshl_b32 s97, s3, 5
  s_add_u32 s97, s97, s88
  s_lshl_b32 s97, s97, 1
  v_add3_u32 v218, v218, v219, s97
  v_mfma_f32_32x32x16_bf16 v[80:95], v[48:51], v[52:55], v[80:95]
  buffer_load_dwordx4 v[168:171], v218, s[60:63], 0 offen
  s_mov_b32 s99, 57344
  buffer_load_dwordx4 v[172:175], v218, s[60:63], s99 offen
  s_lshl_b32 s97, s5, 5
  s_lshl_b32 s98, s6, 4
  v_mfma_f32_32x32x16_bf16 v[112:127], v[48:51], v[56:59], v[112:127]
  s_add_u32 s97, s97, s98
  v_add_u32 v218, s97, v217
  v_lshl_add_u32 v218, v218, 10, v219
  s_lshl_b32 s97, s4, 6
  buffer_load_dwordx4 v[176:179], v218, s[56:59], s97 offen
  s_waitcnt lgkmcnt(0)
  v_mfma_f32_32x32x16_bf16 v[64:79], v[24:27], v[32:35], v[64:79]
  ds_read_b128 v[44:47], v9 offset:0
  ds_read_b128 v[52:55], v17 offset:0
  ds_read_b128 v[56:59], v17 offset:4096
  v_mfma_f32_32x32x16_bf16 v[96:111], v[24:27], v[36:39], v[96:111]
  ds_read_b64_tr_b16 v[60:61], v22 offset:12288
  ds_read_b64_tr_b16 v[62:63], v22 offset:13312
  ds_read_b128 v[48:51], v9 offset:4096
  s_add_u32 m0, s89, 83968
  s_mov_b32 s13, 8448
  buffer_load_dwordx4 v1, s[52:55], s13 offen lds
  v_mfma_f32_32x32x16_bf16 v[128:143], v[40:43], v[24:27], v[128:143]
  v_mfma_f32_32x32x16_bf16 v[80:95], v[28:31], v[32:35], v[80:95]
  s_add_u32 m0, s85, 99328
  s_mov_b32 s13, 256
  buffer_load_dwordx4 v4, s[56:59], s13 offen lds
  v_mfma_f32_32x32x16_bf16 v[112:127], v[28:31], v[36:39], v[112:127]
  s_waitcnt lgkmcnt(0)
  s_waitcnt vmcnt(13)
  s_barrier
  v_mfma_f32_32x32x16_bf16 v[64:79], v[44:47], v[52:55], v[64:79]
  ds_read_b128 v[24:27], v6 offset:40960
  ds_read_b128 v[32:35], v14 offset:40960
  ds_read_b128 v[36:39], v14 offset:45056
  v_mfma_f32_32x32x16_bf16 v[96:111], v[44:47], v[56:59], v[96:111]
  ds_read_b64_tr_b16 v[40:41], v22 offset:40960
  ds_read_b64_tr_b16 v[42:43], v22 offset:41984
  ds_read_b128 v[28:31], v6 offset:45056
  s_add_u32 m0, s84, 108544
  s_mov_b32 s13, 487424
  buffer_load_dwordx4 v5, s[60:63], s13 offen lds
  v_mfma_f32_32x32x16_bf16 v[128:143], v[60:63], v[44:47], v[128:143]
  s_add_u32 m0, s89, 84992
  s_mov_b32 s13, 12544
  buffer_load_dwordx4 v2, s[52:55], s13 offen lds
  v_mfma_f32_32x32x16_bf16 v[80:95], v[48:51], v[52:55], v[80:95]
  s_add_u32 m0, s84, 109568
  s_mov_b32 s13, 501760
  buffer_load_dwordx4 v5, s[60:63], s13 offen lds
  v_mfma_f32_32x32x16_bf16 v[112:127], v[48:51], v[56:59], v[112:127]
  s_waitcnt lgkmcnt(0)
  v_mfma_f32_32x32x16_bf16 v[64:79], v[24:27], v[32:35], v[64:79]
  ds_read_b128 v[44:47], v7 offset:40960
  ds_read_b128 v[52:55], v15 offset:40960
  ds_read_b128 v[56:59], v15 offset:45056
  v_mfma_f32_32x32x16_bf16 v[96:111], v[24:27], v[36:39], v[96:111]
  ds_read_b64_tr_b16 v[60:61], v22 offset:45056
  ds_read_b64_tr_b16 v[62:63], v22 offset:46080
  ds_read_b128 v[48:51], v7 offset:45056
  s_add_u32 m0, s89, 122880
  s_mov_b32 s13, 384
  buffer_load_dwordx4 v1, s[52:55], s13 offen lds
  v_mfma_f32_32x32x16_bf16 v[128:143], v[40:43], v[24:27], v[128:143]
  v_mfma_f32_32x32x16_bf16 v[80:95], v[28:31], v[32:35], v[80:95]
  s_add_u32 m0, s85, 139264
  s_mov_b32 s13, 384
  buffer_load_dwordx4 v3, s[56:59], s13 offen lds
  v_mfma_f32_32x32x16_bf16 v[112:127], v[28:31], v[36:39], v[112:127]
  s_waitcnt lgkmcnt(0)
  v_mfma_f32_32x32x16_bf16 v[64:79], v[44:47], v[52:55], v[64:79]
  ds_read_b128 v[24:27], v8 offset:40960
  ds_read_b128 v[32:35], v16 offset:40960
  ds_read_b128 v[36:39], v16 offset:45056
  v_mfma_f32_32x32x16_bf16 v[96:111], v[44:47], v[56:59], v[96:111]
  ds_read_b64_tr_b16 v[40:41], v22 offset:49152
  ds_read_b64_tr_b16 v[42:43], v22 offset:50176
  ds_read_b128 v[28:31], v8 offset:45056
  s_add_u32 m0, s84, 147456
  s_mov_b32 s13, 688128
  buffer_load_dwordx4 v5, s[60:63], s13 offen lds
  v_mfma_f32_32x32x16_bf16 v[128:143], v[60:63], v[44:47], v[128:143]
  s_add_u32 m0, s89, 123904
  s_mov_b32 s13, 4480
  buffer_load_dwordx4 v2, s[52:55], s13 offen lds
  v_mfma_f32_32x32x16_bf16 v[80:95], v[48:51], v[52:55], v[80:95]
  s_add_u32 m0, s84, 148480
  s_mov_b32 s13, 702464
  buffer_load_dwordx4 v5, s[60:63], s13 offen lds
  v_mfma_f32_32x32x16_bf16 v[112:127], v[48:51], v[56:59], v[112:127]
  s_waitcnt lgkmcnt(0)
  v_mfma_f32_32x32x16_bf16 v[64:79], v[24:27], v[32:35], v[64:79]
  ds_read_b128 v[44:47], v9 offset:40960
  ds_read_b128 v[52:55], v17 offset:40960
  ds_read_b128 v[56:59], v17 offset:45056
  v_mfma_f32_32x32x16_bf16 v[96:111], v[24:27], v[36:39], v[96:111]
  ds_read_b64_tr_b16 v[60:61], v22 offset:53248
  ds_read_b64_tr_b16 v[62:63], v22 offset:54272
  ds_read_b128 v[48:51], v9 offset:45056
  s_add_u32 m0, s89, 124928
  s_mov_b32 s13, 8576
  buffer_load_dwordx4 v1, s[52:55], s13 offen lds
  v_mfma_f32_32x32x16_bf16 v[128:143], v[40:43], v[24:27], v[128:143]
  v_mfma_f32_32x32x16_bf16 v[80:95], v[28:31], v[32:35], v[80:95]
  s_add_u32 m0, s85, 140288
  s_mov_b32 s13, 384
  buffer_load_dwordx4 v4, s[56:59], s13 offen lds
  v_mfma_f32_32x32x16_bf16 v[112:127], v[28:31], v[36:39], v[112:127]
  s_waitcnt lgkmcnt(0)
  s_waitcnt vmcnt(12)
  s_waitcnt lgkmcnt(0)
  s_mul_i32 s8, s8, 0x9E3779B1
  s_add_u32 s8, s8, 0x7F4A7C15
  v_mov_b32 v200, 0
  v_mov_b32 v202, 0
  v_mov_b32 v203, 0x3f803f80
  v_dot2c_f32_bf16 v200, v160, v203
  v_dot2c_f32_bf16 v202, v160, v160
  v_dot2c_f32_bf16 v200, v161, v203
  v_dot2c_f32_bf16 v202, v161, v161
  v_dot2c_f32_bf16 v200, v162, v203
  v_dot2c_f32_bf16 v202, v162, v162
  v_dot2c_f32_bf16 v200, v163, v203
  v_dot2c_f32_bf16 v202, v163, v163
  v_dot2c_f32_bf16 v200, v164, v203
  v_dot2c_f32_bf16 v202, v164, v164
  v_dot2c_f32_bf16 v200, v165, v203
  v_dot2c_f32_bf16 v202, v165, v165
  v_dot2c_f32_bf16 v200, v166, v203
  v_dot2c_f32_bf16 v202, v166, v166
  v_dot2c_f32_bf16 v200, v167, v203
  v_dot2c_f32_bf16 v202, v167, v167
  s_nop 2
  s_nop 0
  v_add_f32_dpp v200, v200, v200 quad_perm:[1,0,3,2] row_mask:0xf bank_mask:0xf
  v_add_f32_dpp v202, v202, v202 quad_perm:[1,0,3,2] row_mask:0xf bank_mask:0xf
  s_nop 0
  v_add_f32_dpp v200, v200, v200 quad_perm:[2,3,0,1] row_mask:0xf bank_mask:0xf
  v_add_f32_dpp v202, v202, v202 quad_perm:[2,3,0,1] row_mask:0xf bank_mask:0xf
  s_nop 0
  v_add_f32_dpp v200, v200, v200 row_half_mirror row_mask:0xf bank_mask:0xf
  v_add_f32_dpp v202, v202, v202 row_half_mirror row_mask:0xf bank_mask:0xf
  s_nop 0
  v_add_f32_dpp v200, v200, v200 row_mirror row_mask:0xf bank_mask:0xf
  v_add_f32_dpp v202, v202, v202 row_mirror row_mask:0xf bank_mask:0xf
  v_mov_b32 v201, v200
  v_mov_b32 v203, v202
  s_nop 0
  v_permlane16_swap_b32 v200, v201
  v_permlane16_swap_b32 v202, v203
  v_add_f32 v200, v200, v201
  v_add_f32 v202, v202, v203
  v_mul_f32 v200, 0x3b000000, v200
  v_mul_f32 v202, 0x3b000000, v202
  v_fma_f32 v202, -v200, v200, v202
  v_max_f32 v202, 0, v202
  v_cvt_pk_bf16_f32 v200, v200, v200
  v_lshlrev_b32 v200, 16, v200
  v_cvt_pk_bf16_f32 v202, v202, v202
  v_lshlrev_b32 v202, 16, v202
  v_add_f32 v202, 0x3727c5ac, v202
  v_cvt_pk_bf16_f32 v202, v202, v202
  v_lshlrev_b32 v202, 16, v202
  v_sqrt_f32 v202, v202
  s_nop 0
  v_cvt_pk_bf16_f32 v202, v202, v202
  v_lshlrev_b32 v202, 16, v202
  v_rcp_f32 v204, v202
  v_mov_b32 v205, s8
  v_mov_b32 v206, v200
  v_mov_b32 v207, s8
  s_lshl_b32 s97, s4, 7
  s_lshl_b32 s98, s5, 3
  s_add_u32 s97, s97, s98
  s_lshl_b32 s98, s3, 1
  s_add_u32 s97, s97, s98
  s_lshl_b32 s97, s97, 4
  s_add_u32 s97, s97, 4096
  v_lshrrev_b32 v216, 5, v0
  v_lshlrev_b32 v216, 4, v216
  s_mov_b32 exec_lo, 0x1
  s_mov_b32 exec_hi, 0x1
  buffer_store_dwordx4 v[204:207], v216, s[64:67], s97 offen sc1
  s_mov_b64 exec, -1
  v_lshlrev_b32 v184, 16, v168
  v_and_b32 v185, 0xffff0000, v168
  v_lshlrev_b32 v186, 16, v169
  v_and_b32 v187, 0xffff0000, v169
  v_lshlrev_b32 v188, 16, v170
  v_and_b32 v189, 0xffff0000, v170
  v_lshlrev_b32 v190, 16, v171
  v_and_b32 v191, 0xffff0000, v171
  v_lshlrev_b32 v192, 16, v172
  v_and_b32 v193, 0xffff0000, v172
  v_lshlrev_b32 v194, 16, v173
  v_and_b32 v195, 0xffff0000, v173
  v_lshlrev_b32 v196, 16, v174
  v_and_b32 v197, 0xffff0000, v174
  v_lshlrev_b32 v198, 16, v175
  v_and_b32 v199, 0xffff0000, v175
  v_add_f32 v184, v184, v192
  v_add_f32 v185, v185, v193
  v_add_f32 v186, v186, v194
  v_add_f32 v187, v187, v195
  v_add_f32 v188, v188, v196
  v_add_f32 v189, v189, v197
  v_add_f32 v190, v190, v198
  v_add_f32 v191, v191, v199
  s_nop 1
  v_permlane32_swap_b32 v184, v188
  v_permlane32_swap_b32 v185, v189
  v_permlane32_swap_b32 v186, v190
  v_permlane32_swap_b32 v187, v191
  v_add_f32 v184, v184, v188
  v_add_f32 v185, v185, v189
  v_add_f32 v186, v186, v190
  v_add_f32 v187, v187, v191
  s_nop 1
  v_permlane16_swap_b32 v184, v186
  v_permlane16_swap_b32 v185, v187
  v_add_f32 v184, v184, v186
  v_add_f32 v185, v185, v187
  s_nop 1
  v_add_f32_dpp v184, v184, v184 row_ror:4 row_mask:0xf bank_mask:0xf
  v_add_f32_dpp v185, v185, v185 row_ror:4 row_mask:0xf bank_mask:0xf
  s_nop 1
  v_add_f32_dpp v184, v184, v184 row_ror:8 row_mask:0xf bank_mask:0xf
  v_add_f32_dpp v185, v185, v185 row_ror:8 row_mask:0xf bank_mask:0xf
  v_mov_b32 v208, v184
  v_mov_b32 v209, s8
  v_mov_b32 v210, v185
  v_mov_b32 v211, s8
  v_and_b32 v216, 3, v0
  v_lshlrev_b32 v216, 3, v216
  v_lshrrev_b32 v217, 5, v0
  v_lshl_add_u32 v216, v217, 2, v216
  v_bfe_u32 v217, v0, 4, 1
  v_lshl_add_u32 v216, v217, 1, v216
  v_lshlrev_b32 v216, 3, v216
  s_lshl_b32 s97, s5, 4
  s_add_u32 s97, s97, s4
  s_mul_i32 s97, s97, 1536
  s_add_u32 s97, s97, 65536
  s_lshl_b32 s98, s3, 8
  s_add_u32 s98, s98, s97
  s_mov_b32 exec_lo, 0xf000f
  s_mov_b32 exec_hi, 0xf000f
  buffer_store_dwordx4 v[208:211], v216, s[64:67], s98 offen sc1
  s_mov_b64 exec, -1
  v_mov_b32 v212, 0
  v_mov_b32 v213, 0x3f803f80
  v_dot2c_f32_bf16 v212, v176, v213
  v_dot2c_f32_bf16 v212, v177, v213
  v_dot2c_f32_bf16 v212, v178, v213
  v_dot2c_f32_bf16 v212, v179, v213
  s_nop 1
  s_nop 1
  v_add_f32_dpp v212, v212, v212 quad_perm:[1,0,3,2] row_mask:0xf bank_mask:0xf
  s_nop 1
  v_add_f32_dpp v212, v212, v212 quad_perm:[2,3,0,1] row_mask:0xf bank_mask:0xf
  v_mov_b32 v213, s8
  v_lshrrev_b32 v216, 2, v0
  v_lshlrev_b32 v216, 3, v216
  s_lshl_b32 s98, s3, 7
  s_add_u32 s98, s98, s97
  s_add_u32 s98, s98, 1024
  s_mov_b32 exec_lo, 0x11111111
  s_mov_b32 exec_hi, 0x11111111
  buffer_store_dwordx2 v[212:213], v216, s[64:67], s98 offen sc1
  s_mov_b64 exec, -1
  s_waitcnt vmcnt(10)
  s_barrier
  v_mfma_f32_32x32x16_bf16 v[64:79], v[44:47], v[52:55], v[64:79]
  ds_read_b128 v[24:27], v10 offset:0
  ds_read_b128 v[32:35], v18 offset:0
  ds_read_b128 v[36:39], v18 offset:4096
  v_mfma_f32_32x32x16_bf16 v[96:111], v[44:47], v[56:59], v[96:111]
  ds_read_b64_tr_b16 v[40:41], v23 offset:0
  ds_read_b64_tr_b16 v[42:43], v23 offset:1024
  ds_read_b128 v[28:31], v10 offset:4096
  s_add_u32 m0, s84, 149504
  s_mov_b32 s13, 716800
  buffer_load_dwordx4 v5, s[60:63], s13 offen lds
  v_mfma_f32_32x32x16_bf16 v[128:143], v[60:63], v[44:47], v[128:143]
  s_add_u32 m0, s89, 125952
  s_mov_b32 s13, 12672
  buffer_load_dwordx4 v2, s[52:55], s13 offen lds
  v_mfma_f32_32x32x16_bf16 v[80:95], v[48:51], v[52:55], v[80:95]
  s_add_u32 m0, s84, 150528
  s_mov_b32 s13, 731136
  buffer_load_dwordx4 v5, s[60:63], s13 offen lds
  v_mfma_f32_32x32x16_bf16 v[112:127], v[48:51], v[56:59], v[112:127]
  s_waitcnt lgkmcnt(0)
  v_mfma_f32_32x32x16_bf16 v[64:79], v[24:27], v[32:35], v[64:79]
  ds_read_b128 v[44:47], v11 offset:0
  ds_read_b128 v[52:55], v19 offset:0
  ds_read_b128 v[56:59], v19 offset:4096
  v_mfma_f32_32x32x16_bf16 v[96:111], v[24:27], v[36:39], v[96:111]
  ds_read_b64_tr_b16 v[60:61], v23 offset:4096
  ds_read_b64_tr_b16 v[62:63], v23 offset:5120
  ds_read_b128 v[48:51], v11 offset:4096
  s_add_u32 m0, s89, 0
  s_mov_b32 s13, 512
  buffer_load_dwordx4 v1, s[52:55], s13 offen lds
  s_add_u32 m0, s85, 16384
  s_mov_b32 s13, 512
  buffer_load_dwordx4 v3, s[56:59], s13 offen lds
  v_and_b32 v218, 31, v0
  s_lshl_b32 s97, s5, 5
  v_mfma_f32_32x32x16_bf16 v[128:143], v[40:43], v[24:27], v[128:143]
  v_add_u32 v218, s97, v218
  v_lshlrev_b32 v218, 1, v218
  global_load_ushort v181, v218, s[18:19]
  global_load_ushort v182, v218, s[20:21]
  v_mfma_f32_32x32x16_bf16 v[80:95], v[28:31], v[32:35], v[80:95]
  global_load_ushort v183, v218, s[30:31]
  s_waitcnt vmcnt(0)
  v_lshlrev_b32 v181, 16, v181
  v_lshlrev_b32 v182, 16, v182
  v_mfma_f32_32x32x16_bf16 v[112:127], v[28:31], v[36:39], v[112:127]
  v_lshlrev_b32 v183, 16, v183
  v_mul_f32 v183, 0x3fb8aa3b, v183
  v_exp_f32 v183, v183
  s_waitcnt lgkmcnt(0)
  v_mfma_f32_32x32x16_bf16 v[64:79], v[44:47], v[52:55], v[64:79]
  ds_read_b128 v[24:27], v12 offset:0
  ds_read_b128 v[32:35], v20 offset:0
  ds_read_b128 v[36:39], v20 offset:4096
  v_mfma_f32_32x32x16_bf16 v[96:111], v[44:47], v[56:59], v[96:111]
  ds_read_b64_tr_b16 v[40:41], v23 offset:8192
  ds_read_b64_tr_b16 v[42:43], v23 offset:9216
  ds_read_b128 v[28:31], v12 offset:4096
  s_add_u32 m0, s84, 24576
  s_mov_b32 s13, 917504
  buffer_load_dwordx4 v5, s[60:63], s13 offen lds
  s_add_u32 m0, s89, 1024
  s_mov_b32 s13, 4608
  buffer_load_dwordx4 v2, s[52:55], s13 offen lds
  s_add_u32 m0, s84, 25600
  s_mov_b32 s13, 931840
  buffer_load_dwordx4 v5, s[60:63], s13 offen lds
  s_nop 0
  v_mfma_f32_32x32x16_bf16 v[128:143], v[60:63], v[44:47], v[128:143]
  v_cvt_pk_bf16_f32 v183, v183, v183
  v_lshlrev_b32 v183, 16, v183
  v_mul_f32 v184, v183, v181
  v_mul_f32 v185, v183, v182
  v_mfma_f32_32x32x16_bf16 v[80:95], v[48:51], v[52:55], v[80:95]
  v_mul_f32 v184, 0x3fb8aa3b, v184
  v_mul_f32 v185, 0x3e22f983, v185
  v_mul_f32 v186, 0x3f800000, v184
  v_mul_f32 v187, 0x3f800000, v185
  v_mfma_f32_32x32x16_bf16 v[112:127], v[48:51], v[56:59], v[112:127]
  v_exp_f32 v186, v186
  v_fract_f32 v187, v187
  s_nop 0
  v_cos_f32 v144, v187
  s_waitcnt lgkmcnt(0)
  v_mfma_f32_32x32x16_bf16 v[64:79], v[24:27], v[32:35], v[64:79]
  ds_read_b128 v[44:47], v13 offset:0
  ds_read_b128 v[52:55], v21 offset:0
  ds_read_b128 v[56:59], v21 offset:4096
  v_mfma_f32_32x32x16_bf16 v[96:111], v[24:27], v[36:39], v[96:111]
  ds_read_b64_tr_b16 v[60:61], v23 offset:12288
  ds_read_b64_tr_b16 v[62:63], v23 offset:13312
  ds_read_b128 v[48:51], v13 offset:4096
  s_add_u32 m0, s89, 2048
  s_mov_b32 s13, 8704
  buffer_load_dwordx4 v1, s[52:55], s13 offen lds
  s_add_u32 m0, s85, 17408
  s_mov_b32 s13, 512
  buffer_load_dwordx4 v4, s[56:59], s13 offen lds
  v_sin_f32 v145, v187
  s_nop 0
  v_mfma_f32_32x32x16_bf16 v[128:143], v[40:43], v[24:27], v[128:143]
  v_mul_f32 v144, v144, v186
  v_mul_f32 v145, v145, v186
  v_mul_f32 v186, 0x41800000, v184
  v_mul_f32 v187, 0x41800000, v185
  v_mfma_f32_32x32x16_bf16 v[80:95], v[28:31], v[32:35], v[80:95]
  v_exp_f32 v186, v186
  v_fract_f32 v187, v187
  s_nop 0
  v_cos_f32 v146, v187
  v_mfma_f32_32x32x16_bf16 v[112:127], v[28:31], v[36:39], v[112:127]
  v_sin_f32 v147, v187
  s_nop 0
  v_mul_f32 v146, v146, v186
  s_waitcnt lgkmcnt(0)
  s_waitcnt vmcnt(10)
  s_barrier
  v_mfma_f32_32x32x16_bf16 v[64:79], v[44:47], v[52:55], v[64:79]
  ds_read_b128 v[24:27], v10 offset:40960
  ds_read_b128 v[32:35], v18 offset:40960
  ds_read_b128 v[36:39], v18 offset:45056
  v_mfma_f32_32x32x16_bf16 v[96:111], v[44:47], v[56:59], v[96:111]
  ds_read_b64_tr_b16 v[40:41], v23 offset:40960
  ds_read_b64_tr_b16 v[42:43], v23 offset:41984
  ds_read_b128 v[28:31], v10 offset:45056
  s_add_u32 m0, s84, 26624
  s_mov_b32 s13, 946176
  buffer_load_dwordx4 v5, s[60:63], s13 offen lds
  s_add_u32 m0, s89, 3072
  s_mov_b32 s13, 12800
  buffer_load_dwordx4 v2, s[52:55], s13 offen lds
  s_add_u32 m0, s84, 27648
  s_mov_b32 s13, 960512
  buffer_load_dwordx4 v5, s[60:63], s13 offen lds
  v_mul_f32 v147, v147, v186
  v_mfma_f32_32x32x16_bf16 v[128:143], v[60:63], v[44:47], v[128:143]
  v_mul_f32 v186, 0x43000000, v184
  v_mul_f32 v187, 0x43000000, v185
  v_exp_f32 v186, v186
  v_fract_f32 v187, v187
  v_mfma_f32_32x32x16_bf16 v[80:95], v[48:51], v[52:55], v[80:95]
  s_nop 0
  v_cos_f32 v148, v187
  v_sin_f32 v149, v187
  s_nop 0
  v_mfma_f32_32x32x16_bf16 v[112:127], v[48:51], v[56:59], v[112:127]
  v_mul_f32 v148, v148, v186
  v_mul_f32 v149, v149, v186
  v_mul_f32 v186, 0x43800000, v184
  v_mul_f32 v187, 0x43800000, v185
  s_waitcnt lgkmcnt(0)
  v_mfma_f32_32x32x16_bf16 v[64:79], v[24:27], v[32:35], v[64:79]
  ds_read_b128 v[44:47], v11 offset:40960
  ds_read_b128 v[52:55], v19 offset:40960
  ds_read_b128 v[56:59], v19 offset:45056
  v_mfma_f32_32x32x16_bf16 v[96:111], v[24:27], v[36:39], v[96:111]
  ds_read_b64_tr_b16 v[60:61], v23 offset:45056
  ds_read_b64_tr_b16 v[62:63], v23 offset:46080
  ds_read_b128 v[48:51], v11 offset:45056
  s_add_u32 m0, s89, 40960
  s_mov_b32 s13, 640
  buffer_load_dwordx4 v1, s[52:55], s13 offen lds
  s_add_u32 m0, s85, 57344
  s_mov_b32 s13, 640
  buffer_load_dwordx4 v3, s[56:59], s13 offen lds
  v_exp_f32 v186, v186
  v_fract_f32 v187, v187
  v_mfma_f32_32x32x16_bf16 v[128:143], v[40:43], v[24:27], v[128:143]
  s_nop 0
  v_cos_f32 v156, v187
  v_sin_f32 v157, v187
  s_nop 0
  v_mfma_f32_32x32x16_bf16 v[80:95], v[28:31], v[32:35], v[80:95]
  v_mul_f32 v156, v156, v186
  v_mul_f32 v157, v157, v186
  v_lshrrev_b32 v188, 5, v0
  s_lshl_b32 s97, s6, 2
  v_mfma_f32_32x32x16_bf16 v[112:127], v[28:31], v[36:39], v[112:127]
  s_lshl_b32 s98, s7, 1
  s_add_u32 s99, s97, s98
  s_xor_b32 s96, s99, 2
  s_waitcnt lgkmcnt(0)
  v_mfma_f32_32x32x16_bf16 v[64:79], v[44:47], v[52:55], v[64:79]
  ds_read_b128 v[24:27], v12 offset:40960
  ds_read_b128 v[32:35], v20 offset:40960
  ds_read_b128 v[36:39], v20 offset:45056
  v_mfma_f32_32x32x16_bf16 v[96:111], v[44:47], v[56:59], v[96:111]
  ds_read_b64_tr_b16 v[40:41], v23 offset:49152
  ds_read_b64_tr_b16 v[42:43], v23 offset:50176
  ds_read_b128 v[28:31], v12 offset:45056
  s_add_u32 m0, s84, 65536
  s_mov_b32 s13, 1146880
  buffer_load_dwordx4 v5, s[60:63], s13 offen lds
  s_add_u32 m0, s89, 41984
  s_mov_b32 s13, 4736
  buffer_load_dwordx4 v2, s[52:55], s13 offen lds
  s_add_u32 m0, s84, 66560
  s_mov_b32 s13, 1161216
  buffer_load_dwordx4 v5, s[60:63], s13 offen lds
  v_add_u32 v189, s99, v188
  v_mfma_f32_32x32x16_bf16 v[128:143], v[60:63], v[44:47], v[128:143]
  v_lshlrev_b32 v189, 4, v189
  v_cvt_f32_u32 v189, v189
  v_mul_f32 v186, v189, v184
  v_mul_f32 v187, v189, v185
  v_mfma_f32_32x32x16_bf16 v[80:95], v[48:51], v[52:55], v[80:95]
  v_exp_f32 v186, v186
  v_fract_f32 v187, v187
  s_nop 0
  v_cos_f32 v150, v187
  v_mfma_f32_32x32x16_bf16 v[112:127], v[48:51], v[56:59], v[112:127]
  v_sin_f32 v151, v187
  s_nop 0
  v_mul_f32 v150, v150, v186
  v_mul_f32 v151, v151, v186
  s_waitcnt lgkmcnt(0)
  v_mfma_f32_32x32x16_bf16 v[64:79], v[24:27], v[32:35], v[64:79]
  ds_read_b128 v[44:47], v13 offset:40960
  ds_read_b128 v[52:55], v21 offset:40960
  ds_read_b128 v[56:59], v21 offset:45056
  v_mfma_f32_32x32x16_bf16 v[96:111], v[24:27], v[36:39], v[96:111]
  ds_read_b64_tr_b16 v[60:61], v23 offset:53248
  ds_read_b64_tr_b16 v[62:63], v23 offset:54272
  ds_read_b128 v[48:51], v13 offset:45056
  s_add_u32 m0, s89, 43008
  s_mov_b32 s13, 8832
  buffer_load_dwordx4 v1, s[52:55], s13 offen lds
  s_add_u32 m0, s85, 58368
  s_mov_b32 s13, 640
  buffer_load_dwordx4 v4, s[56:59], s13 offen lds
  v_add_u32 v189, s96, v188
  v_lshlrev_b32 v189, 4, v189
  v_mfma_f32_32x32x16_bf16 v[128:143], v[40:43], v[24:27], v[128:143]
  v_cvt_f32_u32 v189, v189
  v_mul_f32 v186, v189, v184
  v_mul_f32 v187, v189, v185
  v_exp_f32 v186, v186
  v_mfma_f32_32x32x16_bf16 v[80:95], v[28:31], v[32:35], v[80:95]
  v_fract_f32 v187, v187
  s_nop 0
  v_cos_f32 v152, v187
  v_sin_f32 v153, v187
  v_mfma_f32_32x32x16_bf16 v[112:127], v[28:31], v[36:39], v[112:127]
  s_nop 0
  v_mul_f32 v152, v152, v186
  v_mul_f32 v153, v153, v186
  s_waitcnt lgkmcnt(0)
  s_waitcnt vmcnt(7)
  s_barrier
  v_mfma_f32_32x32x16_bf16 v[64:79], v[44:47], v[52:55], v[64:79]
  ds_read_b128 v[24:27], v6 offset:0
  ds_read_b128 v[32:35], v14 offset:0
  ds_read_b128 v[36:39], v14 offset:4096
  v_mfma_f32_32x32x16_bf16 v[96:111], v[44:47], v[56:59], v[96:111]
  ds_read_b64_tr_b16 v[40:41], v22 offset:0
  ds_read_b64_tr_b16 v[42:43], v22 offset:1024
  ds_read_b128 v[28:31], v6 offset:4096
  s_add_u32 m0, s84, 67584
  s_mov_b32 s13, 1175552
  buffer_load_dwordx4 v5, s[60:63], s13 offen lds
  s_add_u32 m0, s89, 44032
  s_mov_b32 s13, 12928
  buffer_load_dwordx4 v2, s[52:55], s13 offen lds
  s_add_u32 m0, s84, 68608
  s_mov_b32 s13, 1189888
  buffer_load_dwordx4 v5, s[60:63], s13 offen lds
  v_subrev_f32 v186, 1.0, v144
  v_mfma_f32_32x32x16_bf16 v[128:143], v[60:63], v[44:47], v[128:143]
  v_mul_f32 v187, v181, v181
  v_fmac_f32 v187, v182, v182
  v_rcp_f32 v187, v187
  s_nop 0
  v_mfma_f32_32x32x16_bf16 v[80:95], v[48:51], v[52:55], v[80:95]
  v_add_f32 v187, v187, v187
  v_mul_f32 v154, v186, v181
  v_fmac_f32 v154, v145, v182
  v_mul_f32 v154, v154, v187
  v_mfma_f32_32x32x16_bf16 v[112:127], v[48:51], v[56:59], v[112:127]
  v_mul_f32 v155, v145, v181
  v_mul_f32 v188, v186, v182
  v_sub_f32 v155, v155, v188
  v_mul_f32 v155, v155, v187
  s_waitcnt lgkmcnt(0)
  v_mfma_f32_32x32x16_bf16 v[64:79], v[24:27], v[32:35], v[64:79]
  ds_read_b128 v[44:47], v7 offset:0
  ds_read_b128 v[52:55], v15 offset:0
  ds_read_b128 v[56:59], v15 offset:4096
  v_mfma_f32_32x32x16_bf16 v[96:111], v[24:27], v[36:39], v[96:111]
  ds_read_b64_tr_b16 v[60:61], v22 offset:4096
  ds_read_b64_tr_b16 v[62:63], v22 offset:5120
  ds_read_b128 v[48:51], v7 offset:4096
  s_add_u32 m0, s89, 81920
  s_mov_b32 s13, 768
  buffer_load_dwordx4 v1, s[52:55], s13 offen lds
  v_mfma_f32_32x32x16_bf16 v[128:143], v[40:43], v[24:27], v[128:143]
  v_mfma_f32_32x32x16_bf16 v[80:95], v[28:31], v[32:35], v[80:95]
  s_add_u32 m0, s85, 98304
  s_mov_b32 s13, 768
  buffer_load_dwordx4 v3, s[56:59], s13 offen lds
  v_mfma_f32_32x32x16_bf16 v[112:127], v[28:31], v[36:39], v[112:127]
  s_waitcnt lgkmcnt(0)
  v_mfma_f32_32x32x16_bf16 v[64:79], v[44:47], v[52:55], v[64:79]
  ds_read_b128 v[24:27], v8 offset:0
  ds_read_b128 v[32:35], v16 offset:0
  ds_read_b128 v[36:39], v16 offset:4096
  v_mfma_f32_32x32x16_bf16 v[96:111], v[44:47], v[56:59], v[96:111]
  ds_read_b64_tr_b16 v[40:41], v22 offset:8192
  ds_read_b64_tr_b16 v[42:43], v22 offset:9216
  ds_read_b128 v[28:31], v8 offset:4096
  s_add_u32 m0, s84, 106496
  s_mov_b32 s13, 1376256
  buffer_load_dwordx4 v5, s[60:63], s13 offen lds
  v_mfma_f32_32x32x16_bf16 v[128:143], v[60:63], v[44:47], v[128:143]
  s_add_u32 m0, s89, 82944
  s_mov_b32 s13, 4864
  buffer_load_dwordx4 v2, s[52:55], s13 offen lds
  v_mfma_f32_32x32x16_bf16 v[80:95], v[48:51], v[52:55], v[80:95]
  s_add_u32 m0, s84, 107520
  s_mov_b32 s13, 1390592
  buffer_load_dwordx4 v5, s[60:63], s13 offen lds
  v_mfma_f32_32x32x16_bf16 v[112:127], v[48:51], v[56:59], v[112:127]
  v_lshlrev_b32 v248, 3, v0
  s_mul_i32 s10, s5, 24576
  s_lshl_b32 s11, s3, 9
  s_add_u32 s10, s10, s11
  s_add_u32 s10, s10, 65536
  s_add_u32 s13, s10, 0
  buffer_load_dwordx2 v[160:161], v248, s[64:67], s13 offen sc1
  s_add_u32 s13, s10, 1536
  buffer_load_dwordx2 v[162:163], v248, s[64:67], s13 offen sc1
  s_add_u32 s13, s10, 3072
  buffer_load_dwordx2 v[164:165], v248, s[64:67], s13 offen sc1
  s_add_u32 s13, s10, 4608
  buffer_load_dwordx2 v[166:167], v248, s[64:67], s13 offen sc1
  s_add_u32 s13, s10, 6144
  buffer_load_dwordx2 v[168:169], v248, s[64:67], s13 offen sc1
  s_add_u32 s13, s10, 7680
  buffer_load_dwordx2 v[170:171], v248, s[64:67], s13 offen sc1
  s_add_u32 s13, s10, 9216
  buffer_load_dwordx2 v[172:173], v248, s[64:67], s13 offen sc1
  s_add_u32 s13, s10, 10752
  buffer_load_dwordx2 v[174:175], v248, s[64:67], s13 offen sc1
  s_add_u32 s13, s10, 12288
  buffer_load_dwordx2 v[176:177], v248, s[64:67], s13 offen sc1
  s_add_u32 s13, s10, 13824
  buffer_load_dwordx2 v[178:179], v248, s[64:67], s13 offen sc1
  s_add_u32 s13, s10, 15360
  buffer_load_dwordx2 v[180:181], v248, s[64:67], s13 offen sc1
  s_add_u32 s13, s10, 16896
  buffer_load_dwordx2 v[182:183], v248, s[64:67], s13 offen sc1
  s_add_u32 s13, s10, 18432
  buffer_load_dwordx2 v[184:185], v248, s[64:67], s13 offen sc1
  s_add_u32 s13, s10, 19968
  buffer_load_dwordx2 v[186:187], v248, s[64:67], s13 offen sc1
  s_add_u32 s13, s10, 21504
  buffer_load_dwordx2 v[188:189], v248, s[64:67], s13 offen sc1
  s_add_u32 s13, s10, 23040
  buffer_load_dwordx2 v[190:191], v248, s[64:67], s13 offen sc1
  s_waitcnt lgkmcnt(0)
  v_mfma_f32_32x32x16_bf16 v[64:79], v[24:27], v[32:35], v[64:79]
  ds_read_b128 v[44:47], v9 offset:0
  ds_read_b128 v[52:55], v17 offset:0
  ds_read_b128 v[56:59], v17 offset:4096
  v_mfma_f32_32x32x16_bf16 v[96:111], v[24:27], v[36:39], v[96:111]
  ds_read_b64_tr_b16 v[60:61], v22 offset:12288
  ds_read_b64_tr_b16 v[62:63], v22 offset:13312
  ds_read_b128 v[48:51], v9 offset:4096
  s_add_u32 m0, s89, 83968
  s_mov_b32 s13, 8960
  buffer_load_dwordx4 v1, s[52:55], s13 offen lds
  v_mfma_f32_32x32x16_bf16 v[128:143], v[40:43], v[24:27], v[128:143]
  v_mfma_f32_32x32x16_bf16 v[80:95], v[28:31], v[32:35], v[80:95]
  s_add_u32 m0, s85, 99328
  s_mov_b32 s13, 768
  buffer_load_dwordx4 v4, s[56:59], s13 offen lds
  v_mfma_f32_32x32x16_bf16 v[112:127], v[28:31], v[36:39], v[112:127]
  s_waitcnt lgkmcnt(0)
  s_waitcnt vmcnt(23)
  s_barrier
  v_mfma_f32_32x32x16_bf16 v[64:79], v[44:47], v[52:55], v[64:79]
  ds_read_b128 v[24:27], v6 offset:40960
  ds_read_b128 v[32:35], v14 offset:40960
  ds_read_b128 v[36:39], v14 offset:45056
  v_mfma_f32_32x32x16_bf16 v[96:111], v[44:47], v[56:59], v[96:111]
  ds_read_b64_tr_b16 v[40:41], v22 offset:40960
  ds_read_b64_tr_b16 v[42:43], v22 offset:41984
  ds_read_b128 v[28:31], v6 offset:45056
  s_add_u32 m0, s84, 108544
  s_mov_b32 s13, 1404928
  buffer_load_dwordx4 v5, s[60:63], s13 offen lds
  v_mfma_f32_32x32x16_bf16 v[128:143], v[60:63], v[44:47], v[128:143]
  s_add_u32 m0, s89, 84992
  s_mov_b32 s13, 13056
  buffer_load_dwordx4 v2, s[52:55], s13 offen lds
  v_mfma_f32_32x32x16_bf16 v[80:95], v[48:51], v[52:55], v[80:95]
  s_add_u32 m0, s84, 109568
  s_mov_b32 s13, 1419264
  buffer_load_dwordx4 v5, s[60:63], s13 offen lds
  v_mfma_f32_32x32x16_bf16 v[112:127], v[48:51], v[56:59], v[112:127]
  s_waitcnt lgkmcnt(0)
  v_mfma_f32_32x32x16_bf16 v[64:79], v[24:27], v[32:35], v[64:79]
  ds_read_b128 v[44:47], v7 offset:40960
  ds_read_b128 v[52:55], v15 offset:40960
  ds_read_b128 v[56:59], v15 offset:45056
  v_mfma_f32_32x32x16_bf16 v[96:111], v[24:27], v[36:39], v[96:111]
  ds_read_b64_tr_b16 v[60:61], v22 offset:45056
  ds_read_b64_tr_b16 v[62:63], v22 offset:46080
  ds_read_b128 v[48:51], v7 offset:45056
  s_add_u32 m0, s89, 122880
  s_mov_b32 s13, 896
  buffer_load_dwordx4 v1, s[52:55], s13 offen lds
  v_mfma_f32_32x32x16_bf16 v[128:143], v[40:43], v[24:27], v[128:143]
  v_mfma_f32_32x32x16_bf16 v[80:95], v[28:31], v[32:35], v[80:95]
  s_add_u32 m0, s85, 139264
  s_mov_b32 s13, 896
  buffer_load_dwordx4 v3, s[56:59], s13 offen lds
  v_mfma_f32_32x32x16_bf16 v[112:127], v[28:31], v[36:39], v[112:127]
  s_waitcnt lgkmcnt(0)
  v_mfma_f32_32x32x16_bf16 v[64:79], v[44:47], v[52:55], v[64:79]
  ds_read_b128 v[24:27], v8 offset:40960
  ds_read_b128 v[32:35], v16 offset:40960
  ds_read_b128 v[36:39], v16 offset:45056
  v_mfma_f32_32x32x16_bf16 v[96:111], v[44:47], v[56:59], v[96:111]
  ds_read_b64_tr_b16 v[40:41], v22 offset:49152
  ds_read_b64_tr_b16 v[42:43], v22 offset:50176
  ds_read_b128 v[28:31], v8 offset:45056
  s_add_u32 m0, s84, 147456
  s_mov_b32 s13, 1605632
  buffer_load_dwordx4 v5, s[60:63], s13 offen lds
  v_mfma_f32_32x32x16_bf16 v[128:143], v[60:63], v[44:47], v[128:143]
  s_add_u32 m0, s89, 123904
  s_mov_b32 s13, 4992
  buffer_load_dwordx4 v2, s[52:55], s13 offen lds
  v_mfma_f32_32x32x16_bf16 v[80:95], v[48:51], v[52:55], v[80:95]
  s_add_u32 m0, s84, 148480
  s_mov_b32 s13, 1619968
  buffer_load_dwordx4 v5, s[60:63], s13 offen lds
  v_mfma_f32_32x32x16_bf16 v[112:127], v[48:51], v[56:59], v[112:127]
  s_waitcnt lgkmcnt(0)
  v_mfma_f32_32x32x16_bf16 v[64:79], v[24:27], v[32:35], v[64:79]
  ds_read_b128 v[44:47], v9 offset:40960
  ds_read_b128 v[52:55], v17 offset:40960
  ds_read_b128 v[56:59], v17 offset:45056
  v_mfma_f32_32x32x16_bf16 v[96:111], v[24:27], v[36:39], v[96:111]
  ds_read_b64_tr_b16 v[60:61], v22 offset:53248
  ds_read_b64_tr_b16 v[62:63], v22 offset:54272
  ds_read_b128 v[48:51], v9 offset:45056
  s_add_u32 m0, s89, 124928
  s_mov_b32 s13, 9088
  buffer_load_dwordx4 v1, s[52:55], s13 offen lds
  v_mfma_f32_32x32x16_bf16 v[128:143], v[40:43], v[24:27], v[128:143]
  s_add_u32 m0, s85, 140288
  s_mov_b32 s13, 896
  buffer_load_dwordx4 v4, s[56:59], s13 offen lds
  v_mfma_f32_32x32x16_bf16 v[80:95], v[28:31], v[32:35], v[80:95]
  s_waitcnt vmcnt(12)
  s_mov_b32 s97, 0
P_csA_chk:
  v_cmp_ne_u32 vcc, s8, v161
  s_mov_b64 s[90:91], vcc
  v_cmp_ne_u32 vcc, s8, v163
  s_or_b64 s[90:91], s[90:91], vcc
  v_cmp_ne_u32 vcc, s8, v165
  s_or_b64 s[90:91], s[90:91], vcc
  v_cmp_ne_u32 vcc, s8, v167
  s_or_b64 s[90:91], s[90:91], vcc
  v_cmp_ne_u32 vcc, s8, v169
  s_or_b64 s[90:91], s[90:91], vcc
  v_cmp_ne_u32 vcc, s8, v171
  s_or_b64 s[90:91], s[90:91], vcc
  v_cmp_ne_u32 vcc, s8, v173
  s_or_b64 s[90:91], s[90:91], vcc
  v_cmp_ne_u32 vcc, s8, v175
  s_or_b64 s[90:91], s[90:91], vcc
  v_cmp_ne_u32 vcc, s8, v177
  s_or_b64 s[90:91], s[90:91], vcc
  v_cmp_ne_u32 vcc, s8, v179
  s_or_b64 s[90:91], s[90:91], vcc
  v_cmp_ne_u32 vcc, s8, v181
  s_or_b64 s[90:91], s[90:91], vcc
  v_cmp_ne_u32 vcc, s8, v183
  s_or_b64 s[90:91], s[90:91], vcc
  v_cmp_ne_u32 vcc, s8, v185
  s_or_b64 s[90:91], s[90:91], vcc
  v_cmp_ne_u32 vcc, s8, v187
  s_or_b64 s[90:91], s[90:91], vcc
  v_cmp_ne_u32 vcc, s8, v189
  s_or_b64 s[90:91], s[90:91], vcc
  v_cmp_ne_u32 vcc, s8, v191
  s_or_b64 s[90:91], s[90:91], vcc
  s_cmp_lg_u64 s[90:91], 0
  s_cbranch_scc0 P_csA_ok
  s_add_u32 s97, s97, 1
  s_cmp_gt_u32 s97, 20000
  s_cbranch_scc1 P_csA_ok
  s_sleep 2
  v_lshlrev_b32 v248, 3, v0
  s_mul_i32 s10, s5, 24576
  s_lshl_b32 s11, s3, 9
  s_add_u32 s10, s10, s11
  s_add_u32 s10, s10, 65536
  s_add_u32 s13, s10, 0
  buffer_load_dwordx2 v[160:161], v248, s[64:67], s13 offen sc1
  s_add_u32 s13, s10, 1536
  buffer_load_dwordx2 v[162:163], v248, s[64:67], s13 offen sc1
  s_add_u32 s13, s10, 3072
  buffer_load_dwordx2 v[164:165], v248, s[64:67], s13 offen sc1
  s_add_u32 s13, s10, 4608
  buffer_load_dwordx2 v[166:167], v248, s[64:67], s13 offen sc1
  s_add_u32 s13, s10, 6144
  buffer_load_dwordx2 v[168:169], v248, s[64:67], s13 offen sc1
  s_add_u32 s13, s10, 7680
  buffer_load_dwordx2 v[170:171], v248, s[64:67], s13 offen sc1
  s_add_u32 s13, s10, 9216
  buffer_load_dwordx2 v[172:173], v248, s[64:67], s13 offen sc1
  s_add_u32 s13, s10, 10752
  buffer_load_dwordx2 v[174:175], v248, s[64:67], s13 offen sc1
  s_add_u32 s13, s10, 12288
  buffer_load_dwordx2 v[176:177], v248, s[64:67], s13 offen sc1
  s_add_u32 s13, s10, 13824
  buffer_load_dwordx2 v[178:179], v248, s[64:67], s13 offen sc1
  s_add_u32 s13, s10, 15360
  buffer_load_dwordx2 v[180:181], v248, s[64:67], s13 offen sc1
  s_add_u32 s13, s10, 16896
  buffer_load_dwordx2 v[182:183], v248, s[64:67], s13 offen sc1
  s_add_u32 s13, s10, 18432
  buffer_load_dwordx2 v[184:185], v248, s[64:67], s13 offen sc1
  s_add_u32 s13, s10, 19968
  buffer_load_dwordx2 v[186:187], v248, s[64:67], s13 offen sc1
  s_add_u32 s13, s10, 21504
  buffer_load_dwordx2 v[188:189], v248, s[64:67], s13 offen sc1
  s_add_u32 s13, s10, 23040
  buffer_load_dwordx2 v[190:191], v248, s[64:67], s13 offen sc1
  s_waitcnt vmcnt(0)
  s_branch P_csA_chk
P_csA_ok:
  v_add_f32 v248, v160, v162
  v_add_f32 v248, v248, v164
  v_add_f32 v248, v248, v166
  v_add_f32 v248, v248, v168
  v_add_f32 v248, v248, v170
  v_add_f32 v248, v248, v172
  v_add_f32 v248, v248, v174
  v_add_f32 v248, v248, v176
  v_add_f32 v248, v248, v178
  v_add_f32 v248, v248, v180
  v_add_f32 v248, v248, v182
  v_add_f32 v248, v248, v184
  v_add_f32 v248, v248, v186
  v_add_f32 v248, v248, v188
  v_add_f32 v248, v248, v190
  v_lshlrev_b32 v249, 2, v0
  s_lshl_b32 s10, s3, 8
  v_add_u32 v249, s10, v249
  ds_write_b32 v249, v248 offset:32768
  v_mfma_f32_32x32x16_bf16 v[112:127], v[28:31], v[36:39], v[112:127]
  s_waitcnt lgkmcnt(1)
  s_waitcnt vmcnt(7)
  s_barrier
  v_mfma_f32_32x32x16_bf16 v[64:79], v[44:47], v[52:55], v[64:79]
  ds_read_b128 v[24:27], v10 offset:0
  ds_read_b128 v[32:35], v18 offset:0
  ds_read_b128 v[36:39], v18 offset:4096
  v_mfma_f32_32x32x16_bf16 v[96:111], v[44:47], v[56:59], v[96:111]
  ds_read_b64_tr_b16 v[40:41], v23 offset:0
  ds_read_b64_tr_b16 v[42:43], v23 offset:1024
  ds_read_b128 v[28:31], v10 offset:4096
  s_add_u32 m0, s84, 149504
  s_mov_b32 s13, 1634304
  buffer_load_dwordx4 v5, s[60:63], s13 offen lds
  s_add_u32 m0, s89, 125952
  s_mov_b32 s13, 13184
  buffer_load_dwordx4 v2, s[52:55], s13 offen lds
  v_mfma_f32_32x32x16_bf16 v[128:143], v[60:63], v[44:47], v[128:143]
  s_add_u32 m0, s84, 150528
  s_mov_b32 s13, 1648640
  buffer_load_dwordx4 v5, s[60:63], s13 offen lds
  s_and_b32 s95, s5, 7
  s_lshr_b32 s96, s5, 3
  s_mul_i32 s94, s3, 458752
  v_lshrrev_b32 v250, 3, v0
  v_and_b32 v251, 7, v0
  v_mfma_f32_32x32x16_bf16 v[80:95], v[48:51], v[52:55], v[80:95]
  v_bfe_u32 v252, v250, 1, 1
  v_lshlrev_b32 v252, 2, v252
  v_xor_b32 v252, v252, v251
  v_lshlrev_b32 v252, 4, v252
  v_lshl_add_u32 v1, v250, 10, v252
  s_lshl_b32 s10, s95, 7
  v_add_u32 v1, s10, v1
  v_lshrrev_b32 v252, 1, v250
  v_xor_b32 v252, v252, v251
  v_lshlrev_b32 v252, 4, v252
  v_lshl_add_u32 v2, v250, 10, v252
  s_lshl_b32 s10, s95, 16
  s_lshl_b32 s11, s3, 8
  s_add_u32 s10, s10, s11
  v_add_u32 v2, s10, v2
  v_xor_b32 v3, 64, v2
  v_mfma_f32_32x32x16_bf16 v[112:127], v[48:51], v[56:59], v[112:127]
  s_mov_b32 s68, s40
  s_and_b32 s69, s41, 0xffff
  s_mov_b32 s70, 1835008
  s_mov_b32 s71, 0x20000
  s_mov_b32 s72, s26
  s_and_b32 s73, s27, 0xffff
  s_mov_b32 s74, 524288
  s_mov_b32 s75, 0x20000
  s_mov_b32 s76, s28
  s_and_b32 s77, s29, 0xffff
  s_mov_b32 s78, 524288
  s_mov_b32 s79, 0x20000
  s_waitcnt lgkmcnt(0)
  v_mfma_f32_32x32x16_bf16 v[64:79], v[24:27], v[32:35], v[64:79]
  ds_read_b128 v[44:47], v11 offset:0
  ds_read_b128 v[52:55], v19 offset:0
  ds_read_b128 v[56:59], v19 offset:4096
  v_mfma_f32_32x32x16_bf16 v[96:111], v[24:27], v[36:39], v[96:111]
  ds_read_b64_tr_b16 v[60:61], v23 offset:4096
  ds_read_b64_tr_b16 v[62:63], v23 offset:5120
  ds_read_b128 v[48:51], v11 offset:4096
  s_add_u32 m0, s86, 0
  s_add_u32 s13, s94, 0
  buffer_load_dwordx4 v1, s[68:71], s13 offen lds
  v_mfma_f32_32x32x16_bf16 v[128:143], v[40:43], v[24:27], v[128:143]
  s_add_u32 m0, s86, 1024
  s_add_u32 s13, s94, 8192
  buffer_load_dwordx4 v1, s[68:71], s13 offen lds
  v_mfma_f32_32x32x16_bf16 v[80:95], v[28:31], v[32:35], v[80:95]
  s_add_u32 m0, s86, 2048
  s_add_u32 s13, s94, 16384
  buffer_load_dwordx4 v1, s[68:71], s13 offen lds
  v_mfma_f32_32x32x16_bf16 v[112:127], v[28:31], v[36:39], v[112:127]
  s_add_u32 m0, s86, 3072
  s_add_u32 s13, s94, 24576
  buffer_load_dwordx4 v1, s[68:71], s13 offen lds
  s_waitcnt lgkmcnt(0)
  v_mfma_f32_32x32x16_bf16 v[64:79], v[44:47], v[52:55], v[64:79]
  ds_read_b128 v[24:27], v12 offset:0
  ds_read_b128 v[32:35], v20 offset:0
  ds_read_b128 v[36:39], v20 offset:4096
  v_mfma_f32_32x32x16_bf16 v[96:111], v[44:47], v[56:59], v[96:111]
  ds_read_b64_tr_b16 v[40:41], v23 offset:8192
  ds_read_b64_tr_b16 v[42:43], v23 offset:9216
  ds_read_b128 v[28:31], v12 offset:4096
  s_add_u32 m0, s86, 4096
  s_add_u32 s13, s94, 32768
  buffer_load_dwordx4 v1, s[68:71], s13 offen lds
  v_mfma_f32_32x32x16_bf16 v[128:143], v[60:63], v[44:47], v[128:143]
  s_add_u32 m0, s86, 5120
  s_add_u32 s13, s94, 40960
  buffer_load_dwordx4 v1, s[68:71], s13 offen lds
  v_mfma_f32_32x32x16_bf16 v[80:95], v[48:51], v[52:55], v[80:95]
  s_add_u32 m0, s86, 6144
  s_add_u32 s13, s94, 49152
  buffer_load_dwordx4 v1, s[68:71], s13 offen lds
  v_mfma_f32_32x32x16_bf16 v[112:127], v[48:51], v[56:59], v[112:127]
  s_add_u32 m0, s86, 7168
  s_add_u32 s13, s94, 57344
  buffer_load_dwordx4 v1, s[68:71], s13 offen lds
  s_waitcnt lgkmcnt(0)
  v_mfma_f32_32x32x16_bf16 v[64:79], v[24:27], v[32:35], v[64:79]
  ds_read_b128 v[44:47], v13 offset:0
  ds_read_b128 v[52:55], v21 offset:0
  ds_read_b128 v[56:59], v21 offset:4096
  v_mfma_f32_32x32x16_bf16 v[96:111], v[24:27], v[36:39], v[96:111]
  ds_read_b64_tr_b16 v[60:61], v23 offset:12288
  ds_read_b64_tr_b16 v[62:63], v23 offset:13312
  ds_read_b128 v[48:51], v13 offset:4096
  s_add_u32 m0, s86, 40960
  s_add_u32 s13, s94, 65536
  buffer_load_dwordx4 v1, s[68:71], s13 offen lds
  v_mfma_f32_32x32x16_bf16 v[128:143], v[40:43], v[24:27], v[128:143]
  s_add_u32 m0, s86, 41984
  s_add_u32 s13, s94, 73728
  buffer_load_dwordx4 v1, s[68:71], s13 offen lds
  v_mfma_f32_32x32x16_bf16 v[80:95], v[28:31], v[32:35], v[80:95]
  s_add_u32 m0, s86, 43008
  s_add_u32 s13, s94, 81920
  buffer_load_dwordx4 v1, s[68:71], s13 offen lds
  v_mfma_f32_32x32x16_bf16 v[112:127], v[28:31], v[36:39], v[112:127]
  s_add_u32 m0, s86, 44032
  s_add_u32 s13, s94, 90112
  buffer_load_dwordx4 v1, s[68:71], s13 offen lds
  s_waitcnt lgkmcnt(0)
  s_waitcnt vmcnt(12)
  s_barrier
  v_mfma_f32_32x32x16_bf16 v[64:79], v[44:47], v[52:55], v[64:79]
  ds_read_b128 v[24:27], v10 offset:40960
  ds_read_b128 v[32:35], v18 offset:40960
  ds_read_b128 v[36:39], v18 offset:45056
  v_mfma_f32_32x32x16_bf16 v[96:111], v[44:47], v[56:59], v[96:111]
  ds_read_b64_tr_b16 v[40:41], v23 offset:40960
  ds_read_b64_tr_b16 v[42:43], v23 offset:41984
  ds_read_b128 v[28:31], v10 offset:45056
  s_add_u32 m0, s86, 45056
  s_add_u32 s13, s94, 98304
  buffer_load_dwordx4 v1, s[68:71], s13 offen lds
  v_mfma_f32_32x32x16_bf16 v[128:143], v[60:63], v[44:47], v[128:143]
  s_add_u32 m0, s86, 46080
  s_add_u32 s13, s94, 106496
  buffer_load_dwordx4 v1, s[68:71], s13 offen lds
  v_mfma_f32_32x32x16_bf16 v[80:95], v[48:51], v[52:55], v[80:95]
  s_add_u32 m0, s86, 47104
  s_add_u32 s13, s94, 114688
  buffer_load_dwordx4 v1, s[68:71], s13 offen lds
  v_mfma_f32_32x32x16_bf16 v[112:127], v[48:51], v[56:59], v[112:127]
  s_add_u32 m0, s86, 48128
  s_add_u32 s13, s94, 122880
  buffer_load_dwordx4 v1, s[68:71], s13 offen lds
  s_waitcnt lgkmcnt(0)
  v_mfma_f32_32x32x16_bf16 v[64:79], v[24:27], v[32:35], v[64:79]
  ds_read_b128 v[44:47], v11 offset:40960
  ds_read_b128 v[52:55], v19 offset:40960
  ds_read_b128 v[56:59], v19 offset:45056
  v_mfma_f32_32x32x16_bf16 v[96:111], v[24:27], v[36:39], v[96:111]
  ds_read_b64_tr_b16 v[60:61], v23 offset:45056
  ds_read_b64_tr_b16 v[62:63], v23 offset:46080
  ds_read_b128 v[48:51], v11 offset:45056
  s_add_u32 m0, s86, 81920
  s_add_u32 s13, s94, 131072
  buffer_load_dwordx4 v1, s[68:71], s13 offen lds
  v_mfma_f32_32x32x16_bf16 v[128:143], v[40:43], v[24:27], v[128:143]
  s_add_u32 m0, s86, 82944
  s_add_u32 s13, s94, 139264
  buffer_load_dwordx4 v1, s[68:71], s13 offen lds
  v_mfma_f32_32x32x16_bf16 v[80:95], v[28:31], v[32:35], v[80:95]
  s_add_u32 m0, s86, 83968
  s_add_u32 s13, s94, 147456
  buffer_load_dwordx4 v1, s[68:71], s13 offen lds
  v_mfma_f32_32x32x16_bf16 v[112:127], v[28:31], v[36:39], v[112:127]
  s_waitcnt lgkmcnt(0)
  v_mfma_f32_32x32x16_bf16 v[64:79], v[44:47], v[52:55], v[64:79]
  ds_read_b128 v[24:27], v12 offset:40960
  ds_read_b128 v[32:35], v20 offset:40960
  ds_read_b128 v[36:39], v20 offset:45056
  v_mfma_f32_32x32x16_bf16 v[96:111], v[44:47], v[56:59], v[96:111]
  ds_read_b64_tr_b16 v[40:41], v23 offset:49152
  ds_read_b64_tr_b16 v[42:43], v23 offset:50176
  ds_read_b128 v[28:31], v12 offset:45056
  s_add_u32 m0, s86, 84992
  s_add_u32 s13, s94, 155648
  buffer_load_dwordx4 v1, s[68:71], s13 offen lds
  v_mfma_f32_32x32x16_bf16 v[128:143], v[60:63], v[44:47], v[128:143]
  s_add_u32 m0, s86, 86016
  s_add_u32 s13, s94, 163840
  buffer_load_dwordx4 v1, s[68:71], s13 offen lds
  v_mfma_f32_32x32x16_bf16 v[80:95], v[48:51], v[52:55], v[80:95]
  s_add_u32 m0, s86, 87040
  s_add_u32 s13, s94, 172032
  buffer_load_dwordx4 v1, s[68:71], s13 offen lds
  v_mfma_f32_32x32x16_bf16 v[112:127], v[48:51], v[56:59], v[112:127]
  s_waitcnt lgkmcnt(0)
  v_mfma_f32_32x32x16_bf16 v[64:79], v[24:27], v[32:35], v[64:79]
  ds_read_b128 v[44:47], v13 offset:40960
  ds_read_b128 v[52:55], v21 offset:40960
  ds_read_b128 v[56:59], v21 offset:45056
  v_mfma_f32_32x32x16_bf16 v[96:111], v[24:27], v[36:39], v[96:111]
  ds_read_b64_tr_b16 v[60:61], v23 offset:53248
  ds_read_b64_tr_b16 v[62:63], v23 offset:54272
  ds_read_b128 v[48:51], v13 offset:45056
  s_add_u32 m0, s86, 88064
  s_add_u32 s13, s94, 180224
  buffer_load_dwordx4 v1, s[68:71], s13 offen lds
  v_mfma_f32_32x32x16_bf16 v[128:143], v[40:43], v[24:27], v[128:143]
  v_mfma_f32_32x32x16_bf16 v[80:95], v[28:31], v[32:35], v[80:95]
  s_add_u32 m0, s86, 89088
  s_add_u32 s13, s94, 188416
  buffer_load_dwordx4 v1, s[68:71], s13 offen lds
  v_mfma_f32_32x32x16_bf16 v[112:127], v[28:31], v[36:39], v[112:127]
  s_waitcnt lgkmcnt(0)
  s_barrier
  v_mfma_f32_32x32x16_bf16 v[64:79], v[44:47], v[52:55], v[64:79]
  v_mfma_f32_32x32x16_bf16 v[96:111], v[44:47], v[56:59], v[96:111]
  s_add_u32 m0, s86, 122880
  s_add_u32 s13, s94, 196608
  buffer_load_dwordx4 v1, s[68:71], s13 offen lds
  s_add_u32 m0, s86, 123904
  s_add_u32 s13, s94, 204800
  buffer_load_dwordx4 v1, s[68:71], s13 offen lds
  v_mfma_f32_32x32x16_bf16 v[128:143], v[60:63], v[44:47], v[128:143]
  s_add_u32 m0, s86, 124928
  s_add_u32 s13, s94, 212992
  buffer_load_dwordx4 v1, s[68:71], s13 offen lds
  s_add_u32 m0, s86, 125952
  s_add_u32 s13, s94, 221184
  buffer_load_dwordx4 v1, s[68:71], s13 offen lds
  v_mfma_f32_32x32x16_bf16 v[80:95], v[48:51], v[52:55], v[80:95]
  s_add_u32 m0, s86, 126976
  s_add_u32 s13, s94, 229376
  buffer_load_dwordx4 v1, s[68:71], s13 offen lds
  s_add_u32 m0, s86, 128000
  s_add_u32 s13, s94, 237568
  buffer_load_dwordx4 v1, s[68:71], s13 offen lds
  v_mfma_f32_32x32x16_bf16 v[112:127], v[48:51], v[56:59], v[112:127]
  s_add_u32 m0, s86, 129024
  s_add_u32 s13, s94, 245760
  buffer_load_dwordx4 v1, s[68:71], s13 offen lds
  s_add_u32 m0, s86, 130048
  s_add_u32 s13, s94, 253952
  buffer_load_dwordx4 v1, s[68:71], s13 offen lds
  s_nop 15
  v_lshrrev_b32 v13, 4, v0
  v_bfe_u32 v14, v0, 2, 2
  v_and_b32 v15, 3, v0
  v_lshrrev_b32 v16, 1, v13
  v_lshl_add_u32 v16, v16, 2, v14
  v_lshlrev_b32 v16, 7, v16
  v_and_b32 v13, 1, v13
  v_lshl_add_u32 v16, v13, 5, v16
  v_lshl_add_u32 v16, v15, 3, v16
  v_add_u32 v16, s86, v16
  v_bfe_u32 v14, v0, 3, 1
  v_xor_b32 v14, s6, v14
  v_lshl_add_u32 v4, v14, 6, v16
  v_xor_b32 v14, 1, v14
  v_lshl_add_u32 v5, v14, 6, v16
  v_and_b32 v13, 31, v0
  v_lshrrev_b32 v14, 5, v0
  v_lshrrev_b32 v15, 1, v13
  v_and_b32 v15, 7, v15
  v_xor_b32 v15, v15, v14
  v_lshlrev_b32 v15, 4, v15
  v_lshl_add_u32 v15, v13, 7, v15
  s_lshl_b32 s10, s6, 12
  s_add_u32 s10, s10, s86
  v_xor_b32 v16, 0, v15
  v_add_u32 v6, s10, v16
  v_xor_b32 v16, 32, v15
  v_add_u32 v7, s10, v16
  v_xor_b32 v16, 64, v15
  v_add_u32 v8, s10, v16
  v_xor_b32 v16, 96, v15
  v_add_u32 v9, s10, v16
  v_lshlrev_b32 v10, 4, v0
  s_lshl_b32 s10, s4, 2
  s_lshl_b32 s11, s6, 1
  s_add_u32 s10, s10, s11
  s_add_u32 s11, s10, s7
  s_xor_b32 s12, s11, 1
  s_lshr_b32 s13, s5, 2
  s_mul_i32 s13, s13, 45056
  s_add_u32 s13, s13, 1048576
  s_mul_i32 s11, s11, 180224
  s_mul_i32 s12, s12, 180224
  s_add_u32 s97, s11, s13
  s_add_u32 s98, s12, s13
  s_bfe_u32 s10, s5, 0x10001
  s_mul_i32 s99, s10, 7
  v_and_b32 v13, 31, v0
  v_lshlrev_b32 v13, 2, v13
  ds_read_b32 v16, v13 offset:33280
  ds_read_b32 v17, v13 offset:33408
  v_lshrrev_b32 v14, 5, v0
  v_lshlrev_b32 v14, 6, v14
  s_lshl_b32 s10, s6, 1
  s_xor_b32 s11, s7, 0
  s_add_u32 s10, s10, s11
  s_lshl_b32 s10, s10, 7
  v_add_u32 v15, s10, v14
  ds_read_b128 v[40:43], v15 offset:34816
  ds_read_b128 v[44:47], v15 offset:34832
  ds_read_b128 v[48:51], v15 offset:34848
  ds_read_b128 v[52:55], v15 offset:34864
  ds_read_b128 v[24:27], v15 offset:34304
  ds_read_b128 v[28:31], v15 offset:34320
  ds_read_b128 v[32:35], v15 offset:34336
  ds_read_b128 v[36:39], v15 offset:34352
  s_lshl_b32 s10, s6, 1
  s_xor_b32 s11, s7, 1
  s_add_u32 s10, s10, s11
  s_lshl_b32 s10, s10, 7
  v_add_u32 v15, s10, v14
  ds_read_b128 v[240:243], v15 offset:34816
  ds_read_b128 v[244:247], v15 offset:34832
  ds_read_b128 v[248:251], v15 offset:34848
  ds_read_b128 v[252:255], v15 offset:34864
  ds_read_b128 v[224:227], v15 offset:34304
  ds_read_b128 v[228:231], v15 offset:34320
  ds_read_b128 v[232:235], v15 offset:34336
  ds_read_b128 v[236:239], v15 offset:34352
  s_waitcnt lgkmcnt(12)
  v_pk_mul_f32 v[160:161], v[16:17], v[40:41] op_sel:[0,0] op_sel_hi:[1,0] neg_lo:[0,1] neg_hi:[0,1]
  v_pk_mul_f32 v[162:163], v[16:17], v[40:41] op_sel:[0,1] op_sel_hi:[1,1] neg_lo:[0,1] neg_hi:[0,1]
  v_pk_mul_f32 v[164:165], v[16:17], v[42:43] op_sel:[0,0] op_sel_hi:[1,0] neg_lo:[0,1] neg_hi:[0,1]
  v_pk_mul_f32 v[166:167], v[16:17], v[42:43] op_sel:[0,1] op_sel_hi:[1,1] neg_lo:[0,1] neg_hi:[0,1]
  v_pk_mul_f32 v[168:169], v[16:17], v[44:45] op_sel:[0,0] op_sel_hi:[1,0] neg_lo:[0,1] neg_hi:[0,1]
  v_pk_mul_f32 v[170:171], v[16:17], v[44:45] op_sel:[0,1] op_sel_hi:[1,1] neg_lo:[0,1] neg_hi:[0,1]
  v_pk_mul_f32 v[172:173], v[16:17], v[46:47] op_sel:[0,0] op_sel_hi:[1,0] neg_lo:[0,1] neg_hi:[0,1]
  v_pk_mul_f32 v[174:175], v[16:17], v[46:47] op_sel:[0,1] op_sel_hi:[1,1] neg_lo:[0,1] neg_hi:[0,1]
  v_pk_mul_f32 v[176:177], v[16:17], v[48:49] op_sel:[0,0] op_sel_hi:[1,0] neg_lo:[0,1] neg_hi:[0,1]
  v_pk_mul_f32 v[178:179], v[16:17], v[48:49] op_sel:[0,1] op_sel_hi:[1,1] neg_lo:[0,1] neg_hi:[0,1]
  v_pk_mul_f32 v[180:181], v[16:17], v[50:51] op_sel:[0,0] op_sel_hi:[1,0] neg_lo:[0,1] neg_hi:[0,1]
  v_pk_mul_f32 v[182:183], v[16:17], v[50:51] op_sel:[0,1] op_sel_hi:[1,1] neg_lo:[0,1] neg_hi:[0,1]
  v_pk_mul_f32 v[184:185], v[16:17], v[52:53] op_sel:[0,0] op_sel_hi:[1,0] neg_lo:[0,1] neg_hi:[0,1]
  v_pk_mul_f32 v[186:187], v[16:17], v[52:53] op_sel:[0,1] op_sel_hi:[1,1] neg_lo:[0,1] neg_hi:[0,1]
  v_pk_mul_f32 v[188:189], v[16:17], v[54:55] op_sel:[0,0] op_sel_hi:[1,0] neg_lo:[0,1] neg_hi:[0,1]
  v_pk_mul_f32 v[190:191], v[16:17], v[54:55] op_sel:[0,1] op_sel_hi:[1,1] neg_lo:[0,1] neg_hi:[0,1]
  s_waitcnt lgkmcnt(8)
  v_fma_f32 v160, v64, v24, v160
  v_fma_f32 v161, v96, v24, v161
  v_fma_f32 v162, v65, v25, v162
  v_fma_f32 v163, v97, v25, v163
  v_fma_f32 v164, v66, v26, v164
  v_fma_f32 v165, v98, v26, v165
  v_fma_f32 v166, v67, v27, v166
  v_fma_f32 v167, v99, v27, v167
  v_fma_f32 v168, v68, v28, v168
  v_fma_f32 v169, v100, v28, v169
  v_fma_f32 v170, v69, v29, v170
  v_fma_f32 v171, v101, v29, v171
  v_fma_f32 v172, v70, v30, v172
  v_fma_f32 v173, v102, v30, v173
  v_fma_f32 v174, v71, v31, v174
  v_fma_f32 v175, v103, v31, v175
  v_fma_f32 v176, v72, v32, v176
  v_fma_f32 v177, v104, v32, v177
  v_fma_f32 v178, v73, v33, v178
  v_fma_f32 v179, v105, v33, v179
  v_fma_f32 v180, v74, v34, v180
  v_fma_f32 v181, v106, v34, v181
  v_fma_f32 v182, v75, v35, v182
  v_fma_f32 v183, v107, v35, v183
  v_fma_f32 v184, v76, v36, v184
  v_fma_f32 v185, v108, v36, v185
  v_fma_f32 v186, v77, v37, v186
  v_fma_f32 v187, v109, v37, v187
  v_fma_f32 v188, v78, v38, v188
  v_fma_f32 v189, v110, v38, v189
  v_fma_f32 v190, v79, v39, v190
  v_fma_f32 v191, v111, v39, v191
  s_waitcnt lgkmcnt(4)
  v_pk_mul_f32 v[192:193], v[16:17], v[240:241] op_sel:[0,0] op_sel_hi:[1,0] neg_lo:[0,1] neg_hi:[0,1]
  v_pk_mul_f32 v[194:195], v[16:17], v[240:241] op_sel:[0,1] op_sel_hi:[1,1] neg_lo:[0,1] neg_hi:[0,1]
  v_pk_mul_f32 v[196:197], v[16:17], v[242:243] op_sel:[0,0] op_sel_hi:[1,0] neg_lo:[0,1] neg_hi:[0,1]
  v_pk_mul_f32 v[198:199], v[16:17], v[242:243] op_sel:[0,1] op_sel_hi:[1,1] neg_lo:[0,1] neg_hi:[0,1]
  v_pk_mul_f32 v[200:201], v[16:17], v[244:245] op_sel:[0,0] op_sel_hi:[1,0] neg_lo:[0,1] neg_hi:[0,1]
  v_pk_mul_f32 v[202:203], v[16:17], v[244:245] op_sel:[0,1] op_sel_hi:[1,1] neg_lo:[0,1] neg_hi:[0,1]
  v_pk_mul_f32 v[204:205], v[16:17], v[246:247] op_sel:[0,0] op_sel_hi:[1,0] neg_lo:[0,1] neg_hi:[0,1]
  v_pk_mul_f32 v[206:207], v[16:17], v[246:247] op_sel:[0,1] op_sel_hi:[1,1] neg_lo:[0,1] neg_hi:[0,1]
  v_pk_mul_f32 v[208:209], v[16:17], v[248:249] op_sel:[0,0] op_sel_hi:[1,0] neg_lo:[0,1] neg_hi:[0,1]
  v_pk_mul_f32 v[210:211], v[16:17], v[248:249] op_sel:[0,1] op_sel_hi:[1,1] neg_lo:[0,1] neg_hi:[0,1]
  v_pk_mul_f32 v[212:213], v[16:17], v[250:251] op_sel:[0,0] op_sel_hi:[1,0] neg_lo:[0,1] neg_hi:[0,1]
  v_pk_mul_f32 v[214:215], v[16:17], v[250:251] op_sel:[0,1] op_sel_hi:[1,1] neg_lo:[0,1] neg_hi:[0,1]
  v_pk_mul_f32 v[216:217], v[16:17], v[252:253] op_sel:[0,0] op_sel_hi:[1,0] neg_lo:[0,1] neg_hi:[0,1]
  v_pk_mul_f32 v[218:219], v[16:17], v[252:253] op_sel:[0,1] op_sel_hi:[1,1] neg_lo:[0,1] neg_hi:[0,1]
  v_pk_mul_f32 v[220:221], v[16:17], v[254:255] op_sel:[0,0] op_sel_hi:[1,0] neg_lo:[0,1] neg_hi:[0,1]
  v_pk_mul_f32 v[222:223], v[16:17], v[254:255] op_sel:[0,1] op_sel_hi:[1,1] neg_lo:[0,1] neg_hi:[0,1]
  s_waitcnt lgkmcnt(0)
  v_fma_f32 v192, v80, v224, v192
  v_fma_f32 v193, v112, v224, v193
  v_fma_f32 v194, v81, v225, v194
  v_fma_f32 v195, v113, v225, v195
  v_fma_f32 v196, v82, v226, v196
  v_fma_f32 v197, v114, v226, v197
  v_fma_f32 v198, v83, v227, v198
  v_fma_f32 v199, v115, v227, v199
  v_fma_f32 v200, v84, v228, v200
  v_fma_f32 v201, v116, v228, v201
  v_fma_f32 v202, v85, v229, v202
  v_fma_f32 v203, v117, v229, v203
  v_fma_f32 v204, v86, v230, v204
  v_fma_f32 v205, v118, v230, v205
  v_fma_f32 v206, v87, v231, v206
  v_fma_f32 v207, v119, v231, v207
  v_fma_f32 v208, v88, v232, v208
  v_fma_f32 v209, v120, v232, v209
  v_fma_f32 v210, v89, v233, v210
  v_fma_f32 v211, v121, v233, v211
  v_fma_f32 v212, v90, v234, v212
  v_fma_f32 v213, v122, v234, v213
  v_fma_f32 v214, v91, v235, v214
  v_fma_f32 v215, v123, v235, v215
  v_fma_f32 v216, v92, v236, v216
  v_fma_f32 v217, v124, v236, v217
  v_fma_f32 v218, v93, v237, v218
  v_fma_f32 v219, v125, v237, v219
  v_fma_f32 v220, v94, v238, v220
  v_fma_f32 v221, v126, v238, v221
  v_fma_f32 v222, v95, v239, v222
  v_fma_f32 v223, v127, v239, v223
  v_mov_b32 v18, v160
  v_mov_b32 v19, v161
  v_mov_b32 v20, v192
  v_mov_b32 v21, v193
  v_pk_fma_f32 v[56:57], v[18:19], v[144:145], v[162:163] op_sel:[0,0,0] op_sel_hi:[1,0,1]
  v_pk_fma_f32 v[58:59], v[20:21], v[144:145], v[194:195] op_sel:[0,0,0] op_sel_hi:[1,0,1]
  v_pk_fma_f32 v[18:19], v[18:19], v[144:145], v[56:57] op_sel:[1,1,0] op_sel_hi:[0,1,1] neg_lo:[0,1,0]
  v_pk_fma_f32 v[20:21], v[20:21], v[144:145], v[58:59] op_sel:[1,1,0] op_sel_hi:[0,1,1] neg_lo:[0,1,0]
  v_pk_fma_f32 v[56:57], v[18:19], v[144:145], v[164:165] op_sel:[0,0,0] op_sel_hi:[1,0,1]
  v_pk_fma_f32 v[58:59], v[20:21], v[144:145], v[196:197] op_sel:[0,0,0] op_sel_hi:[1,0,1]
  v_pk_fma_f32 v[18:19], v[18:19], v[144:145], v[56:57] op_sel:[1,1,0] op_sel_hi:[0,1,1] neg_lo:[0,1,0]
  v_pk_fma_f32 v[20:21], v[20:21], v[144:145], v[58:59] op_sel:[1,1,0] op_sel_hi:[0,1,1] neg_lo:[0,1,0]
  v_pk_fma_f32 v[56:57], v[18:19], v[144:145], v[166:167] op_sel:[0,0,0] op_sel_hi:[1,0,1]
  v_pk_fma_f32 v[58:59], v[20:21], v[144:145], v[198:199] op_sel:[0,0,0] op_sel_hi:[1,0,1]
  v_pk_fma_f32 v[18:19], v[18:19], v[144:145], v[56:57] op_sel:[1,1,0] op_sel_hi:[0,1,1] neg_lo:[0,1,0]
  v_pk_fma_f32 v[20:21], v[20:21], v[144:145], v[58:59] op_sel:[1,1,0] op_sel_hi:[0,1,1] neg_lo:[0,1,0]
  v_pk_fma_f32 v[56:57], v[18:19], v[144:145], v[168:169] op_sel:[0,0,0] op_sel_hi:[1,0,1]
  v_pk_fma_f32 v[58:59], v[20:21], v[144:145], v[200:201] op_sel:[0,0,0] op_sel_hi:[1,0,1]
  v_pk_fma_f32 v[18:19], v[18:19], v[144:145], v[56:57] op_sel:[1,1,0] op_sel_hi:[0,1,1] neg_lo:[0,1,0]
  v_pk_fma_f32 v[20:21], v[20:21], v[144:145], v[58:59] op_sel:[1,1,0] op_sel_hi:[0,1,1] neg_lo:[0,1,0]
  v_pk_fma_f32 v[56:57], v[18:19], v[144:145], v[170:171] op_sel:[0,0,0] op_sel_hi:[1,0,1]
  v_pk_fma_f32 v[58:59], v[20:21], v[144:145], v[202:203] op_sel:[0,0,0] op_sel_hi:[1,0,1]
  v_pk_fma_f32 v[18:19], v[18:19], v[144:145], v[56:57] op_sel:[1,1,0] op_sel_hi:[0,1,1] neg_lo:[0,1,0]
  v_pk_fma_f32 v[20:21], v[20:21], v[144:145], v[58:59] op_sel:[1,1,0] op_sel_hi:[0,1,1] neg_lo:[0,1,0]
  v_pk_fma_f32 v[56:57], v[18:19], v[144:145], v[172:173] op_sel:[0,0,0] op_sel_hi:[1,0,1]
  v_pk_fma_f32 v[58:59], v[20:21], v[144:145], v[204:205] op_sel:[0,0,0] op_sel_hi:[1,0,1]
  v_pk_fma_f32 v[18:19], v[18:19], v[144:145], v[56:57] op_sel:[1,1,0] op_sel_hi:[0,1,1] neg_lo:[0,1,0]
  v_pk_fma_f32 v[20:21], v[20:21], v[144:145], v[58:59] op_sel:[1,1,0] op_sel_hi:[0,1,1] neg_lo:[0,1,0]
  v_pk_fma_f32 v[56:57], v[18:19], v[144:145], v[174:175] op_sel:[0,0,0] op_sel_hi:[1,0,1]
  v_pk_fma_f32 v[58:59], v[20:21], v[144:145], v[206:207] op_sel:[0,0,0] op_sel_hi:[1,0,1]
  v_pk_fma_f32 v[18:19], v[18:19], v[144:145], v[56:57] op_sel:[1,1,0] op_sel_hi:[0,1,1] neg_lo:[0,1,0]
  v_pk_fma_f32 v[20:21], v[20:21], v[144:145], v[58:59] op_sel:[1,1,0] op_sel_hi:[0,1,1] neg_lo:[0,1,0]
  v_pk_fma_f32 v[56:57], v[18:19], v[144:145], v[176:177] op_sel:[0,0,0] op_sel_hi:[1,0,1]
  v_pk_fma_f32 v[58:59], v[20:21], v[144:145], v[208:209] op_sel:[0,0,0] op_sel_hi:[1,0,1]
  v_pk_fma_f32 v[18:19], v[18:19], v[144:145], v[56:57] op_sel:[1,1,0] op_sel_hi:[0,1,1] neg_lo:[0,1,0]
  v_pk_fma_f32 v[20:21], v[20:21], v[144:145], v[58:59] op_sel:[1,1,0] op_sel_hi:[0,1,1] neg_lo:[0,1,0]
  v_pk_fma_f32 v[56:57], v[18:19], v[144:145], v[178:179] op_sel:[0,0,0] op_sel_hi:[1,0,1]
  v_pk_fma_f32 v[58:59], v[20:21], v[144:145], v[210:211] op_sel:[0,0,0] op_sel_hi:[1,0,1]
  v_pk_fma_f32 v[18:19], v[18:19], v[144:145], v[56:57] op_sel:[1,1,0] op_sel_hi:[0,1,1] neg_lo:[0,1,0]
  v_pk_fma_f32 v[20:21], v[20:21], v[144:145], v[58:59] op_sel:[1,1,0] op_sel_hi:[0,1,1] neg_lo:[0,1,0]
  v_pk_fma_f32 v[56:57], v[18:19], v[144:145], v[180:181] op_sel:[0,0,0] op_sel_hi:[1,0,1]
  v_pk_fma_f32 v[58:59], v[20:21], v[144:145], v[212:213] op_sel:[0,0,0] op_sel_hi:[1,0,1]
  v_pk_fma_f32 v[18:19], v[18:19], v[144:145], v[56:57] op_sel:[1,1,0] op_sel_hi:[0,1,1] neg_lo:[0,1,0]
  v_pk_fma_f32 v[20:21], v[20:21], v[144:145], v[58:59] op_sel:[1,1,0] op_sel_hi:[0,1,1] neg_lo:[0,1,0]
  v_pk_fma_f32 v[56:57], v[18:19], v[144:145], v[182:183] op_sel:[0,0,0] op_sel_hi:[1,0,1]
  v_pk_fma_f32 v[58:59], v[20:21], v[144:145], v[214:215] op_sel:[0,0,0] op_sel_hi:[1,0,1]
  v_pk_fma_f32 v[18:19], v[18:19], v[144:145], v[56:57] op_sel:[1,1,0] op_sel_hi:[0,1,1] neg_lo:[0,1,0]
  v_pk_fma_f32 v[20:21], v[20:21], v[144:145], v[58:59] op_sel:[1,1,0] op_sel_hi:[0,1,1] neg_lo:[0,1,0]
  v_pk_fma_f32 v[56:57], v[18:19], v[144:145], v[184:185] op_sel:[0,0,0] op_sel_hi:[1,0,1]
  v_pk_fma_f32 v[58:59], v[20:21], v[144:145], v[216:217] op_sel:[0,0,0] op_sel_hi:[1,0,1]
  v_pk_fma_f32 v[18:19], v[18:19], v[144:145], v[56:57] op_sel:[1,1,0] op_sel_hi:[0,1,1] neg_lo:[0,1,0]
  v_pk_fma_f32 v[20:21], v[20:21], v[144:145], v[58:59] op_sel:[1,1,0] op_sel_hi:[0,1,1] neg_lo:[0,1,0]
  v_pk_fma_f32 v[56:57], v[18:19], v[144:145], v[186:187] op_sel:[0,0,0] op_sel_hi:[1,0,1]
  v_pk_fma_f32 v[58:59], v[20:21], v[144:145], v[218:219] op_sel:[0,0,0] op_sel_hi:[1,0,1]
  v_pk_fma_f32 v[18:19], v[18:19], v[144:145], v[56:57] op_sel:[1,1,0] op_sel_hi:[0,1,1] neg_lo:[0,1,0]
  v_pk_fma_f32 v[20:21], v[20:21], v[144:145], v[58:59] op_sel:[1,1,0] op_sel_hi:[0,1,1] neg_lo:[0,1,0]
  v_pk_fma_f32 v[56:57], v[18:19], v[144:145], v[188:189] op_sel:[0,0,0] op_sel_hi:[1,0,1]
  v_pk_fma_f32 v[58:59], v[20:21], v[144:145], v[220:221] op_sel:[0,0,0] op_sel_hi:[1,0,1]
  v_pk_fma_f32 v[18:19], v[18:19], v[144:145], v[56:57] op_sel:[1,1,0] op_sel_hi:[0,1,1] neg_lo:[0,1,0]
  v_pk_fma_f32 v[20:21], v[20:21], v[144:145], v[58:59] op_sel:[1,1,0] op_sel_hi:[0,1,1] neg_lo:[0,1,0]
  v_pk_fma_f32 v[56:57], v[18:19], v[144:145], v[190:191] op_sel:[0,0,0] op_sel_hi:[1,0,1]
  v_pk_fma_f32 v[58:59], v[20:21], v[144:145], v[222:223] op_sel:[0,0,0] op_sel_hi:[1,0,1]
  v_pk_fma_f32 v[18:19], v[18:19], v[144:145], v[56:57] op_sel:[1,1,0] op_sel_hi:[0,1,1] neg_lo:[0,1,0]
  v_pk_fma_f32 v[20:21], v[20:21], v[144:145], v[58:59] op_sel:[1,1,0] op_sel_hi:[0,1,1] neg_lo:[0,1,0]
  v_and_b32 v13, 31, v0
  v_lshlrev_b32 v13, 6, v13
  v_lshrrev_b32 v14, 5, v0
  v_lshl_add_u32 v14, v14, 3, v13
  s_lshl_b32 s10, s6, 2
  s_xor_b32 s11, s7, 0
  s_lshl_b32 s11, s11, 1
  s_add_u32 s10, s10, s11
  s_lshl_b32 s10, s10, 3
  v_add_u32 v15, s10, v14
  ds_write_b64 v15, v[18:19] offset:36864
  s_lshl_b32 s10, s6, 2
  s_xor_b32 s11, s7, 1
  s_lshl_b32 s11, s11, 1
  s_add_u32 s10, s10, s11
  s_lshl_b32 s10, s10, 3
  v_add_u32 v15, s10, v14
  ds_write_b64 v15, v[20:21] offset:36864
  s_waitcnt lgkmcnt(0)
  s_lshl_b32 s10, s6, 2
  v_mov_b32 v15, s10
  v_mov_b32 v14, 1
  ds_write_b32 v15, v14 offset:38912
  v_xor_b32 v15, 4, v15
  s_mov_b32 s9, 0
L_eflag:
  ds_read_b32 v14, v15 offset:38912
  s_waitcnt lgkmcnt(0)
  v_cmp_ne_u32 vcc, 0, v14
  s_add_u32 s9, s9, 1
  s_cmp_gt_u32 s9, 100000
  s_cbranch_scc1 L_eflag_ok
  s_nop 1
  s_cbranch_vccz L_eflag
L_eflag_ok:
  ds_read_b128 v[24:27], v13 offset:36864
  ds_read_b128 v[28:31], v13 offset:36880
  ds_read_b128 v[32:35], v13 offset:36896
  ds_read_b128 v[36:39], v13 offset:36912
  s_waitcnt lgkmcnt(0)
  v_pk_fma_f32 v[56:57], v[24:25], v[146:147], v[26:27] op_sel:[0,0,0] op_sel_hi:[1,0,1]
  v_pk_fma_f32 v[26:27], v[24:25], v[146:147], v[56:57] op_sel:[1,1,0] op_sel_hi:[0,1,1] neg_lo:[0,1,0]
  v_pk_fma_f32 v[56:57], v[26:27], v[146:147], v[28:29] op_sel:[0,0,0] op_sel_hi:[1,0,1]
  v_pk_fma_f32 v[28:29], v[26:27], v[146:147], v[56:57] op_sel:[1,1,0] op_sel_hi:[0,1,1] neg_lo:[0,1,0]
  v_pk_fma_f32 v[56:57], v[28:29], v[146:147], v[30:31] op_sel:[0,0,0] op_sel_hi:[1,0,1]
  v_pk_fma_f32 v[30:31], v[28:29], v[146:147], v[56:57] op_sel:[1,1,0] op_sel_hi:[0,1,1] neg_lo:[0,1,0]
  v_pk_fma_f32 v[56:57], v[30:31], v[146:147], v[32:33] op_sel:[0,0,0] op_sel_hi:[1,0,1]
  v_pk_fma_f32 v[32:33], v[30:31], v[146:147], v[56:57] op_sel:[1,1,0] op_sel_hi:[0,1,1] neg_lo:[0,1,0]
  v_pk_fma_f32 v[56:57], v[32:33], v[146:147], v[34:35] op_sel:[0,0,0] op_sel_hi:[1,0,1]
  v_pk_fma_f32 v[34:35], v[32:33], v[146:147], v[56:57] op_sel:[1,1,0] op_sel_hi:[0,1,1] neg_lo:[0,1,0]
  v_pk_fma_f32 v[56:57], v[34:35], v[146:147], v[36:37] op_sel:[0,0,0] op_sel_hi:[1,0,1]
  v_pk_fma_f32 v[36:37], v[34:35], v[146:147], v[56:57] op_sel:[1,1,0] op_sel_hi:[0,1,1] neg_lo:[0,1,0]
  v_pk_fma_f32 v[56:57], v[36:37], v[146:147], v[38:39] op_sel:[0,0,0] op_sel_hi:[1,0,1]
  v_pk_fma_f32 v[38:39], v[36:37], v[146:147], v[56:57] op_sel:[1,1,0] op_sel_hi:[0,1,1] neg_lo:[0,1,0]
  s_mul_i32 s10, s5, 8192
  s_add_u32 s10, s10, 524288
  s_add_u32 s56, s48, s10
  s_addc_u32 s57, s49, 0
  s_and_b32 s57, s57, 0xffff
  s_mov_b32 s58, 8192
  s_mov_b32 s59, 0x20000
  v_mov_b32 v40, v38
  v_mov_b32 v41, s8
  v_mov_b32 v42, v39
  v_mov_b32 v43, s8
  v_and_b32 v13, 31, v0
  v_lshlrev_b32 v13, 4, v13
  s_lshl_b32 s10, s4, 9
  s_mov_b32 exec_lo, 0xffffffff
  s_mov_b32 exec_hi, 0x0
  buffer_store_dwordx4 v[40:43], v13, s[56:59], s10 offen sc1
  s_mov_b64 exec, -1
  v_lshrrev_b32 v14, 5, v0
  s_sub_u32 s10, s4, 16
  v_add_u32 v14, s10, v14
  v_lshl_add_u32 v22, v14, 9, v13
  s_cmp_eq_u32 s6, 1
  s_cselect_b64 s[90:91], -1, 0
  s_mov_b32 s92, 0
  s_mov_b32 s93, -1
  v_cndmask_b32 v44, 0, v30, s[90:91]
  v_cndmask_b32 v45, 0, v31, s[90:91]
  v_cndmask_b32 v46, v24, v32, s[90:91]
  v_cndmask_b32 v47, v25, v33, s[90:91]
  v_cndmask_b32 v48, v26, v34, s[90:91]
  v_cndmask_b32 v49, v27, v35, s[90:91]
  v_cndmask_b32 v50, v28, v36, s[90:91]
  v_cndmask_b32 v51, v29, v37, s[90:91]
  v_cndmask_b32 v52, v44, v46, s[92:93]
  v_cndmask_b32 v53, v45, v47, s[92:93]
  v_cndmask_b32 v54, v48, v50, s[92:93]
  v_cndmask_b32 v55, v49, v51, s[92:93]
  s_cmp_eq_u32 s7, 1
  s_cselect_b64 s[90:91], -1, 0
  v_cndmask_b32 v60, v52, v54, s[90:91]
  v_cndmask_b32 v62, v54, v52, s[90:91]
  v_cndmask_b32 v61, v53, v55, s[90:91]
  v_cndmask_b32 v63, v55, v53, s[90:91]
  s_waitcnt vmcnt(25)
  v_add_u32 v11, 0, v4
  v_add_u32 v12, 0, v5
  ds_read_b64_tr_b16 a[0:1], v11 offset:0
  ds_read_b64_tr_b16 a[2:3], v11 offset:1024
  ds_read_b64_tr_b16 a[4:5], v12 offset:0
  ds_read_b64_tr_b16 a[6:7], v12 offset:1024
  ds_read_b64_tr_b16 a[8:9], v11 offset:2048
  ds_read_b64_tr_b16 a[10:11], v11 offset:3072
  ds_read_b64_tr_b16 a[12:13], v12 offset:2048
  ds_read_b64_tr_b16 a[14:15], v12 offset:3072
  ds_read_b64_tr_b16 a[16:17], v11 offset:4096
  ds_read_b64_tr_b16 a[18:19], v11 offset:5120
  ds_read_b64_tr_b16 a[20:21], v12 offset:4096
  ds_read_b64_tr_b16 a[22:23], v12 offset:5120
  ds_read_b64_tr_b16 a[24:25], v11 offset:6144
  ds_read_b64_tr_b16 a[26:27], v11 offset:7168
  ds_read_b64_tr_b16 a[28:29], v12 offset:6144
  ds_read_b64_tr_b16 a[30:31], v12 offset:7168
  s_waitcnt vmcnt(17)
  v_add_u32 v11, 40960, v4
  v_add_u32 v12, 40960, v5
  ds_read_b64_tr_b16 a[32:33], v11 offset:0
  ds_read_b64_tr_b16 a[34:35], v11 offset:1024
  ds_read_b64_tr_b16 a[36:37], v12 offset:0
  ds_read_b64_tr_b16 a[38:39], v12 offset:1024
  ds_read_b64_tr_b16 a[40:41], v11 offset:2048
  ds_read_b64_tr_b16 a[42:43], v11 offset:3072
  ds_read_b64_tr_b16 a[44:45], v12 offset:2048
  ds_read_b64_tr_b16 a[46:47], v12 offset:3072
  ds_read_b64_tr_b16 a[48:49], v11 offset:4096
  ds_read_b64_tr_b16 a[50:51], v11 offset:5120
  ds_read_b64_tr_b16 a[52:53], v12 offset:4096
  ds_read_b64_tr_b16 a[54:55], v12 offset:5120
  ds_read_b64_tr_b16 a[56:57], v11 offset:6144
  ds_read_b64_tr_b16 a[58:59], v11 offset:7168
  ds_read_b64_tr_b16 a[60:61], v12 offset:6144
  ds_read_b64_tr_b16 a[62:63], v12 offset:7168
  s_waitcnt vmcnt(9)
  v_add_u32 v11, 81920, v4
  v_add_u32 v12, 81920, v5
  ds_read_b64_tr_b16 a[64:65], v11 offset:0
  ds_read_b64_tr_b16 a[66:67], v11 offset:1024
  ds_read_b64_tr_b16 a[68:69], v12 offset:0
  ds_read_b64_tr_b16 a[70:71], v12 offset:1024
  ds_read_b64_tr_b16 a[72:73], v11 offset:2048
  ds_read_b64_tr_b16 a[74:75], v11 offset:3072
  ds_read_b64_tr_b16 a[76:77], v12 offset:2048
  ds_read_b64_tr_b16 a[78:79], v12 offset:3072
  ds_read_b64_tr_b16 a[80:81], v11 offset:4096
  ds_read_b64_tr_b16 a[82:83], v11 offset:5120
  ds_read_b64_tr_b16 a[84:85], v12 offset:4096
  ds_read_b64_tr_b16 a[86:87], v12 offset:5120
  ds_read_b64_tr_b16 a[88:89], v11 offset:6144
  ds_read_b64_tr_b16 a[90:91], v11 offset:7168
  ds_read_b64_tr_b16 a[92:93], v12 offset:6144
  ds_read_b64_tr_b16 a[94:95], v12 offset:7168
  s_waitcnt vmcnt(1)
  v_add_u32 v11, 122880, v4
  v_add_u32 v12, 122880, v5
  ds_read_b64_tr_b16 a[96:97], v11 offset:0
  ds_read_b64_tr_b16 a[98:99], v11 offset:1024
  ds_read_b64_tr_b16 a[100:101], v12 offset:0
  ds_read_b64_tr_b16 a[102:103], v12 offset:1024
  ds_read_b64_tr_b16 a[104:105], v11 offset:2048
  ds_read_b64_tr_b16 a[106:107], v11 offset:3072
  ds_read_b64_tr_b16 a[108:109], v12 offset:2048
  ds_read_b64_tr_b16 a[110:111], v12 offset:3072
  ds_read_b64_tr_b16 a[112:113], v11 offset:4096
  ds_read_b64_tr_b16 a[114:115], v11 offset:5120
  ds_read_b64_tr_b16 a[116:117], v12 offset:4096
  ds_read_b64_tr_b16 a[118:119], v12 offset:5120
  ds_read_b64_tr_b16 a[120:121], v11 offset:6144
  ds_read_b64_tr_b16 a[122:123], v11 offset:7168
  ds_read_b64_tr_b16 a[124:125], v12 offset:6144
  ds_read_b64_tr_b16 a[126:127], v12 offset:7168
  s_waitcnt lgkmcnt(0)
  v_mov_b32 v112, 0xbdd2d3e8
  v_mov_b32 v113, 0xc0135761
  v_and_b32 v13, 31, v0
  v_bfe_u32 v14, v13, 2, 1
  v_lshlrev_b32 v14, 4, v14
  v_lshrrev_b32 v15, 3, v13
  v_lshl_add_u32 v14, v15, 2, v14
  v_and_b32 v15, 3, v13
  v_add_u32 v14, v14, v15
  s_lshl_b32 s10, s6, 1
  s_xor_b32 s11, s7, 0
  s_add_u32 s10, s10, s11
  s_lshl_b32 s10, s10, 5
  v_add_u32 v14, s10, v14
  v_lshlrev_b32 v23, 2, v14
  ds_read_b32 v114, v23 offset:34304
  ds_read_b32 v115, v23 offset:34816
  s_cmp_eq_u32 s7, 0
  s_cselect_b32 s10, 384, 0
  v_lshrrev_b32 v13, 5, v0
  v_lshlrev_b32 v13, 4, v13
  v_add_u32 v116, s10, v13
  ds_read_b128 v[64:67], v116 offset:32768
  ds_read_b128 v[80:83], v116 offset:33792
  ds_read_b128 v[68:71], v116 offset:32800
  ds_read_b128 v[84:87], v116 offset:33824
  ds_read_b128 v[72:75], v116 offset:32832
  ds_read_b128 v[88:91], v116 offset:33856
  ds_read_b128 v[76:79], v116 offset:32864
  ds_read_b128 v[92:95], v116 offset:33888
  s_waitcnt lgkmcnt(0)
  v_sub_f32 v115, 0, v115
  s_add_u32 s10, s99, 3
  s_lshl_b32 s10, s10, 11
  s_add_u32 s14, s97, s10
  v_pk_fma_f32 v[96:97], v[64:65], v[114:115], v[80:81] op_sel:[0,1,0] op_sel_hi:[1,1,1]
  v_pk_fma_f32 v[98:99], v[66:67], v[114:115], v[82:83] op_sel:[0,1,0] op_sel_hi:[1,1,1]
  v_pk_fma_f32 v[100:101], v[68:69], v[114:115], v[84:85] op_sel:[0,1,0] op_sel_hi:[1,1,1]
  v_pk_fma_f32 v[102:103], v[70:71], v[114:115], v[86:87] op_sel:[0,1,0] op_sel_hi:[1,1,1]
  v_pk_fma_f32 v[128:129], v[128:129], v[114:115], v[96:97] op_sel:[0,0,0] op_sel_hi:[1,0,1]
  v_pk_fma_f32 v[130:131], v[130:131], v[114:115], v[98:99] op_sel:[0,0,0] op_sel_hi:[1,0,1]
  v_pk_fma_f32 v[132:133], v[132:133], v[114:115], v[100:101] op_sel:[0,0,0] op_sel_hi:[1,0,1]
  v_pk_fma_f32 v[134:135], v[134:135], v[114:115], v[102:103] op_sel:[0,0,0] op_sel_hi:[1,0,1]
  v_pk_mul_f32 v[96:97], v[128:129], v[128:129]
  v_pk_mul_f32 v[98:99], v[130:131], v[130:131]
  v_pk_mul_f32 v[100:101], v[132:133], v[132:133]
  v_pk_mul_f32 v[102:103], v[134:135], v[134:135]
  v_pk_fma_f32 v[96:97], v[96:97], v[112:113], v[112:113] op_sel:[0,0,1] op_sel_hi:[1,0,1]
  v_pk_fma_f32 v[98:99], v[98:99], v[112:113], v[112:113] op_sel:[0,0,1] op_sel_hi:[1,0,1]
  v_pk_fma_f32 v[100:101], v[100:101], v[112:113], v[112:113] op_sel:[0,0,1] op_sel_hi:[1,0,1]
  v_pk_fma_f32 v[102:103], v[102:103], v[112:113], v[112:113] op_sel:[0,0,1] op_sel_hi:[1,0,1]
  v_pk_mul_f32 v[96:97], v[96:97], v[128:129]
  v_pk_mul_f32 v[98:99], v[98:99], v[130:131]
  v_pk_mul_f32 v[100:101], v[100:101], v[132:133]
  v_pk_mul_f32 v[102:103], v[102:103], v[134:135]
  v_exp_f32 v96, v96
  v_exp_f32 v97, v97
  v_exp_f32 v98, v98
  v_exp_f32 v99, v99
  v_exp_f32 v100, v100
  v_exp_f32 v101, v101
  v_exp_f32 v102, v102
  v_exp_f32 v103, v103
  v_pk_add_f32 v[96:97], v[96:97], 1.0
  v_pk_add_f32 v[98:99], v[98:99], 1.0
  v_pk_add_f32 v[100:101], v[100:101], 1.0
  v_pk_add_f32 v[102:103], v[102:103], 1.0
  v_rcp_f32 v96, v96
  v_rcp_f32 v97, v97
  v_rcp_f32 v98, v98
  v_rcp_f32 v99, v99
  v_rcp_f32 v100, v100
  v_rcp_f32 v101, v101
  v_rcp_f32 v102, v102
  v_rcp_f32 v103, v103
  v_pk_mul_f32 v[96:97], v[96:97], v[128:129]
  v_pk_mul_f32 v[98:99], v[98:99], v[130:131]
  v_pk_mul_f32 v[100:101], v[100:101], v[132:133]
  v_pk_mul_f32 v[102:103], v[102:103], v[134:135]
  v_cvt_pk_bf16_f32 v104, v96, v97
  v_cvt_pk_bf16_f32 v105, v98, v99
  v_cvt_pk_bf16_f32 v106, v100, v101
  v_cvt_pk_bf16_f32 v107, v102, v103
  s_add_u32 s13, s14, 0
  buffer_store_dwordx4 v[104:107], v10, s[64:67], s13 offen sc1
  v_pk_fma_f32 v[96:97], v[72:73], v[114:115], v[88:89] op_sel:[0,1,0] op_sel_hi:[1,1,1]
  v_pk_fma_f32 v[98:99], v[74:75], v[114:115], v[90:91] op_sel:[0,1,0] op_sel_hi:[1,1,1]
  v_pk_fma_f32 v[100:101], v[76:77], v[114:115], v[92:93] op_sel:[0,1,0] op_sel_hi:[1,1,1]
  v_pk_fma_f32 v[102:103], v[78:79], v[114:115], v[94:95] op_sel:[0,1,0] op_sel_hi:[1,1,1]
  v_pk_fma_f32 v[136:137], v[136:137], v[114:115], v[96:97] op_sel:[0,0,0] op_sel_hi:[1,0,1]
  v_pk_fma_f32 v[138:139], v[138:139], v[114:115], v[98:99] op_sel:[0,0,0] op_sel_hi:[1,0,1]
  v_pk_fma_f32 v[140:141], v[140:141], v[114:115], v[100:101] op_sel:[0,0,0] op_sel_hi:[1,0,1]
  v_pk_fma_f32 v[142:143], v[142:143], v[114:115], v[102:103] op_sel:[0,0,0] op_sel_hi:[1,0,1]
  v_pk_mul_f32 v[96:97], v[136:137], v[136:137]
  v_pk_mul_f32 v[98:99], v[138:139], v[138:139]
  v_pk_mul_f32 v[100:101], v[140:141], v[140:141]
  v_pk_mul_f32 v[102:103], v[142:143], v[142:143]
  v_pk_fma_f32 v[96:97], v[96:97], v[112:113], v[112:113] op_sel:[0,0,1] op_sel_hi:[1,0,1]
  v_pk_fma_f32 v[98:99], v[98:99], v[112:113], v[112:113] op_sel:[0,0,1] op_sel_hi:[1,0,1]
  v_pk_fma_f32 v[100:101], v[100:101], v[112:113], v[112:113] op_sel:[0,0,1] op_sel_hi:[1,0,1]
  v_pk_fma_f32 v[102:103], v[102:103], v[112:113], v[112:113] op_sel:[0,0,1] op_sel_hi:[1,0,1]
  v_pk_mul_f32 v[96:97], v[96:97], v[136:137]
  v_pk_mul_f32 v[98:99], v[98:99], v[138:139]
  v_pk_mul_f32 v[100:101], v[100:101], v[140:141]
  v_pk_mul_f32 v[102:103], v[102:103], v[142:143]
  v_exp_f32 v96, v96
  v_exp_f32 v97, v97
  v_exp_f32 v98, v98
  v_exp_f32 v99, v99
  v_exp_f32 v100, v100
  v_exp_f32 v101, v101
  v_exp_f32 v102, v102
  v_exp_f32 v103, v103
  v_pk_add_f32 v[96:97], v[96:97], 1.0
  v_pk_add_f32 v[98:99], v[98:99], 1.0
  v_pk_add_f32 v[100:101], v[100:101], 1.0
  v_pk_add_f32 v[102:103], v[102:103], 1.0
  v_rcp_f32 v96, v96
  v_rcp_f32 v97, v97
  v_rcp_f32 v98, v98
  v_rcp_f32 v99, v99
  v_rcp_f32 v100, v100
  v_rcp_f32 v101, v101
  v_rcp_f32 v102, v102
  v_rcp_f32 v103, v103
  v_pk_mul_f32 v[96:97], v[96:97], v[136:137]
  v_pk_mul_f32 v[98:99], v[98:99], v[138:139]
  v_pk_mul_f32 v[100:101], v[100:101], v[140:141]
  v_pk_mul_f32 v[102:103], v[102:103], v[142:143]
  v_cvt_pk_bf16_f32 v108, v96, v97
  v_cvt_pk_bf16_f32 v109, v98, v99
  v_cvt_pk_bf16_f32 v110, v100, v101
  v_cvt_pk_bf16_f32 v111, v102, v103
  s_add_u32 s13, s14, 1024
  buffer_store_dwordx4 v[108:111], v10, s[64:67], s13 offen sc1
  v_add_u32 v23, 0, v22
  buffer_load_dwordx4 v[224:227], v23, s[56:59], 0 offen sc1
  v_add_u32 v23, 1024, v22
  buffer_load_dwordx4 v[228:231], v23, s[56:59], 0 offen sc1
  v_add_u32 v23, 2048, v22
  buffer_load_dwordx4 v[232:235], v23, s[56:59], 0 offen sc1
  v_add_u32 v23, 3072, v22
  buffer_load_dwordx4 v[236:239], v23, s[56:59], 0 offen sc1
  v_add_u32 v23, 4096, v22
  buffer_load_dwordx4 v[240:243], v23, s[56:59], 0 offen sc1
  v_add_u32 v23, 5120, v22
  buffer_load_dwordx4 v[244:247], v23, s[56:59], 0 offen sc1
  v_add_u32 v23, 6144, v22
  buffer_load_dwordx4 v[248:251], v23, s[56:59], 0 offen sc1
  v_add_u32 v23, 7168, v22
  buffer_load_dwordx4 v[252:255], v23, s[56:59], 0 offen sc1
  s_add_u32 m0, s86, 0
  s_add_u32 s13, s94, 262144
  buffer_load_dwordx4 v1, s[68:71], s13 offen lds
  s_add_u32 m0, s86, 1024
  s_add_u32 s13, s94, 270336
  buffer_load_dwordx4 v1, s[68:71], s13 offen lds
  s_add_u32 m0, s86, 2048
  s_add_u32 s13, s94, 278528
  buffer_load_dwordx4 v1, s[68:71], s13 offen lds
  s_add_u32 m0, s86, 3072
  s_add_u32 s13, s94, 286720
  buffer_load_dwordx4 v1, s[68:71], s13 offen lds
  s_add_u32 m0, s86, 4096
  s_add_u32 s13, s94, 294912
  buffer_load_dwordx4 v1, s[68:71], s13 offen lds
  s_add_u32 m0, s86, 5120
  s_add_u32 s13, s94, 303104
  buffer_load_dwordx4 v1, s[68:71], s13 offen lds
  s_add_u32 m0, s86, 6144
  s_add_u32 s13, s94, 311296
  buffer_load_dwordx4 v1, s[68:71], s13 offen lds
  s_add_u32 m0, s86, 7168
  s_add_u32 s13, s94, 319488
  buffer_load_dwordx4 v1, s[68:71], s13 offen lds
  s_add_u32 m0, s86, 40960
  s_add_u32 s13, s94, 327680
  buffer_load_dwordx4 v1, s[68:71], s13 offen lds
  s_add_u32 m0, s86, 41984
  s_add_u32 s13, s94, 335872
  buffer_load_dwordx4 v1, s[68:71], s13 offen lds
  s_add_u32 m0, s86, 43008
  s_add_u32 s13, s94, 344064
  buffer_load_dwordx4 v1, s[68:71], s13 offen lds
  s_add_u32 m0, s86, 44032
  s_add_u32 s13, s94, 352256
  buffer_load_dwordx4 v1, s[68:71], s13 offen lds
  s_waitcnt vmcnt(12)
  s_lshl_b32 s10, s4, 1
  s_add_u32 s10, s10, s6
  s_lshl_b32 s10, s10, 2
  s_lshr_b32 s11, s5, 2
  s_add_u32 s10, s10, s11
  s_lshl_b32 s10, s10, 7
  s_and_b32 s11, s5, 3
  s_lshl_b32 s11, s11, 4
  s_add_u32 s10, s10, s11
  s_add_u32 s10, s10, 655368
  v_mov_b32 v13, 0
  v_mov_b32 v14, s8
  s_mov_b32 exec_lo, 0x1
  s_mov_b32 exec_hi, 0x0
  buffer_store_dword v14, v13, s[64:67], s10 offen sc1
  s_mov_b64 exec, -1
  s_mov_b32 s9, 0
P_hin_chk:
  v_mov_b32 v13, 0
  v_add_u32 v14, 0, v22
  v_xor_b32 v15, s8, v225
  v_xor_b32 v23, s8, v227
  v_ashrrev_i32 v14, 31, v14
  v_or_b32 v15, v15, v23
  v_not_b32 v14, v14
  v_and_or_b32 v13, v15, v14, v13
  v_add_u32 v14, 1024, v22
  v_xor_b32 v15, s8, v229
  v_xor_b32 v23, s8, v231
  v_ashrrev_i32 v14, 31, v14
  v_or_b32 v15, v15, v23
  v_not_b32 v14, v14
  v_and_or_b32 v13, v15, v14, v13
  v_add_u32 v14, 2048, v22
  v_xor_b32 v15, s8, v233
  v_xor_b32 v23, s8, v235
  v_ashrrev_i32 v14, 31, v14
  v_or_b32 v15, v15, v23
  v_not_b32 v14, v14
  v_and_or_b32 v13, v15, v14, v13
  v_add_u32 v14, 3072, v22
  v_xor_b32 v15, s8, v237
  v_xor_b32 v23, s8, v239
  v_ashrrev_i32 v14, 31, v14
  v_or_b32 v15, v15, v23
  v_not_b32 v14, v14
  v_and_or_b32 v13, v15, v14, v13
  v_add_u32 v14, 4096, v22
  v_xor_b32 v15, s8, v241
  v_xor_b32 v23, s8, v243
  v_ashrrev_i32 v14, 31, v14
  v_or_b32 v15, v15, v23
  v_not_b32 v14, v14
  v_and_or_b32 v13, v15, v14, v13
  v_add_u32 v14, 5120, v22
  v_xor_b32 v15, s8, v245
  v_xor_b32 v23, s8, v247
  v_ashrrev_i32 v14, 31, v14
  v_or_b32 v15, v15, v23
  v_not_b32 v14, v14
  v_and_or_b32 v13, v15, v14, v13
  v_add_u32 v14, 6144, v22
  v_xor_b32 v15, s8, v249
  v_xor_b32 v23, s8, v251
  v_ashrrev_i32 v14, 31, v14
  v_or_b32 v15, v15, v23
  v_not_b32 v14, v14
  v_and_or_b32 v13, v15, v14, v13
  v_add_u32 v14, 7168, v22
  v_xor_b32 v15, s8, v253
  v_xor_b32 v23, s8, v255
  v_ashrrev_i32 v14, 31, v14
  v_or_b32 v15, v15, v23
  v_not_b32 v14, v14
  v_and_or_b32 v13, v15, v14, v13
  v_cmp_ne_u32 vcc, 0, v13
  s_nop 0
  s_cmp_lg_u64 vcc, 0
  s_cbranch_scc0 P_hin_ok
  s_add_u32 s9, s9, 1
  s_cmp_gt_u32 s9, 20000
  s_cbranch_scc1 P_hin_ok
  s_sleep 2
  v_add_u32 v23, 0, v22
  buffer_load_dwordx4 v[224:227], v23, s[56:59], 0 offen sc1
  v_add_u32 v23, 1024, v22
  buffer_load_dwordx4 v[228:231], v23, s[56:59], 0 offen sc1
  v_add_u32 v23, 2048, v22
  buffer_load_dwordx4 v[232:235], v23, s[56:59], 0 offen sc1
  v_add_u32 v23, 3072, v22
  buffer_load_dwordx4 v[236:239], v23, s[56:59], 0 offen sc1
  v_add_u32 v23, 4096, v22
  buffer_load_dwordx4 v[240:243], v23, s[56:59], 0 offen sc1
  v_add_u32 v23, 5120, v22
  buffer_load_dwordx4 v[244:247], v23, s[56:59], 0 offen sc1
  v_add_u32 v23, 6144, v22
  buffer_load_dwordx4 v[248:251], v23, s[56:59], 0 offen sc1
  v_add_u32 v23, 7168, v22
  buffer_load_dwordx4 v[252:255], v23, s[56:59], 0 offen sc1
  s_waitcnt vmcnt(0)
  s_branch P_hin_chk
P_hin_ok:
  v_mov_b32 v18, v224
  v_mov_b32 v19, v226
  v_mov_b32 v20, v228
  v_mov_b32 v21, v230
  v_pk_fma_f32 v[56:57], v[18:19], v[156:157], v[20:21] op_sel:[0,0,0] op_sel_hi:[1,0,1]
  v_pk_fma_f32 v[18:19], v[18:19], v[156:157], v[56:57] op_sel:[1,1,0] op_sel_hi:[0,1,1] neg_lo:[0,1,0]
  v_mov_b32 v20, v232
  v_mov_b32 v21, v234
  v_pk_fma_f32 v[56:57], v[18:19], v[156:157], v[20:21] op_sel:[0,0,0] op_sel_hi:[1,0,1]
  v_pk_fma_f32 v[18:19], v[18:19], v[156:157], v[56:57] op_sel:[1,1,0] op_sel_hi:[0,1,1] neg_lo:[0,1,0]
  v_mov_b32 v20, v236
  v_mov_b32 v21, v238
  v_pk_fma_f32 v[56:57], v[18:19], v[156:157], v[20:21] op_sel:[0,0,0] op_sel_hi:[1,0,1]
  v_pk_fma_f32 v[18:19], v[18:19], v[156:157], v[56:57] op_sel:[1,1,0] op_sel_hi:[0,1,1] neg_lo:[0,1,0]
  v_mov_b32 v20, v240
  v_mov_b32 v21, v242
  v_pk_fma_f32 v[56:57], v[18:19], v[156:157], v[20:21] op_sel:[0,0,0] op_sel_hi:[1,0,1]
  v_pk_fma_f32 v[18:19], v[18:19], v[156:157], v[56:57] op_sel:[1,1,0] op_sel_hi:[0,1,1] neg_lo:[0,1,0]
  v_mov_b32 v20, v244
  v_mov_b32 v21, v246
  v_pk_fma_f32 v[56:57], v[18:19], v[156:157], v[20:21] op_sel:[0,0,0] op_sel_hi:[1,0,1]
  v_pk_fma_f32 v[18:19], v[18:19], v[156:157], v[56:57] op_sel:[1,1,0] op_sel_hi:[0,1,1] neg_lo:[0,1,0]
  v_mov_b32 v20, v248
  v_mov_b32 v21, v250
  v_pk_fma_f32 v[56:57], v[18:19], v[156:157], v[20:21] op_sel:[0,0,0] op_sel_hi:[1,0,1]
  v_pk_fma_f32 v[18:19], v[18:19], v[156:157], v[56:57] op_sel:[1,1,0] op_sel_hi:[0,1,1] neg_lo:[0,1,0]
  v_mov_b32 v20, v252
  v_mov_b32 v21, v254
  v_pk_fma_f32 v[56:57], v[18:19], v[156:157], v[20:21] op_sel:[0,0,0] op_sel_hi:[1,0,1]
  v_pk_fma_f32 v[18:19], v[18:19], v[156:157], v[56:57] op_sel:[1,1,0] op_sel_hi:[0,1,1] neg_lo:[0,1,0]
  v_mov_b32 v20, v18
  v_mov_b32 v21, v19
  s_nop 1
  v_permlane32_swap_b32 v18, v20
  v_permlane32_swap_b32 v19, v21
  s_nop 0
  v_pk_fma_f32 v[56:57], v[18:19], v[148:149], v[20:21] op_sel:[0,0,0] op_sel_hi:[1,0,1]
  v_pk_fma_f32 v[24:25], v[18:19], v[148:149], v[56:57] op_sel:[1,1,0] op_sel_hi:[0,1,1] neg_lo:[0,1,0]
  v_pk_fma_f32 v[56:57], v[24:25], v[150:151], v[60:61] op_sel:[0,0,0] op_sel_hi:[1,0,1]
  v_pk_fma_f32 v[18:19], v[24:25], v[150:151], v[56:57] op_sel:[1,1,0] op_sel_hi:[0,1,1] neg_lo:[0,1,0]
  v_pk_fma_f32 v[58:59], v[24:25], v[152:153], v[62:63] op_sel:[0,0,0] op_sel_hi:[1,0,1]
  v_pk_fma_f32 v[20:21], v[24:25], v[152:153], v[58:59] op_sel:[1,1,0] op_sel_hi:[0,1,1] neg_lo:[0,1,0]
  v_pk_fma_f32 v[56:57], v[18:19], v[144:145], v[160:161] op_sel:[0,0,0] op_sel_hi:[1,0,1]
  v_pk_fma_f32 v[58:59], v[20:21], v[144:145], v[192:193] op_sel:[0,0,0] op_sel_hi:[1,0,1]
  v_pk_fma_f32 v[160:161], v[18:19], v[144:145], v[56:57] op_sel:[1,1,0] op_sel_hi:[0,1,1] neg_lo:[0,1,0]
  v_pk_fma_f32 v[192:193], v[20:21], v[144:145], v[58:59] op_sel:[1,1,0] op_sel_hi:[0,1,1] neg_lo:[0,1,0]
  v_pk_fma_f32 v[56:57], v[160:161], v[144:145], v[162:163] op_sel:[0,0,0] op_sel_hi:[1,0,1]
  v_pk_fma_f32 v[58:59], v[192:193], v[144:145], v[194:195] op_sel:[0,0,0] op_sel_hi:[1,0,1]
  v_pk_fma_f32 v[162:163], v[160:161], v[144:145], v[56:57] op_sel:[1,1,0] op_sel_hi:[0,1,1] neg_lo:[0,1,0]
  v_pk_fma_f32 v[194:195], v[192:193], v[144:145], v[58:59] op_sel:[1,1,0] op_sel_hi:[0,1,1] neg_lo:[0,1,0]
  v_pk_fma_f32 v[56:57], v[162:163], v[144:145], v[164:165] op_sel:[0,0,0] op_sel_hi:[1,0,1]
  v_pk_fma_f32 v[58:59], v[194:195], v[144:145], v[196:197] op_sel:[0,0,0] op_sel_hi:[1,0,1]
  v_pk_fma_f32 v[164:165], v[162:163], v[144:145], v[56:57] op_sel:[1,1,0] op_sel_hi:[0,1,1] neg_lo:[0,1,0]
  v_pk_fma_f32 v[196:197], v[194:195], v[144:145], v[58:59] op_sel:[1,1,0] op_sel_hi:[0,1,1] neg_lo:[0,1,0]
  s_add_u32 m0, s86, 45056
  s_add_u32 s13, s94, 360448
  buffer_load_dwordx4 v1, s[68:71], s13 offen lds
  s_add_u32 m0, s86, 46080
  s_add_u32 s13, s94, 368640
  buffer_load_dwordx4 v1, s[68:71], s13 offen lds
  v_pk_fma_f32 v[56:57], v[164:165], v[144:145], v[166:167] op_sel:[0,0,0] op_sel_hi:[1,0,1]
  v_pk_fma_f32 v[58:59], v[196:197], v[144:145], v[198:199] op_sel:[0,0,0] op_sel_hi:[1,0,1]
  v_pk_fma_f32 v[166:167], v[164:165], v[144:145], v[56:57] op_sel:[1,1,0] op_sel_hi:[0,1,1] neg_lo:[0,1,0]
  v_pk_fma_f32 v[198:199], v[196:197], v[144:145], v[58:59] op_sel:[1,1,0] op_sel_hi:[0,1,1] neg_lo:[0,1,0]
  v_pk_fma_f32 v[56:57], v[166:167], v[144:145], v[168:169] op_sel:[0,0,0] op_sel_hi:[1,0,1]
  v_pk_fma_f32 v[58:59], v[198:199], v[144:145], v[200:201] op_sel:[0,0,0] op_sel_hi:[1,0,1]
  v_pk_fma_f32 v[168:169], v[166:167], v[144:145], v[56:57] op_sel:[1,1,0] op_sel_hi:[0,1,1] neg_lo:[0,1,0]
  v_pk_fma_f32 v[200:201], v[198:199], v[144:145], v[58:59] op_sel:[1,1,0] op_sel_hi:[0,1,1] neg_lo:[0,1,0]
  v_pk_fma_f32 v[56:57], v[168:169], v[144:145], v[170:171] op_sel:[0,0,0] op_sel_hi:[1,0,1]
  v_pk_fma_f32 v[58:59], v[200:201], v[144:145], v[202:203] op_sel:[0,0,0] op_sel_hi:[1,0,1]
  v_pk_fma_f32 v[170:171], v[168:169], v[144:145], v[56:57] op_sel:[1,1,0] op_sel_hi:[0,1,1] neg_lo:[0,1,0]
  v_pk_fma_f32 v[202:203], v[200:201], v[144:145], v[58:59] op_sel:[1,1,0] op_sel_hi:[0,1,1] neg_lo:[0,1,0]
  s_add_u32 m0, s86, 47104
  s_add_u32 s13, s94, 376832
  buffer_load_dwordx4 v1, s[68:71], s13 offen lds
  s_add_u32 m0, s86, 48128
  s_add_u32 s13, s94, 385024
  buffer_load_dwordx4 v1, s[68:71], s13 offen lds
  v_pk_fma_f32 v[56:57], v[170:171], v[144:145], v[172:173] op_sel:[0,0,0] op_sel_hi:[1,0,1]
  v_pk_fma_f32 v[58:59], v[202:203], v[144:145], v[204:205] op_sel:[0,0,0] op_sel_hi:[1,0,1]
  v_pk_fma_f32 v[172:173], v[170:171], v[144:145], v[56:57] op_sel:[1,1,0] op_sel_hi:[0,1,1] neg_lo:[0,1,0]
  v_pk_fma_f32 v[204:205], v[202:203], v[144:145], v[58:59] op_sel:[1,1,0] op_sel_hi:[0,1,1] neg_lo:[0,1,0]
  v_pk_fma_f32 v[56:57], v[172:173], v[144:145], v[174:175] op_sel:[0,0,0] op_sel_hi:[1,0,1]
  v_pk_fma_f32 v[58:59], v[204:205], v[144:145], v[206:207] op_sel:[0,0,0] op_sel_hi:[1,0,1]
  v_pk_fma_f32 v[174:175], v[172:173], v[144:145], v[56:57] op_sel:[1,1,0] op_sel_hi:[0,1,1] neg_lo:[0,1,0]
  v_pk_fma_f32 v[206:207], v[204:205], v[144:145], v[58:59] op_sel:[1,1,0] op_sel_hi:[0,1,1] neg_lo:[0,1,0]
  v_pk_fma_f32 v[56:57], v[174:175], v[144:145], v[176:177] op_sel:[0,0,0] op_sel_hi:[1,0,1]
  v_pk_fma_f32 v[58:59], v[206:207], v[144:145], v[208:209] op_sel:[0,0,0] op_sel_hi:[1,0,1]
  v_pk_fma_f32 v[176:177], v[174:175], v[144:145], v[56:57] op_sel:[1,1,0] op_sel_hi:[0,1,1] neg_lo:[0,1,0]
  v_pk_fma_f32 v[208:209], v[206:207], v[144:145], v[58:59] op_sel:[1,1,0] op_sel_hi:[0,1,1] neg_lo:[0,1,0]
  s_add_u32 m0, s86, 81920
  s_add_u32 s13, s94, 393216
  buffer_load_dwordx4 v1, s[68:71], s13 offen lds
  s_add_u32 m0, s86, 82944
  s_add_u32 s13, s94, 401408
  buffer_load_dwordx4 v1, s[68:71], s13 offen lds
  v_pk_fma_f32 v[56:57], v[176:177], v[144:145], v[178:179] op_sel:[0,0,0] op_sel_hi:[1,0,1]
  v_pk_fma_f32 v[58:59], v[208:209], v[144:145], v[210:211] op_sel:[0,0,0] op_sel_hi:[1,0,1]
  v_pk_fma_f32 v[178:179], v[176:177], v[144:145], v[56:57] op_sel:[1,1,0] op_sel_hi:[0,1,1] neg_lo:[0,1,0]
  v_pk_fma_f32 v[210:211], v[208:209], v[144:145], v[58:59] op_sel:[1,1,0] op_sel_hi:[0,1,1] neg_lo:[0,1,0]
  v_pk_fma_f32 v[56:57], v[178:179], v[144:145], v[180:181] op_sel:[0,0,0] op_sel_hi:[1,0,1]
  v_pk_fma_f32 v[58:59], v[210:211], v[144:145], v[212:213] op_sel:[0,0,0] op_sel_hi:[1,0,1]
  v_pk_fma_f32 v[180:181], v[178:179], v[144:145], v[56:57] op_sel:[1,1,0] op_sel_hi:[0,1,1] neg_lo:[0,1,0]
  v_pk_fma_f32 v[212:213], v[210:211], v[144:145], v[58:59] op_sel:[1,1,0] op_sel_hi:[0,1,1] neg_lo:[0,1,0]
  v_pk_fma_f32 v[56:57], v[180:181], v[144:145], v[182:183] op_sel:[0,0,0] op_sel_hi:[1,0,1]
  v_pk_fma_f32 v[58:59], v[212:213], v[144:145], v[214:215] op_sel:[0,0,0] op_sel_hi:[1,0,1]
  v_pk_fma_f32 v[182:183], v[180:181], v[144:145], v[56:57] op_sel:[1,1,0] op_sel_hi:[0,1,1] neg_lo:[0,1,0]
  v_pk_fma_f32 v[214:215], v[212:213], v[144:145], v[58:59] op_sel:[1,1,0] op_sel_hi:[0,1,1] neg_lo:[0,1,0]
  s_add_u32 m0, s86, 83968
  s_add_u32 s13, s94, 409600
  buffer_load_dwordx4 v1, s[68:71], s13 offen lds
  s_add_u32 m0, s86, 84992
  s_add_u32 s13, s94, 417792
  buffer_load_dwordx4 v1, s[68:71], s13 offen lds
  v_pk_fma_f32 v[56:57], v[182:183], v[144:145], v[184:185] op_sel:[0,0,0] op_sel_hi:[1,0,1]
  v_pk_fma_f32 v[58:59], v[214:215], v[144:145], v[216:217] op_sel:[0,0,0] op_sel_hi:[1,0,1]
  v_pk_fma_f32 v[184:185], v[182:183], v[144:145], v[56:57] op_sel:[1,1,0] op_sel_hi:[0,1,1] neg_lo:[0,1,0]
  v_pk_fma_f32 v[216:217], v[214:215], v[144:145], v[58:59] op_sel:[1,1,0] op_sel_hi:[0,1,1] neg_lo:[0,1,0]
  v_pk_fma_f32 v[56:57], v[184:185], v[144:145], v[186:187] op_sel:[0,0,0] op_sel_hi:[1,0,1]
  v_pk_fma_f32 v[58:59], v[216:217], v[144:145], v[218:219] op_sel:[0,0,0] op_sel_hi:[1,0,1]
  v_pk_fma_f32 v[186:187], v[184:185], v[144:145], v[56:57] op_sel:[1,1,0] op_sel_hi:[0,1,1] neg_lo:[0,1,0]
  v_pk_fma_f32 v[218:219], v[216:217], v[144:145], v[58:59] op_sel:[1,1,0] op_sel_hi:[0,1,1] neg_lo:[0,1,0]
  v_pk_fma_f32 v[56:57], v[186:187], v[144:145], v[188:189] op_sel:[0,0,0] op_sel_hi:[1,0,1]
  v_pk_fma_f32 v[58:59], v[218:219], v[144:145], v[220:221] op_sel:[0,0,0] op_sel_hi:[1,0,1]
  v_pk_fma_f32 v[188:189], v[186:187], v[144:145], v[56:57] op_sel:[1,1,0] op_sel_hi:[0,1,1] neg_lo:[0,1,0]
  v_pk_fma_f32 v[220:221], v[218:219], v[144:145], v[58:59] op_sel:[1,1,0] op_sel_hi:[0,1,1] neg_lo:[0,1,0]
  s_add_u32 m0, s86, 86016
  s_add_u32 s13, s94, 425984
  buffer_load_dwordx4 v1, s[68:71], s13 offen lds
  s_add_u32 m0, s86, 87040
  s_add_u32 s13, s94, 434176
  buffer_load_dwordx4 v1, s[68:71], s13 offen lds
  v_pk_fma_f32 v[56:57], v[188:189], v[144:145], v[190:191] op_sel:[0,0,0] op_sel_hi:[1,0,1]
  v_pk_fma_f32 v[58:59], v[220:221], v[144:145], v[222:223] op_sel:[0,0,0] op_sel_hi:[1,0,1]
  v_pk_fma_f32 v[190:191], v[188:189], v[144:145], v[56:57] op_sel:[1,1,0] op_sel_hi:[0,1,1] neg_lo:[0,1,0]
  v_pk_fma_f32 v[222:223], v[220:221], v[144:145], v[58:59] op_sel:[1,1,0] op_sel_hi:[0,1,1] neg_lo:[0,1,0]
  v_pk_mul_f32 v[56:57], v[160:161], v[154:155] op_sel:[0,0] op_sel_hi:[1,0] neg_hi:[1,0]
  v_pk_mul_f32 v[58:59], v[192:193], v[154:155] op_sel:[0,0] op_sel_hi:[1,0] neg_hi:[1,0]
  v_pk_fma_f32 v[160:161], v[160:161], v[154:155], v[56:57] op_sel:[1,1,0] op_sel_hi:[0,1,1] neg_lo:[0,1,0] neg_hi:[0,1,0]
  v_pk_fma_f32 v[192:193], v[192:193], v[154:155], v[58:59] op_sel:[1,1,0] op_sel_hi:[0,1,1] neg_lo:[0,1,0] neg_hi:[0,1,0]
  v_pk_mul_f32 v[56:57], v[162:163], v[154:155] op_sel:[0,0] op_sel_hi:[1,0] neg_hi:[1,0]
  v_pk_mul_f32 v[58:59], v[194:195], v[154:155] op_sel:[0,0] op_sel_hi:[1,0] neg_hi:[1,0]
  v_pk_fma_f32 v[162:163], v[162:163], v[154:155], v[56:57] op_sel:[1,1,0] op_sel_hi:[0,1,1] neg_lo:[0,1,0] neg_hi:[0,1,0]
  v_pk_fma_f32 v[194:195], v[194:195], v[154:155], v[58:59] op_sel:[1,1,0] op_sel_hi:[0,1,1] neg_lo:[0,1,0] neg_hi:[0,1,0]
  v_pk_mul_f32 v[56:57], v[164:165], v[154:155] op_sel:[0,0] op_sel_hi:[1,0] neg_hi:[1,0]
  v_pk_mul_f32 v[58:59], v[196:197], v[154:155] op_sel:[0,0] op_sel_hi:[1,0] neg_hi:[1,0]
  v_pk_fma_f32 v[164:165], v[164:165], v[154:155], v[56:57] op_sel:[1,1,0] op_sel_hi:[0,1,1] neg_lo:[0,1,0] neg_hi:[0,1,0]
  v_pk_fma_f32 v[196:197], v[196:197], v[154:155], v[58:59] op_sel:[1,1,0] op_sel_hi:[0,1,1] neg_lo:[0,1,0] neg_hi:[0,1,0]
  s_add_u32 m0, s86, 88064
  s_add_u32 s13, s94, 442368
  buffer_load_dwordx4 v1, s[68:71], s13 offen lds
  s_add_u32 m0, s86, 89088
  s_add_u32 s13, s94, 450560
  buffer_load_dwordx4 v1, s[68:71], s13 offen lds
  v_pk_mul_f32 v[56:57], v[166:167], v[154:155] op_sel:[0,0] op_sel_hi:[1,0] neg_hi:[1,0]
  v_pk_mul_f32 v[58:59], v[198:199], v[154:155] op_sel:[0,0] op_sel_hi:[1,0] neg_hi:[1,0]
  v_pk_fma_f32 v[166:167], v[166:167], v[154:155], v[56:57] op_sel:[1,1,0] op_sel_hi:[0,1,1] neg_lo:[0,1,0] neg_hi:[0,1,0]
  v_pk_fma_f32 v[198:199], v[198:199], v[154:155], v[58:59] op_sel:[1,1,0] op_sel_hi:[0,1,1] neg_lo:[0,1,0] neg_hi:[0,1,0]
  v_pk_mul_f32 v[56:57], v[168:169], v[154:155] op_sel:[0,0] op_sel_hi:[1,0] neg_hi:[1,0]
  v_pk_mul_f32 v[58:59], v[200:201], v[154:155] op_sel:[0,0] op_sel_hi:[1,0] neg_hi:[1,0]
  v_pk_fma_f32 v[168:169], v[168:169], v[154:155], v[56:57] op_sel:[1,1,0] op_sel_hi:[0,1,1] neg_lo:[0,1,0] neg_hi:[0,1,0]
  v_pk_fma_f32 v[200:201], v[200:201], v[154:155], v[58:59] op_sel:[1,1,0] op_sel_hi:[0,1,1] neg_lo:[0,1,0] neg_hi:[0,1,0]
  v_pk_mul_f32 v[56:57], v[170:171], v[154:155] op_sel:[0,0] op_sel_hi:[1,0] neg_hi:[1,0]
  v_pk_mul_f32 v[58:59], v[202:203], v[154:155] op_sel:[0,0] op_sel_hi:[1,0] neg_hi:[1,0]
  v_pk_fma_f32 v[170:171], v[170:171], v[154:155], v[56:57] op_sel:[1,1,0] op_sel_hi:[0,1,1] neg_lo:[0,1,0] neg_hi:[0,1,0]
  v_pk_fma_f32 v[202:203], v[202:203], v[154:155], v[58:59] op_sel:[1,1,0] op_sel_hi:[0,1,1] neg_lo:[0,1,0] neg_hi:[0,1,0]
  s_add_u32 m0, s86, 122880
  s_mov_b32 s13, 0
  buffer_load_dwordx4 v2, s[72:75], s13 offen lds
  s_add_u32 m0, s86, 123904
  s_mov_b32 s13, 8192
  buffer_load_dwordx4 v3, s[72:75], s13 offen lds
  v_pk_mul_f32 v[56:57], v[172:173], v[154:155] op_sel:[0,0] op_sel_hi:[1,0] neg_hi:[1,0]
  v_pk_mul_f32 v[58:59], v[204:205], v[154:155] op_sel:[0,0] op_sel_hi:[1,0] neg_hi:[1,0]
  v_pk_fma_f32 v[172:173], v[172:173], v[154:155], v[56:57] op_sel:[1,1,0] op_sel_hi:[0,1,1] neg_lo:[0,1,0] neg_hi:[0,1,0]
  v_pk_fma_f32 v[204:205], v[204:205], v[154:155], v[58:59] op_sel:[1,1,0] op_sel_hi:[0,1,1] neg_lo:[0,1,0] neg_hi:[0,1,0]
  v_pk_mul_f32 v[56:57], v[174:175], v[154:155] op_sel:[0,0] op_sel_hi:[1,0] neg_hi:[1,0]
  v_pk_mul_f32 v[58:59], v[206:207], v[154:155] op_sel:[0,0] op_sel_hi:[1,0] neg_hi:[1,0]
  v_pk_fma_f32 v[174:175], v[174:175], v[154:155], v[56:57] op_sel:[1,1,0] op_sel_hi:[0,1,1] neg_lo:[0,1,0] neg_hi:[0,1,0]
  v_pk_fma_f32 v[206:207], v[206:207], v[154:155], v[58:59] op_sel:[1,1,0] op_sel_hi:[0,1,1] neg_lo:[0,1,0] neg_hi:[0,1,0]
  v_pk_mul_f32 v[56:57], v[176:177], v[154:155] op_sel:[0,0] op_sel_hi:[1,0] neg_hi:[1,0]
  v_pk_mul_f32 v[58:59], v[208:209], v[154:155] op_sel:[0,0] op_sel_hi:[1,0] neg_hi:[1,0]
  v_pk_fma_f32 v[176:177], v[176:177], v[154:155], v[56:57] op_sel:[1,1,0] op_sel_hi:[0,1,1] neg_lo:[0,1,0] neg_hi:[0,1,0]
  v_pk_fma_f32 v[208:209], v[208:209], v[154:155], v[58:59] op_sel:[1,1,0] op_sel_hi:[0,1,1] neg_lo:[0,1,0] neg_hi:[0,1,0]
  s_add_u32 m0, s86, 124928
  s_mov_b32 s13, 16384
  buffer_load_dwordx4 v2, s[72:75], s13 offen lds
  s_add_u32 m0, s86, 125952
  s_mov_b32 s13, 24576
  buffer_load_dwordx4 v3, s[72:75], s13 offen lds
  v_pk_mul_f32 v[56:57], v[178:179], v[154:155] op_sel:[0,0] op_sel_hi:[1,0] neg_hi:[1,0]
  v_pk_mul_f32 v[58:59], v[210:211], v[154:155] op_sel:[0,0] op_sel_hi:[1,0] neg_hi:[1,0]
  v_pk_fma_f32 v[178:179], v[178:179], v[154:155], v[56:57] op_sel:[1,1,0] op_sel_hi:[0,1,1] neg_lo:[0,1,0] neg_hi:[0,1,0]
  v_pk_fma_f32 v[210:211], v[210:211], v[154:155], v[58:59] op_sel:[1,1,0] op_sel_hi:[0,1,1] neg_lo:[0,1,0] neg_hi:[0,1,0]
  v_pk_mul_f32 v[56:57], v[180:181], v[154:155] op_sel:[0,0] op_sel_hi:[1,0] neg_hi:[1,0]
  v_pk_mul_f32 v[58:59], v[212:213], v[154:155] op_sel:[0,0] op_sel_hi:[1,0] neg_hi:[1,0]
  v_pk_fma_f32 v[180:181], v[180:181], v[154:155], v[56:57] op_sel:[1,1,0] op_sel_hi:[0,1,1] neg_lo:[0,1,0] neg_hi:[0,1,0]
  v_pk_fma_f32 v[212:213], v[212:213], v[154:155], v[58:59] op_sel:[1,1,0] op_sel_hi:[0,1,1] neg_lo:[0,1,0] neg_hi:[0,1,0]
  v_pk_mul_f32 v[56:57], v[182:183], v[154:155] op_sel:[0,0] op_sel_hi:[1,0] neg_hi:[1,0]
  v_pk_mul_f32 v[58:59], v[214:215], v[154:155] op_sel:[0,0] op_sel_hi:[1,0] neg_hi:[1,0]
  v_pk_fma_f32 v[182:183], v[182:183], v[154:155], v[56:57] op_sel:[1,1,0] op_sel_hi:[0,1,1] neg_lo:[0,1,0] neg_hi:[0,1,0]
  v_pk_fma_f32 v[214:215], v[214:215], v[154:155], v[58:59] op_sel:[1,1,0] op_sel_hi:[0,1,1] neg_lo:[0,1,0] neg_hi:[0,1,0]
  s_add_u32 m0, s86, 126976
  s_mov_b32 s13, 32768
  buffer_load_dwordx4 v2, s[72:75], s13 offen lds
  s_add_u32 m0, s86, 128000
  s_mov_b32 s13, 40960
  buffer_load_dwordx4 v3, s[72:75], s13 offen lds
  v_pk_mul_f32 v[56:57], v[184:185], v[154:155] op_sel:[0,0] op_sel_hi:[1,0] neg_hi:[1,0]
  v_pk_mul_f32 v[58:59], v[216:217], v[154:155] op_sel:[0,0] op_sel_hi:[1,0] neg_hi:[1,0]
  v_pk_fma_f32 v[184:185], v[184:185], v[154:155], v[56:57] op_sel:[1,1,0] op_sel_hi:[0,1,1] neg_lo:[0,1,0] neg_hi:[0,1,0]
  v_pk_fma_f32 v[216:217], v[216:217], v[154:155], v[58:59] op_sel:[1,1,0] op_sel_hi:[0,1,1] neg_lo:[0,1,0] neg_hi:[0,1,0]
  v_pk_mul_f32 v[56:57], v[186:187], v[154:155] op_sel:[0,0] op_sel_hi:[1,0] neg_hi:[1,0]
  v_pk_mul_f32 v[58:59], v[218:219], v[154:155] op_sel:[0,0] op_sel_hi:[1,0] neg_hi:[1,0]
  v_pk_fma_f32 v[186:187], v[186:187], v[154:155], v[56:57] op_sel:[1,1,0] op_sel_hi:[0,1,1] neg_lo:[0,1,0] neg_hi:[0,1,0]
  v_pk_fma_f32 v[218:219], v[218:219], v[154:155], v[58:59] op_sel:[1,1,0] op_sel_hi:[0,1,1] neg_lo:[0,1,0] neg_hi:[0,1,0]
  v_pk_mul_f32 v[56:57], v[188:189], v[154:155] op_sel:[0,0] op_sel_hi:[1,0] neg_hi:[1,0]
  v_pk_mul_f32 v[58:59], v[220:221], v[154:155] op_sel:[0,0] op_sel_hi:[1,0] neg_hi:[1,0]
  v_pk_fma_f32 v[188:189], v[188:189], v[154:155], v[56:57] op_sel:[1,1,0] op_sel_hi:[0,1,1] neg_lo:[0,1,0] neg_hi:[0,1,0]
  v_pk_fma_f32 v[220:221], v[220:221], v[154:155], v[58:59] op_sel:[1,1,0] op_sel_hi:[0,1,1] neg_lo:[0,1,0] neg_hi:[0,1,0]
  s_add_u32 m0, s86, 129024
  s_mov_b32 s13, 49152
  buffer_load_dwordx4 v2, s[72:75], s13 offen lds
  s_add_u32 m0, s86, 130048
  s_mov_b32 s13, 57344
  buffer_load_dwordx4 v3, s[72:75], s13 offen lds
  v_pk_mul_f32 v[56:57], v[190:191], v[154:155] op_sel:[0,0] op_sel_hi:[1,0] neg_hi:[1,0]
  v_pk_mul_f32 v[58:59], v[222:223], v[154:155] op_sel:[0,0] op_sel_hi:[1,0] neg_hi:[1,0]
  v_pk_fma_f32 v[190:191], v[190:191], v[154:155], v[56:57] op_sel:[1,1,0] op_sel_hi:[0,1,1] neg_lo:[0,1,0] neg_hi:[0,1,0]
  v_pk_fma_f32 v[222:223], v[222:223], v[154:155], v[58:59] op_sel:[1,1,0] op_sel_hi:[0,1,1] neg_lo:[0,1,0] neg_hi:[0,1,0]
  v_cvt_pk_bf16_f32 v64, v160, v162
  v_cvt_pk_bf16_f32 v72, v161, v163
  v_cvt_pk_bf16_f32 v65, v164, v166
  v_cvt_pk_bf16_f32 v73, v165, v167
  v_cvt_pk_bf16_f32 v66, v168, v170
  v_cvt_pk_bf16_f32 v74, v169, v171
  v_cvt_pk_bf16_f32 v67, v172, v174
  v_cvt_pk_bf16_f32 v75, v173, v175
  v_cvt_pk_bf16_f32 v68, v176, v178
  v_cvt_pk_bf16_f32 v76, v177, v179
  v_cvt_pk_bf16_f32 v69, v180, v182
  v_cvt_pk_bf16_f32 v77, v181, v183
  v_cvt_pk_bf16_f32 v70, v184, v186
  v_cvt_pk_bf16_f32 v78, v185, v187
  v_cvt_pk_bf16_f32 v71, v188, v190
  v_cvt_pk_bf16_f32 v79, v189, v191
  v_cvt_pk_bf16_f32 v80, v192, v194
  v_cvt_pk_bf16_f32 v88, v193, v195
  v_cvt_pk_bf16_f32 v81, v196, v198
  v_cvt_pk_bf16_f32 v89, v197, v199
  v_cvt_pk_bf16_f32 v82, v200, v202
  v_cvt_pk_bf16_f32 v90, v201, v203
  v_cvt_pk_bf16_f32 v83, v204, v206
  v_cvt_pk_bf16_f32 v91, v205, v207
  v_cvt_pk_bf16_f32 v84, v208, v210
  v_cvt_pk_bf16_f32 v92, v209, v211
  v_cvt_pk_bf16_f32 v85, v212, v214
  v_cvt_pk_bf16_f32 v93, v213, v215
  v_cvt_pk_bf16_f32 v86, v216, v218
  v_cvt_pk_bf16_f32 v94, v217, v219
  v_cvt_pk_bf16_f32 v87, v220, v222
  v_cvt_pk_bf16_f32 v95, v221, v223
  s_add_u32 s10, s6, 1
  s_mul_i32 s10, s10, 40960
  s_add_u32 s10, s10, 32768
  v_and_b32 v13, 31, v0
  v_mul_u32_u24 v13, 72, v13
  v_lshrrev_b32 v14, 5, v0
  v_lshl_add_u32 v13, v14, 3, v13
  v_add_u32 v24, s10, v13
  v_lshrrev_b32 v13, 4, v0
  v_bfe_u32 v14, v0, 2, 2
  v_and_b32 v15, 3, v0
  v_lshrrev_b32 v25, 1, v13
  v_lshl_add_u32 v25, v25, 3, v14
  v_mul_u32_u24 v25, 72, v25
  v_and_b32 v13, 1, v13
  v_lshl_add_u32 v25, v13, 5, v25
  v_lshl_add_u32 v25, v15, 3, v25
  v_add_u32 v25, s10, v25
  s_and_b32 s10, s5, 3
  s_lshl_b32 s10, s10, 11
  ds_write_b64 v24, v[64:65] offset:0
  ds_write_b64 v24, v[72:73] offset:2304
  ds_write_b64 v24, v[66:67] offset:16
  ds_write_b64 v24, v[74:75] offset:2320
  ds_write_b64 v24, v[68:69] offset:32
  ds_write_b64 v24, v[76:77] offset:2336
  ds_write_b64 v24, v[70:71] offset:48
  ds_write_b64 v24, v[78:79] offset:2352
  s_waitcnt lgkmcnt(0)
  ds_read_b64_tr_b16 v[96:97], v25 offset:0
  ds_read_b64_tr_b16 v[98:99], v25 offset:288
  ds_read_b64_tr_b16 v[100:101], v25 offset:1152
  ds_read_b64_tr_b16 v[102:103], v25 offset:1440
  ds_read_b64_tr_b16 v[104:105], v25 offset:2304
  ds_read_b64_tr_b16 v[106:107], v25 offset:2592
  ds_read_b64_tr_b16 v[108:109], v25 offset:3456
  ds_read_b64_tr_b16 v[110:111], v25 offset:3744
  s_waitcnt lgkmcnt(0)
  s_add_u32 s11, s97, s10
  s_add_u32 s13, s11, 28672
  buffer_store_dwordx4 v[96:99], v10, s[64:67], s13 offen sc1
  s_add_u32 s13, s11, 29696
  buffer_store_dwordx4 v[100:103], v10, s[64:67], s13 offen sc1
  s_add_u32 s13, s11, 36864
  buffer_store_dwordx4 v[104:107], v10, s[64:67], s13 offen sc1
  s_add_u32 s13, s11, 37888
  buffer_store_dwordx4 v[108:111], v10, s[64:67], s13 offen sc1
  s_nop 1
  ds_write_b64 v24, v[80:81] offset:0
  ds_write_b64 v24, v[88:89] offset:2304
  ds_write_b64 v24, v[82:83] offset:16
  ds_write_b64 v24, v[90:91] offset:2320
  ds_write_b64 v24, v[84:85] offset:32
  ds_write_b64 v24, v[92:93] offset:2336
  ds_write_b64 v24, v[86:87] offset:48
  ds_write_b64 v24, v[94:95] offset:2352
  s_waitcnt lgkmcnt(0)
  ds_read_b64_tr_b16 v[96:97], v25 offset:0
  ds_read_b64_tr_b16 v[98:99], v25 offset:288
  ds_read_b64_tr_b16 v[100:101], v25 offset:1152
  ds_read_b64_tr_b16 v[102:103], v25 offset:1440
  ds_read_b64_tr_b16 v[104:105], v25 offset:2304
  ds_read_b64_tr_b16 v[106:107], v25 offset:2592
  ds_read_b64_tr_b16 v[108:109], v25 offset:3456
  ds_read_b64_tr_b16 v[110:111], v25 offset:3744
  s_waitcnt lgkmcnt(0)
  s_add_u32 s11, s98, s10
  s_add_u32 s13, s11, 28672
  buffer_store_dwordx4 v[96:99], v10, s[64:67], s13 offen sc1
  s_add_u32 s13, s11, 29696
  buffer_store_dwordx4 v[100:103], v10, s[64:67], s13 offen sc1
  s_add_u32 s13, s11, 36864
  buffer_store_dwordx4 v[104:107], v10, s[64:67], s13 offen sc1
  s_add_u32 s13, s11, 37888
  buffer_store_dwordx4 v[108:111], v10, s[64:67], s13 offen sc1
  s_nop 1
  s_mov_b32 s52, s16
  s_and_b32 s53, s17, 0xffff
  s_mov_b32 s54, 2097152
  s_mov_b32 s55, 0x20000
  s_mov_b32 s80, s44
  s_and_b32 s81, s45, 0xffff
  s_mov_b32 s82, 4194304
  s_mov_b32 s83, 0x20000
  s_lshl_b32 s10, s95, 6
  s_lshl_b32 s11, s6, 5
  s_add_u32 s10, s10, s11
  v_and_b32 v13, 31, v0
  v_add_u32 v13, s10, v13
  v_lshrrev_b32 v14, 5, v0
  v_lshlrev_b32 v15, 1, v13
  v_lshl_add_u32 v16, v14, 14, v15
  v_lshlrev_b32 v17, 2, v13
  v_lshl_add_u32 v17, v14, 15, v17
  s_lshl_b32 s10, s4, 7
  s_lshl_b32 s11, s96, 6
  s_add_u32 s10, s10, s11
  s_lshr_b32 s11, s3, 1
  s_lshl_b32 s11, s11, 5
  s_add_u32 s12, s10, s11
  global_load_ushort v18, v15, s[42:43]
  global_load_ushort v19, v15, s[32:33]
  s_lshl_b32 s10, s12, 10
  s_add_u32 s13, s10, 0
  buffer_load_ushort v144, v16, s[52:55], s13 offen
  s_add_u32 s13, s10, 1024
  buffer_load_ushort v145, v16, s[52:55], s13 offen
  s_add_u32 s13, s10, 2048
  buffer_load_ushort v146, v16, s[52:55], s13 offen
  s_add_u32 s13, s10, 3072
  buffer_load_ushort v147, v16, s[52:55], s13 offen
  s_add_u32 s13, s10, 4096
  buffer_load_ushort v148, v16, s[52:55], s13 offen
  s_add_u32 s13, s10, 5120
  buffer_load_ushort v149, v16, s[52:55], s13 offen
  s_add_u32 s13, s10, 6144
  buffer_load_ushort v150, v16, s[52:55], s13 offen
  s_add_u32 s13, s10, 7168
  buffer_load_ushort v151, v16, s[52:55], s13 offen
  s_add_u32 s13, s10, 8192
  buffer_load_ushort v152, v16, s[52:55], s13 offen
  s_add_u32 s13, s10, 9216
  buffer_load_ushort v153, v16, s[52:55], s13 offen
  s_add_u32 s13, s10, 10240
  buffer_load_ushort v154, v16, s[52:55], s13 offen
  s_add_u32 s13, s10, 11264
  buffer_load_ushort v155, v16, s[52:55], s13 offen
  s_add_u32 s13, s10, 12288
  buffer_load_ushort v156, v16, s[52:55], s13 offen
  s_add_u32 s13, s10, 13312
  buffer_load_ushort v157, v16, s[52:55], s13 offen
  s_add_u32 s13, s10, 14336
  buffer_load_ushort v158, v16, s[52:55], s13 offen
  s_add_u32 s13, s10, 15360
  buffer_load_ushort v159, v16, s[52:55], s13 offen
  s_lshl_b32 s10, s96, 6
  s_lshr_b32 s11, s3, 1
  s_lshl_b32 s11, s11, 5
  s_add_u32 s10, s10, s11
  s_lshl_b32 s10, s10, 2
  v_lshlrev_b32 v20, 6, v14
  v_add_u32 v20, s10, v20
  ds_read_b128 v[24:27], v20 offset:34304
  ds_read_b128 v[40:43], v20 offset:35328
  ds_read_b128 v[28:31], v20 offset:34320
  ds_read_b128 v[44:47], v20 offset:35344
  ds_read_b128 v[32:35], v20 offset:34336
  ds_read_b128 v[48:51], v20 offset:35360
  ds_read_b128 v[36:39], v20 offset:34352
  ds_read_b128 v[52:55], v20 offset:35376
  s_waitcnt vmcnt(18)
  s_lshl_b32 s10, s4, 1
  s_add_u32 s10, s10, s6
  s_lshl_b32 s10, s10, 2
  s_lshr_b32 s11, s5, 2
  s_add_u32 s10, s10, s11
  s_lshl_b32 s10, s10, 7
  s_and_b32 s11, s5, 3
  s_lshl_b32 s11, s11, 4
  s_add_u32 s10, s10, s11
  s_add_u32 s10, s10, 655360
  v_mov_b32 v13, 0
  v_mov_b32 v14, s8
  s_mov_b32 exec_lo, 0x1
  s_mov_b32 exec_hi, 0x0
  buffer_store_dword v14, v13, s[64:67], s10 offen sc1
  s_mov_b64 exec, -1
  s_waitcnt vmcnt(52)
  v_add_u32 v11, 0, v4
  v_add_u32 v12, 0, v5
  ds_read_b64_tr_b16 a[128:129], v11 offset:0
  ds_read_b64_tr_b16 a[130:131], v11 offset:1024
  ds_read_b64_tr_b16 a[132:133], v12 offset:0
  ds_read_b64_tr_b16 a[134:135], v12 offset:1024
  ds_read_b64_tr_b16 a[136:137], v11 offset:2048
  ds_read_b64_tr_b16 a[138:139], v11 offset:3072
  ds_read_b64_tr_b16 a[140:141], v12 offset:2048
  ds_read_b64_tr_b16 a[142:143], v12 offset:3072
  ds_read_b64_tr_b16 a[144:145], v11 offset:4096
  ds_read_b64_tr_b16 a[146:147], v11 offset:5120
  ds_read_b64_tr_b16 a[148:149], v12 offset:4096
  ds_read_b64_tr_b16 a[150:151], v12 offset:5120
  ds_read_b64_tr_b16 a[152:153], v11 offset:6144
  ds_read_b64_tr_b16 a[154:155], v11 offset:7168
  ds_read_b64_tr_b16 a[156:157], v12 offset:6144
  ds_read_b64_tr_b16 a[158:159], v12 offset:7168
  s_waitcnt vmcnt(43)
  v_add_u32 v11, 40960, v4
  v_add_u32 v12, 40960, v5
  ds_read_b64_tr_b16 a[160:161], v11 offset:0
  ds_read_b64_tr_b16 a[162:163], v11 offset:1024
  ds_read_b64_tr_b16 a[164:165], v12 offset:0
  ds_read_b64_tr_b16 a[166:167], v12 offset:1024
  ds_read_b64_tr_b16 a[168:169], v11 offset:2048
  ds_read_b64_tr_b16 a[170:171], v11 offset:3072
  ds_read_b64_tr_b16 a[172:173], v12 offset:2048
  ds_read_b64_tr_b16 a[174:175], v12 offset:3072
  ds_read_b64_tr_b16 a[176:177], v11 offset:4096
  ds_read_b64_tr_b16 a[178:179], v11 offset:5120
  ds_read_b64_tr_b16 a[180:181], v12 offset:4096
  ds_read_b64_tr_b16 a[182:183], v12 offset:5120
  ds_read_b64_tr_b16 a[184:185], v11 offset:6144
  ds_read_b64_tr_b16 a[186:187], v11 offset:7168
  ds_read_b64_tr_b16 a[188:189], v12 offset:6144
  ds_read_b64_tr_b16 a[190:191], v12 offset:7168
  s_waitcnt vmcnt(35)
  v_add_u32 v11, 81920, v4
  v_add_u32 v12, 81920, v5
  ds_read_b64_tr_b16 a[192:193], v11 offset:0
  ds_read_b64_tr_b16 a[194:195], v11 offset:1024
  ds_read_b64_tr_b16 a[196:197], v12 offset:0
  ds_read_b64_tr_b16 a[198:199], v12 offset:1024
  ds_read_b64_tr_b16 a[200:201], v11 offset:2048
  ds_read_b64_tr_b16 a[202:203], v11 offset:3072
  ds_read_b64_tr_b16 a[204:205], v12 offset:2048
  ds_read_b64_tr_b16 a[206:207], v12 offset:3072
  ds_read_b64_tr_b16 a[208:209], v11 offset:4096
  ds_read_b64_tr_b16 a[210:211], v11 offset:5120
  ds_read_b64_tr_b16 a[212:213], v12 offset:4096
  ds_read_b64_tr_b16 a[214:215], v12 offset:5120
  ds_read_b64_tr_b16 a[216:217], v11 offset:6144
  ds_read_b64_tr_b16 a[218:219], v11 offset:7168
  ds_read_b64_tr_b16 a[220:221], v12 offset:6144
  ds_read_b64_tr_b16 a[222:223], v12 offset:7168
  s_waitcnt vmcnt(27)
  v_add_u32 v11, 122880, v6
  v_xor_b32 v12, 4096, v11
  ds_read_b128 a[224:227], v11
  ds_read_b128 a[228:231], v12
  v_add_u32 v11, 122880, v7
  v_xor_b32 v12, 4096, v11
  ds_read_b128 a[232:235], v11
  ds_read_b128 a[236:239], v12
  v_add_u32 v11, 122880, v8
  v_xor_b32 v12, 4096, v11
  ds_read_b128 a[240:243], v11
  ds_read_b128 a[244:247], v12
  v_add_u32 v11, 122880, v9
  v_xor_b32 v12, 4096, v11
  ds_read_b128 a[248:251], v11
  ds_read_b128 a[252:255], v12
  s_waitcnt lgkmcnt(0)
  s_add_u32 m0, s86, 0
  s_mov_b32 s13, 128
  buffer_load_dwordx4 v2, s[72:75], s13 offen lds
  s_add_u32 m0, s86, 1024
  s_mov_b32 s13, 8320
  buffer_load_dwordx4 v3, s[72:75], s13 offen lds
  s_add_u32 m0, s86, 2048
  s_mov_b32 s13, 16512
  buffer_load_dwordx4 v2, s[72:75], s13 offen lds
  s_add_u32 m0, s86, 3072
  s_mov_b32 s13, 24704
  buffer_load_dwordx4 v3, s[72:75], s13 offen lds
  s_add_u32 m0, s86, 4096
  s_mov_b32 s13, 32896
  buffer_load_dwordx4 v2, s[72:75], s13 offen lds
  s_add_u32 m0, s86, 5120
  s_mov_b32 s13, 41088
  buffer_load_dwordx4 v3, s[72:75], s13 offen lds
  s_add_u32 m0, s86, 6144
  s_mov_b32 s13, 49280
  buffer_load_dwordx4 v2, s[72:75], s13 offen lds
  s_add_u32 m0, s86, 7168
  s_mov_b32 s13, 57472
  buffer_load_dwordx4 v3, s[72:75], s13 offen lds
  s_add_u32 m0, s86, 40960
  s_mov_b32 s13, 0
  buffer_load_dwordx4 v2, s[76:79], s13 offen lds
  s_add_u32 m0, s86, 41984
  s_mov_b32 s13, 8192
  buffer_load_dwordx4 v3, s[76:79], s13 offen lds
  s_add_u32 m0, s86, 43008
  s_mov_b32 s13, 16384
  buffer_load_dwordx4 v2, s[76:79], s13 offen lds
  s_add_u32 m0, s86, 44032
  s_mov_b32 s13, 24576
  buffer_load_dwordx4 v3, s[76:79], s13 offen lds
  s_add_u32 m0, s86, 45056
  s_mov_b32 s13, 32768
  buffer_load_dwordx4 v2, s[76:79], s13 offen lds
  s_add_u32 m0, s86, 46080
  s_mov_b32 s13, 40960
  buffer_load_dwordx4 v3, s[76:79], s13 offen lds
  s_add_u32 m0, s86, 47104
  s_mov_b32 s13, 49152
  buffer_load_dwordx4 v2, s[76:79], s13 offen lds
  s_add_u32 m0, s86, 48128
  s_mov_b32 s13, 57344
  buffer_load_dwordx4 v3, s[76:79], s13 offen lds
  s_add_u32 m0, s86, 81920
  s_mov_b32 s13, 128
  buffer_load_dwordx4 v2, s[76:79], s13 offen lds
  s_add_u32 m0, s86, 82944
  s_mov_b32 s13, 8320
  buffer_load_dwordx4 v3, s[76:79], s13 offen lds
  s_add_u32 m0, s86, 83968
  s_mov_b32 s13, 16512
  buffer_load_dwordx4 v2, s[76:79], s13 offen lds
  s_add_u32 m0, s86, 84992
  s_mov_b32 s13, 24704
  buffer_load_dwordx4 v3, s[76:79], s13 offen lds
  s_add_u32 m0, s86, 86016
  s_mov_b32 s13, 32896
  buffer_load_dwordx4 v2, s[76:79], s13 offen lds
  s_add_u32 m0, s86, 87040
  s_mov_b32 s13, 41088
  buffer_load_dwordx4 v3, s[76:79], s13 offen lds
  s_add_u32 m0, s86, 88064
  s_mov_b32 s13, 49280
  buffer_load_dwordx4 v2, s[76:79], s13 offen lds
  s_add_u32 m0, s86, 89088
  s_mov_b32 s13, 57472
  buffer_load_dwordx4 v3, s[76:79], s13 offen lds
  s_waitcnt vmcnt(25)
  s_waitcnt lgkmcnt(0)
  v_lshlrev_b32 v18, 16, v18
  v_lshlrev_b32 v19, 16, v19
  v_lshlrev_b32 v144, 16, v144
  v_lshlrev_b32 v145, 16, v145
  v_lshlrev_b32 v146, 16, v146
  v_lshlrev_b32 v147, 16, v147
  v_sub_f32 v128, v144, v40
  v_sub_f32 v129, v145, v41
  v_sub_f32 v130, v146, v42
  v_sub_f32 v131, v147, v43
  v_cvt_pk_bf16_f32 v128, v128, v128
  v_cvt_pk_bf16_f32 v129, v129, v129
  v_cvt_pk_bf16_f32 v130, v130, v130
  v_cvt_pk_bf16_f32 v131, v131, v131
  v_lshlrev_b32 v128, 16, v128
  v_lshlrev_b32 v129, 16, v129
  v_lshlrev_b32 v130, 16, v130
  v_lshlrev_b32 v131, 16, v131
  v_mul_f32 v128, v128, v24
  v_mul_f32 v129, v129, v25
  v_mul_f32 v130, v130, v26
  v_mul_f32 v131, v131, v27
  v_cvt_pk_bf16_f32 v128, v128, v128
  v_cvt_pk_bf16_f32 v129, v129, v129
  v_cvt_pk_bf16_f32 v130, v130, v130
  v_cvt_pk_bf16_f32 v131, v131, v131
  v_lshlrev_b32 v128, 16, v128
  v_lshlrev_b32 v129, 16, v129
  v_lshlrev_b32 v130, 16, v130
  v_lshlrev_b32 v131, 16, v131
  v_mul_f32 v128, v128, v19
  v_mul_f32 v129, v129, v19
  v_mul_f32 v130, v130, v19
  v_mul_f32 v131, v131, v19
  v_cvt_pk_bf16_f32 v128, v128, v128
  v_cvt_pk_bf16_f32 v129, v129, v129
  v_cvt_pk_bf16_f32 v130, v130, v130
  v_cvt_pk_bf16_f32 v131, v131, v131
  v_lshlrev_b32 v128, 16, v128
  v_lshlrev_b32 v129, 16, v129
  v_lshlrev_b32 v130, 16, v130
  v_lshlrev_b32 v131, 16, v131
  v_add_f32 v128, v128, v144
  v_add_f32 v129, v129, v145
  v_add_f32 v130, v130, v146
  v_add_f32 v131, v131, v147
  v_add_f32 v128, v128, v18
  v_add_f32 v129, v129, v18
  v_add_f32 v130, v130, v18
  v_add_f32 v131, v131, v18
  v_lshlrev_b32 v148, 16, v148
  v_lshlrev_b32 v149, 16, v149
  v_lshlrev_b32 v150, 16, v150
  v_lshlrev_b32 v151, 16, v151
  v_sub_f32 v132, v148, v44
  v_sub_f32 v133, v149, v45
  v_sub_f32 v134, v150, v46
  v_sub_f32 v135, v151, v47
  v_cvt_pk_bf16_f32 v132, v132, v132
  v_cvt_pk_bf16_f32 v133, v133, v133
  v_cvt_pk_bf16_f32 v134, v134, v134
  v_cvt_pk_bf16_f32 v135, v135, v135
  v_lshlrev_b32 v132, 16, v132
  v_lshlrev_b32 v133, 16, v133
  v_lshlrev_b32 v134, 16, v134
  v_lshlrev_b32 v135, 16, v135
  v_mul_f32 v132, v132, v28
  v_mul_f32 v133, v133, v29
  v_mul_f32 v134, v134, v30
  v_mul_f32 v135, v135, v31
  v_cvt_pk_bf16_f32 v132, v132, v132
  v_cvt_pk_bf16_f32 v133, v133, v133
  v_cvt_pk_bf16_f32 v134, v134, v134
  v_cvt_pk_bf16_f32 v135, v135, v135
  v_lshlrev_b32 v132, 16, v132
  v_lshlrev_b32 v133, 16, v133
  v_lshlrev_b32 v134, 16, v134
  v_lshlrev_b32 v135, 16, v135
  v_mul_f32 v132, v132, v19
  v_mul_f32 v133, v133, v19
  v_mul_f32 v134, v134, v19
  v_mul_f32 v135, v135, v19
  v_cvt_pk_bf16_f32 v132, v132, v132
  v_cvt_pk_bf16_f32 v133, v133, v133
  v_cvt_pk_bf16_f32 v134, v134, v134
  v_cvt_pk_bf16_f32 v135, v135, v135
  v_lshlrev_b32 v132, 16, v132
  v_lshlrev_b32 v133, 16, v133
  v_lshlrev_b32 v134, 16, v134
  v_lshlrev_b32 v135, 16, v135
  v_add_f32 v132, v132, v148
  v_add_f32 v133, v133, v149
  v_add_f32 v134, v134, v150
  v_add_f32 v135, v135, v151
  v_add_f32 v132, v132, v18
  v_add_f32 v133, v133, v18
  v_add_f32 v134, v134, v18
  v_add_f32 v135, v135, v18
  v_lshlrev_b32 v152, 16, v152
  v_lshlrev_b32 v153, 16, v153
  v_lshlrev_b32 v154, 16, v154
  v_lshlrev_b32 v155, 16, v155
  v_sub_f32 v136, v152, v48
  v_sub_f32 v137, v153, v49
  v_sub_f32 v138, v154, v50
  v_sub_f32 v139, v155, v51
  v_cvt_pk_bf16_f32 v136, v136, v136
  v_cvt_pk_bf16_f32 v137, v137, v137
  v_cvt_pk_bf16_f32 v138, v138, v138
  v_cvt_pk_bf16_f32 v139, v139, v139
  v_lshlrev_b32 v136, 16, v136
  v_lshlrev_b32 v137, 16, v137
  v_lshlrev_b32 v138, 16, v138
  v_lshlrev_b32 v139, 16, v139
  v_mul_f32 v136, v136, v32
  v_mul_f32 v137, v137, v33
  v_mul_f32 v138, v138, v34
  v_mul_f32 v139, v139, v35
  v_cvt_pk_bf16_f32 v136, v136, v136
  v_cvt_pk_bf16_f32 v137, v137, v137
  v_cvt_pk_bf16_f32 v138, v138, v138
  v_cvt_pk_bf16_f32 v139, v139, v139
  v_lshlrev_b32 v136, 16, v136
  v_lshlrev_b32 v137, 16, v137
  v_lshlrev_b32 v138, 16, v138
  v_lshlrev_b32 v139, 16, v139
  v_mul_f32 v136, v136, v19
  v_mul_f32 v137, v137, v19
  v_mul_f32 v138, v138, v19
  v_mul_f32 v139, v139, v19
  v_cvt_pk_bf16_f32 v136, v136, v136
  v_cvt_pk_bf16_f32 v137, v137, v137
  v_cvt_pk_bf16_f32 v138, v138, v138
  v_cvt_pk_bf16_f32 v139, v139, v139
  v_lshlrev_b32 v136, 16, v136
  v_lshlrev_b32 v137, 16, v137
  v_lshlrev_b32 v138, 16, v138
  v_lshlrev_b32 v139, 16, v139
  v_add_f32 v136, v136, v152
  v_add_f32 v137, v137, v153
  v_add_f32 v138, v138, v154
  v_add_f32 v139, v139, v155
  v_add_f32 v136, v136, v18
  v_add_f32 v137, v137, v18
  v_add_f32 v138, v138, v18
  v_add_f32 v139, v139, v18
  v_lshlrev_b32 v156, 16, v156
  v_lshlrev_b32 v157, 16, v157
  v_lshlrev_b32 v158, 16, v158
  v_lshlrev_b32 v159, 16, v159
  v_sub_f32 v140, v156, v52
  v_sub_f32 v141, v157, v53
  v_sub_f32 v142, v158, v54
  v_sub_f32 v143, v159, v55
  v_cvt_pk_bf16_f32 v140, v140, v140
  v_cvt_pk_bf16_f32 v141, v141, v141
  v_cvt_pk_bf16_f32 v142, v142, v142
  v_cvt_pk_bf16_f32 v143, v143, v143
  v_lshlrev_b32 v140, 16, v140
  v_lshlrev_b32 v141, 16, v141
  v_lshlrev_b32 v142, 16, v142
  v_lshlrev_b32 v143, 16, v143
  v_mul_f32 v140, v140, v36
  v_mul_f32 v141, v141, v37
  v_mul_f32 v142, v142, v38
  v_mul_f32 v143, v143, v39
  v_cvt_pk_bf16_f32 v140, v140, v140
  v_cvt_pk_bf16_f32 v141, v141, v141
  v_cvt_pk_bf16_f32 v142, v142, v142
  v_cvt_pk_bf16_f32 v143, v143, v143
  v_lshlrev_b32 v140, 16, v140
  v_lshlrev_b32 v141, 16, v141
  v_lshlrev_b32 v142, 16, v142
  v_lshlrev_b32 v143, 16, v143
  v_mul_f32 v140, v140, v19
  v_mul_f32 v141, v141, v19
  v_mul_f32 v142, v142, v19
  v_mul_f32 v143, v143, v19
  v_cvt_pk_bf16_f32 v140, v140, v140
  v_cvt_pk_bf16_f32 v141, v141, v141
  v_cvt_pk_bf16_f32 v142, v142, v142
  v_cvt_pk_bf16_f32 v143, v143, v143
  v_lshlrev_b32 v140, 16, v140
  v_lshlrev_b32 v141, 16, v141
  v_lshlrev_b32 v142, 16, v142
  v_lshlrev_b32 v143, 16, v143
  v_add_f32 v140, v140, v156
  v_add_f32 v141, v141, v157
  v_add_f32 v142, v142, v158
  v_add_f32 v143, v143, v159
  v_add_f32 v140, v140, v18
  v_add_f32 v141, v141, v18
  v_add_f32 v142, v142, v18
  v_add_f32 v143, v143, v18
  v_mov_b32 v1, v17
  s_branch L_PHASE2
L_BWAVE:
  ds_read_b128 v[24:27], v6 offset:0
  ds_read_b64_tr_b16 v[32:33], v14 offset:0
  ds_read_b64_tr_b16 v[34:35], v14 offset:1024
  ds_read_b128 v[28:31], v6 offset:4096
  ds_read_b64_tr_b16 v[36:37], v15 offset:0
  ds_read_b64_tr_b16 v[38:39], v15 offset:1024
  ds_read_b64_tr_b16 v[40:41], v16 offset:0
  ds_read_b64_tr_b16 v[42:43], v16 offset:1024
  s_waitcnt lgkmcnt(0)
  v_mfma_f32_32x32x16_bf16 v[64:79], v[32:35], v[24:27], 0
  ds_read_b128 v[44:47], v7 offset:0
  ds_read_b64_tr_b16 v[52:53], v14 offset:4096
  ds_read_b64_tr_b16 v[54:55], v14 offset:5120
  v_mfma_f32_32x32x16_bf16 v[80:95], v[32:35], v[28:31], 0
  ds_read_b128 v[48:51], v7 offset:4096
  ds_read_b64_tr_b16 v[56:57], v15 offset:4096
  ds_read_b64_tr_b16 v[58:59], v15 offset:5120
  s_add_u32 m0, s89, 81920
  s_mov_b32 s13, 256
  buffer_load_dwordx4 v1, s[52:55], s13 offen lds
  s_add_u32 m0, s85, 98304
  s_mov_b32 s13, 256
  buffer_load_dwordx4 v3, s[56:59], s13 offen lds
  s_lshl_b32 s97, s4, 7
  s_lshl_b32 s98, s5, 3
  v_mfma_f32_32x32x16_bf16 v[96:111], v[36:39], v[24:27], 0
  ds_read_b64_tr_b16 v[60:61], v16 offset:4096
  ds_read_b64_tr_b16 v[62:63], v16 offset:5120
  s_add_u32 s97, s97, s98
  s_lshl_b32 s98, s3, 1
  s_add_u32 s97, s97, s98
  v_lshrrev_b32 v216, 5, v0
  v_mfma_f32_32x32x16_bf16 v[112:127], v[36:39], v[28:31], 0
  v_add_u32 v216, s97, v216
  v_and_b32 v217, 31, v0
  v_lshlrev_b32 v217, 4, v217
  v_mfma_f32_32x32x16_bf16 v[128:143], v[40:43], v[24:27], 0
  v_lshl_add_u32 v216, v216, 10, v217
  buffer_load_dwordx4 v[160:163], v216, s[52:55], 0 offen
  buffer_load_dwordx4 v[164:167], v216, s[52:55], 0 offen offset:512
  v_lshrrev_b32 v217, 2, v0
  v_mfma_f32_32x32x16_bf16 v[144:159], v[40:43], v[28:31], 0
  s_lshl_b32 s97, s4, 5
  v_add_u32 v218, s97, v217
  s_movk_i32 s98, 3584
  s_waitcnt lgkmcnt(0)
  v_mfma_f32_32x32x16_bf16 v[64:79], v[52:55], v[44:47], v[64:79]
  ds_read_b128 v[24:27], v8 offset:0
  ds_read_b64_tr_b16 v[32:33], v14 offset:8192
  ds_read_b64_tr_b16 v[34:35], v14 offset:9216
  v_mfma_f32_32x32x16_bf16 v[80:95], v[52:55], v[48:51], v[80:95]
  ds_read_b128 v[28:31], v8 offset:4096
  ds_read_b64_tr_b16 v[36:37], v15 offset:8192
  ds_read_b64_tr_b16 v[38:39], v15 offset:9216
  s_add_u32 m0, s84, 106496
  s_mov_b32 s13, 458752
  buffer_load_dwordx4 v5, s[60:63], s13 offen lds
  s_add_u32 m0, s89, 82944
  s_mov_b32 s13, 4352
  buffer_load_dwordx4 v2, s[52:55], s13 offen lds
  s_add_u32 m0, s84, 107520
  s_mov_b32 s13, 473088
  buffer_load_dwordx4 v5, s[60:63], s13 offen lds
  v_mul_lo_u32 v218, v218, s98
  v_mfma_f32_32x32x16_bf16 v[96:111], v[56:59], v[44:47], v[96:111]
  ds_read_b64_tr_b16 v[40:41], v16 offset:8192
  ds_read_b64_tr_b16 v[42:43], v16 offset:9216
  v_and_b32 v219, 3, v0
  v_lshlrev_b32 v219, 4, v219
  s_lshl_b32 s97, s3, 5
  s_add_u32 s97, s97, s88
  v_mfma_f32_32x32x16_bf16 v[112:127], v[56:59], v[48:51], v[112:127]
  s_lshl_b32 s97, s97, 1
  v_add3_u32 v218, v218, v219, s97
  buffer_load_dwordx4 v[168:171], v218, s[60:63], 0 offen
  s_mov_b32 s99, 57344
  v_mfma_f32_32x32x16_bf16 v[128:143], v[60:63], v[44:47], v[128:143]
  buffer_load_dwordx4 v[172:175], v218, s[60:63], s99 offen
  s_lshl_b32 s97, s5, 5
  s_lshl_b32 s98, s6, 4
  s_add_u32 s97, s97, s98
  v_mfma_f32_32x32x16_bf16 v[144:159], v[60:63], v[48:51], v[144:159]
  v_add_u32 v218, s97, v217
  v_lshl_add_u32 v218, v218, 10, v219
  s_lshl_b32 s97, s4, 6
  buffer_load_dwordx4 v[176:179], v218, s[56:59], s97 offen
  s_waitcnt lgkmcnt(0)
  v_mfma_f32_32x32x16_bf16 v[64:79], v[32:35], v[24:27], v[64:79]
  ds_read_b128 v[44:47], v9 offset:0
  ds_read_b64_tr_b16 v[52:53], v14 offset:12288
  ds_read_b64_tr_b16 v[54:55], v14 offset:13312
  v_mfma_f32_32x32x16_bf16 v[80:95], v[32:35], v[28:31], v[80:95]
  ds_read_b128 v[48:51], v9 offset:4096
  ds_read_b64_tr_b16 v[56:57], v15 offset:12288
  ds_read_b64_tr_b16 v[58:59], v15 offset:13312
  s_add_u32 m0, s89, 83968
  s_mov_b32 s13, 8448
  buffer_load_dwordx4 v1, s[52:55], s13 offen lds
  v_mfma_f32_32x32x16_bf16 v[96:111], v[36:39], v[24:27], v[96:111]
  ds_read_b64_tr_b16 v[60:61], v16 offset:12288
  ds_read_b64_tr_b16 v[62:63], v16 offset:13312
  v_mfma_f32_32x32x16_bf16 v[112:127], v[36:39], v[28:31], v[112:127]
  s_add_u32 m0, s85, 99328
  s_mov_b32 s13, 256
  buffer_load_dwordx4 v4, s[56:59], s13 offen lds
  v_mfma_f32_32x32x16_bf16 v[128:143], v[40:43], v[24:27], v[128:143]
  v_mfma_f32_32x32x16_bf16 v[144:159], v[40:43], v[28:31], v[144:159]
  s_waitcnt lgkmcnt(0)
  s_waitcnt vmcnt(13)
  s_barrier
  v_mfma_f32_32x32x16_bf16 v[64:79], v[52:55], v[44:47], v[64:79]
  ds_read_b128 v[24:27], v6 offset:40960
  ds_read_b64_tr_b16 v[32:33], v14 offset:40960
  ds_read_b64_tr_b16 v[34:35], v14 offset:41984
  v_mfma_f32_32x32x16_bf16 v[80:95], v[52:55], v[48:51], v[80:95]
  ds_read_b128 v[28:31], v6 offset:45056
  ds_read_b64_tr_b16 v[36:37], v15 offset:40960
  ds_read_b64_tr_b16 v[38:39], v15 offset:41984
  s_add_u32 m0, s84, 108544
  s_mov_b32 s13, 487424
  buffer_load_dwordx4 v5, s[60:63], s13 offen lds
  v_mfma_f32_32x32x16_bf16 v[96:111], v[56:59], v[44:47], v[96:111]
  ds_read_b64_tr_b16 v[40:41], v16 offset:40960
  ds_read_b64_tr_b16 v[42:43], v16 offset:41984
  s_add_u32 m0, s89, 84992
  s_mov_b32 s13, 12544
  buffer_load_dwordx4 v2, s[52:55], s13 offen lds
  v_mfma_f32_32x32x16_bf16 v[112:127], v[56:59], v[48:51], v[112:127]
  v_mfma_f32_32x32x16_bf16 v[128:143], v[60:63], v[44:47], v[128:143]
  s_add_u32 m0, s84, 109568
  s_mov_b32 s13, 501760
  buffer_load_dwordx4 v5, s[60:63], s13 offen lds
  v_mfma_f32_32x32x16_bf16 v[144:159], v[60:63], v[48:51], v[144:159]
  s_waitcnt lgkmcnt(0)
  v_mfma_f32_32x32x16_bf16 v[64:79], v[32:35], v[24:27], v[64:79]
  ds_read_b128 v[44:47], v7 offset:40960
  ds_read_b64_tr_b16 v[52:53], v14 offset:45056
  ds_read_b64_tr_b16 v[54:55], v14 offset:46080
  v_mfma_f32_32x32x16_bf16 v[80:95], v[32:35], v[28:31], v[80:95]
  ds_read_b128 v[48:51], v7 offset:45056
  ds_read_b64_tr_b16 v[56:57], v15 offset:45056
  ds_read_b64_tr_b16 v[58:59], v15 offset:46080
  s_add_u32 m0, s89, 122880
  s_mov_b32 s13, 384
  buffer_load_dwordx4 v1, s[52:55], s13 offen lds
  v_mfma_f32_32x32x16_bf16 v[96:111], v[36:39], v[24:27], v[96:111]
  ds_read_b64_tr_b16 v[60:61], v16 offset:45056
  ds_read_b64_tr_b16 v[62:63], v16 offset:46080
  v_mfma_f32_32x32x16_bf16 v[112:127], v[36:39], v[28:31], v[112:127]
  s_add_u32 m0, s85, 139264
  s_mov_b32 s13, 384
  buffer_load_dwordx4 v3, s[56:59], s13 offen lds
  v_mfma_f32_32x32x16_bf16 v[128:143], v[40:43], v[24:27], v[128:143]
  v_mfma_f32_32x32x16_bf16 v[144:159], v[40:43], v[28:31], v[144:159]
  s_waitcnt lgkmcnt(0)
  v_mfma_f32_32x32x16_bf16 v[64:79], v[52:55], v[44:47], v[64:79]
  ds_read_b128 v[24:27], v8 offset:40960
  ds_read_b64_tr_b16 v[32:33], v14 offset:49152
  ds_read_b64_tr_b16 v[34:35], v14 offset:50176
  v_mfma_f32_32x32x16_bf16 v[80:95], v[52:55], v[48:51], v[80:95]
  ds_read_b128 v[28:31], v8 offset:45056
  ds_read_b64_tr_b16 v[36:37], v15 offset:49152
  ds_read_b64_tr_b16 v[38:39], v15 offset:50176
  s_add_u32 m0, s84, 147456
  s_mov_b32 s13, 688128
  buffer_load_dwordx4 v5, s[60:63], s13 offen lds
  v_mfma_f32_32x32x16_bf16 v[96:111], v[56:59], v[44:47], v[96:111]
  ds_read_b64_tr_b16 v[40:41], v16 offset:49152
  ds_read_b64_tr_b16 v[42:43], v16 offset:50176
  s_add_u32 m0, s89, 123904
  s_mov_b32 s13, 4480
  buffer_load_dwordx4 v2, s[52:55], s13 offen lds
  v_mfma_f32_32x32x16_bf16 v[112:127], v[56:59], v[48:51], v[112:127]
  v_mfma_f32_32x32x16_bf16 v[128:143], v[60:63], v[44:47], v[128:143]
  s_add_u32 m0, s84, 148480
  s_mov_b32 s13, 702464
  buffer_load_dwordx4 v5, s[60:63], s13 offen lds
  v_mfma_f32_32x32x16_bf16 v[144:159], v[60:63], v[48:51], v[144:159]
  s_waitcnt lgkmcnt(0)
  v_mfma_f32_32x32x16_bf16 v[64:79], v[32:35], v[24:27], v[64:79]
  ds_read_b128 v[44:47], v9 offset:40960
  ds_read_b64_tr_b16 v[52:53], v14 offset:53248
  ds_read_b64_tr_b16 v[54:55], v14 offset:54272
  v_mfma_f32_32x32x16_bf16 v[80:95], v[32:35], v[28:31], v[80:95]
  ds_read_b128 v[48:51], v9 offset:45056
  ds_read_b64_tr_b16 v[56:57], v15 offset:53248
  ds_read_b64_tr_b16 v[58:59], v15 offset:54272
  s_add_u32 m0, s89, 124928
  s_mov_b32 s13, 8576
  buffer_load_dwordx4 v1, s[52:55], s13 offen lds
  v_mfma_f32_32x32x16_bf16 v[96:111], v[36:39], v[24:27], v[96:111]
  ds_read_b64_tr_b16 v[60:61], v16 offset:53248
  ds_read_b64_tr_b16 v[62:63], v16 offset:54272
  v_mfma_f32_32x32x16_bf16 v[112:127], v[36:39], v[28:31], v[112:127]
  s_add_u32 m0, s85, 140288
  s_mov_b32 s13, 384
  buffer_load_dwordx4 v4, s[56:59], s13 offen lds
  v_mfma_f32_32x32x16_bf16 v[128:143], v[40:43], v[24:27], v[128:143]
  v_mfma_f32_32x32x16_bf16 v[144:159], v[40:43], v[28:31], v[144:159]
  s_waitcnt lgkmcnt(0)
  s_waitcnt vmcnt(12)
  s_waitcnt lgkmcnt(0)
  s_mul_i32 s8, s8, 0x9E3779B1
  s_add_u32 s8, s8, 0x7F4A7C15
  v_mov_b32 v200, 0
  v_mov_b32 v202, 0
  v_mov_b32 v203, 0x3f803f80
  v_dot2c_f32_bf16 v200, v160, v203
  v_dot2c_f32_bf16 v202, v160, v160
  v_dot2c_f32_bf16 v200, v161, v203
  v_dot2c_f32_bf16 v202, v161, v161
  v_dot2c_f32_bf16 v200, v162, v203
  v_dot2c_f32_bf16 v202, v162, v162
  v_dot2c_f32_bf16 v200, v163, v203
  v_dot2c_f32_bf16 v202, v163, v163
  v_dot2c_f32_bf16 v200, v164, v203
  v_dot2c_f32_bf16 v202, v164, v164
  v_dot2c_f32_bf16 v200, v165, v203
  v_dot2c_f32_bf16 v202, v165, v165
  v_dot2c_f32_bf16 v200, v166, v203
  v_dot2c_f32_bf16 v202, v166, v166
  v_dot2c_f32_bf16 v200, v167, v203
  v_dot2c_f32_bf16 v202, v167, v167
  s_nop 2
  s_nop 0
  v_add_f32_dpp v200, v200, v200 quad_perm:[1,0,3,2] row_mask:0xf bank_mask:0xf
  v_add_f32_dpp v202, v202, v202 quad_perm:[1,0,3,2] row_mask:0xf bank_mask:0xf
  s_nop 0
  v_add_f32_dpp v200, v200, v200 quad_perm:[2,3,0,1] row_mask:0xf bank_mask:0xf
  v_add_f32_dpp v202, v202, v202 quad_perm:[2,3,0,1] row_mask:0xf bank_mask:0xf
  s_nop 0
  v_add_f32_dpp v200, v200, v200 row_half_mirror row_mask:0xf bank_mask:0xf
  v_add_f32_dpp v202, v202, v202 row_half_mirror row_mask:0xf bank_mask:0xf
  s_nop 0
  v_add_f32_dpp v200, v200, v200 row_mirror row_mask:0xf bank_mask:0xf
  v_add_f32_dpp v202, v202, v202 row_mirror row_mask:0xf bank_mask:0xf
  v_mov_b32 v201, v200
  v_mov_b32 v203, v202
  s_nop 0
  v_permlane16_swap_b32 v200, v201
  v_permlane16_swap_b32 v202, v203
  v_add_f32 v200, v200, v201
  v_add_f32 v202, v202, v203
  v_mul_f32 v200, 0x3b000000, v200
  v_mul_f32 v202, 0x3b000000, v202
  v_fma_f32 v202, -v200, v200, v202
  v_max_f32 v202, 0, v202
  v_cvt_pk_bf16_f32 v200, v200, v200
  v_lshlrev_b32 v200, 16, v200
  v_cvt_pk_bf16_f32 v202, v202, v202
  v_lshlrev_b32 v202, 16, v202
  v_add_f32 v202, 0x3727c5ac, v202
  v_cvt_pk_bf16_f32 v202, v202, v202
  v_lshlrev_b32 v202, 16, v202
  v_sqrt_f32 v202, v202
  s_nop 0
  v_cvt_pk_bf16_f32 v202, v202, v202
  v_lshlrev_b32 v202, 16, v202
  v_rcp_f32 v204, v202
  v_mov_b32 v205, s8
  v_mov_b32 v206, v200
  v_mov_b32 v207, s8
  s_lshl_b32 s97, s4, 7
  s_lshl_b32 s98, s5, 3
  s_add_u32 s97, s97, s98
  s_lshl_b32 s98, s3, 1
  s_add_u32 s97, s97, s98
  s_lshl_b32 s97, s97, 4
  s_add_u32 s97, s97, 4096
  v_lshrrev_b32 v216, 5, v0
  v_lshlrev_b32 v216, 4, v216
  s_mov_b32 exec_lo, 0x1
  s_mov_b32 exec_hi, 0x1
  buffer_store_dwordx4 v[204:207], v216, s[64:67], s97 offen sc1
  s_mov_b64 exec, -1
  v_lshlrev_b32 v184, 16, v168
  v_and_b32 v185, 0xffff0000, v168
  v_lshlrev_b32 v186, 16, v169
  v_and_b32 v187, 0xffff0000, v169
  v_lshlrev_b32 v188, 16, v170
  v_and_b32 v189, 0xffff0000, v170
  v_lshlrev_b32 v190, 16, v171
  v_and_b32 v191, 0xffff0000, v171
  v_lshlrev_b32 v192, 16, v172
  v_and_b32 v193, 0xffff0000, v172
  v_lshlrev_b32 v194, 16, v173
  v_and_b32 v195, 0xffff0000, v173
  v_lshlrev_b32 v196, 16, v174
  v_and_b32 v197, 0xffff0000, v174
  v_lshlrev_b32 v198, 16, v175
  v_and_b32 v199, 0xffff0000, v175
  v_add_f32 v184, v184, v192
  v_add_f32 v185, v185, v193
  v_add_f32 v186, v186, v194
  v_add_f32 v187, v187, v195
  v_add_f32 v188, v188, v196
  v_add_f32 v189, v189, v197
  v_add_f32 v190, v190, v198
  v_add_f32 v191, v191, v199
  s_nop 1
  v_permlane32_swap_b32 v184, v188
  v_permlane32_swap_b32 v185, v189
  v_permlane32_swap_b32 v186, v190
  v_permlane32_swap_b32 v187, v191
  v_add_f32 v184, v184, v188
  v_add_f32 v185, v185, v189
  v_add_f32 v186, v186, v190
  v_add_f32 v187, v187, v191
  s_nop 1
  v_permlane16_swap_b32 v184, v186
  v_permlane16_swap_b32 v185, v187
  v_add_f32 v184, v184, v186
  v_add_f32 v185, v185, v187
  s_nop 1
  v_add_f32_dpp v184, v184, v184 row_ror:4 row_mask:0xf bank_mask:0xf
  v_add_f32_dpp v185, v185, v185 row_ror:4 row_mask:0xf bank_mask:0xf
  s_nop 1
  v_add_f32_dpp v184, v184, v184 row_ror:8 row_mask:0xf bank_mask:0xf
  v_add_f32_dpp v185, v185, v185 row_ror:8 row_mask:0xf bank_mask:0xf
  v_mov_b32 v208, v184
  v_mov_b32 v209, s8
  v_mov_b32 v210, v185
  v_mov_b32 v211, s8
  v_and_b32 v216, 3, v0
  v_lshlrev_b32 v216, 3, v216
  v_lshrrev_b32 v217, 5, v0
  v_lshl_add_u32 v216, v217, 2, v216
  v_bfe_u32 v217, v0, 4, 1
  v_lshl_add_u32 v216, v217, 1, v216
  v_lshlrev_b32 v216, 3, v216
  s_lshl_b32 s97, s5, 4
  s_add_u32 s97, s97, s4
  s_mul_i32 s97, s97, 1536
  s_add_u32 s97, s97, 65536
  s_lshl_b32 s98, s3, 8
  s_add_u32 s98, s98, s97
  s_mov_b32 exec_lo, 0xf000f
  s_mov_b32 exec_hi, 0xf000f
  buffer_store_dwordx4 v[208:211], v216, s[64:67], s98 offen sc1
  s_mov_b64 exec, -1
  v_mov_b32 v212, 0
  v_mov_b32 v213, 0x3f803f80
  v_dot2c_f32_bf16 v212, v176, v213
  v_dot2c_f32_bf16 v212, v177, v213
  v_dot2c_f32_bf16 v212, v178, v213
  v_dot2c_f32_bf16 v212, v179, v213
  s_nop 1
  s_nop 1
  v_add_f32_dpp v212, v212, v212 quad_perm:[1,0,3,2] row_mask:0xf bank_mask:0xf
  s_nop 1
  v_add_f32_dpp v212, v212, v212 quad_perm:[2,3,0,1] row_mask:0xf bank_mask:0xf
  v_mov_b32 v213, s8
  v_lshrrev_b32 v216, 2, v0
  v_lshlrev_b32 v216, 3, v216
  s_lshl_b32 s98, s3, 7
  s_add_u32 s98, s98, s97
  s_add_u32 s98, s98, 1024
  s_mov_b32 exec_lo, 0x11111111
  s_mov_b32 exec_hi, 0x11111111
  buffer_store_dwordx2 v[212:213], v216, s[64:67], s98 offen sc1
  s_mov_b64 exec, -1
  s_waitcnt vmcnt(10)
  s_barrier
  v_mfma_f32_32x32x16_bf16 v[64:79], v[52:55], v[44:47], v[64:79]
  ds_read_b128 v[24:27], v10 offset:0
  ds_read_b64_tr_b16 v[32:33], v18 offset:0
  ds_read_b64_tr_b16 v[34:35], v18 offset:1024
  v_mfma_f32_32x32x16_bf16 v[80:95], v[52:55], v[48:51], v[80:95]
  ds_read_b128 v[28:31], v10 offset:4096
  ds_read_b64_tr_b16 v[36:37], v19 offset:0
  ds_read_b64_tr_b16 v[38:39], v19 offset:1024
  s_add_u32 m0, s84, 149504
  s_mov_b32 s13, 716800
  buffer_load_dwordx4 v5, s[60:63], s13 offen lds
  v_mfma_f32_32x32x16_bf16 v[96:111], v[56:59], v[44:47], v[96:111]
  ds_read_b64_tr_b16 v[40:41], v20 offset:0
  ds_read_b64_tr_b16 v[42:43], v20 offset:1024
  s_add_u32 m0, s89, 125952
  s_mov_b32 s13, 12672
  buffer_load_dwordx4 v2, s[52:55], s13 offen lds
  v_mfma_f32_32x32x16_bf16 v[112:127], v[56:59], v[48:51], v[112:127]
  v_mfma_f32_32x32x16_bf16 v[128:143], v[60:63], v[44:47], v[128:143]
  s_add_u32 m0, s84, 150528
  s_mov_b32 s13, 731136
  buffer_load_dwordx4 v5, s[60:63], s13 offen lds
  v_mfma_f32_32x32x16_bf16 v[144:159], v[60:63], v[48:51], v[144:159]
  s_waitcnt lgkmcnt(0)
  v_mfma_f32_32x32x16_bf16 v[64:79], v[32:35], v[24:27], v[64:79]
  ds_read_b128 v[44:47], v11 offset:0
  ds_read_b64_tr_b16 v[52:53], v18 offset:4096
  ds_read_b64_tr_b16 v[54:55], v18 offset:5120
  v_mfma_f32_32x32x16_bf16 v[80:95], v[32:35], v[28:31], v[80:95]
  ds_read_b128 v[48:51], v11 offset:4096
  ds_read_b64_tr_b16 v[56:57], v19 offset:4096
  ds_read_b64_tr_b16 v[58:59], v19 offset:5120
  s_add_u32 m0, s89, 0
  s_mov_b32 s13, 512
  buffer_load_dwordx4 v1, s[52:55], s13 offen lds
  v_mfma_f32_32x32x16_bf16 v[96:111], v[36:39], v[24:27], v[96:111]
  ds_read_b64_tr_b16 v[60:61], v20 offset:4096
  ds_read_b64_tr_b16 v[62:63], v20 offset:5120
  v_mfma_f32_32x32x16_bf16 v[112:127], v[36:39], v[28:31], v[112:127]
  s_add_u32 m0, s85, 16384
  s_mov_b32 s13, 512
  buffer_load_dwordx4 v3, s[56:59], s13 offen lds
  v_mfma_f32_32x32x16_bf16 v[128:143], v[40:43], v[24:27], v[128:143]
  v_mfma_f32_32x32x16_bf16 v[144:159], v[40:43], v[28:31], v[144:159]
  s_waitcnt lgkmcnt(0)
  v_mfma_f32_32x32x16_bf16 v[64:79], v[52:55], v[44:47], v[64:79]
  ds_read_b128 v[24:27], v12 offset:0
  ds_read_b64_tr_b16 v[32:33], v18 offset:8192
  ds_read_b64_tr_b16 v[34:35], v18 offset:9216
  v_mfma_f32_32x32x16_bf16 v[80:95], v[52:55], v[48:51], v[80:95]
  ds_read_b128 v[28:31], v12 offset:4096
  ds_read_b64_tr_b16 v[36:37], v19 offset:8192
  ds_read_b64_tr_b16 v[38:39], v19 offset:9216
  s_add_u32 m0, s84, 24576
  s_mov_b32 s13, 917504
  buffer_load_dwordx4 v5, s[60:63], s13 offen lds
  v_mfma_f32_32x32x16_bf16 v[96:111], v[56:59], v[44:47], v[96:111]
  ds_read_b64_tr_b16 v[40:41], v20 offset:8192
  ds_read_b64_tr_b16 v[42:43], v20 offset:9216
  s_add_u32 m0, s89, 1024
  s_mov_b32 s13, 4608
  buffer_load_dwordx4 v2, s[52:55], s13 offen lds
  v_mfma_f32_32x32x16_bf16 v[112:127], v[56:59], v[48:51], v[112:127]
  v_mfma_f32_32x32x16_bf16 v[128:143], v[60:63], v[44:47], v[128:143]
  s_add_u32 m0, s84, 25600
  s_mov_b32 s13, 931840
  buffer_load_dwordx4 v5, s[60:63], s13 offen lds
  v_mfma_f32_32x32x16_bf16 v[144:159], v[60:63], v[48:51], v[144:159]
  s_waitcnt lgkmcnt(0)
  v_mfma_f32_32x32x16_bf16 v[64:79], v[32:35], v[24:27], v[64:79]
  ds_read_b128 v[44:47], v13 offset:0
  ds_read_b64_tr_b16 v[52:53], v18 offset:12288
  ds_read_b64_tr_b16 v[54:55], v18 offset:13312
  v_mfma_f32_32x32x16_bf16 v[80:95], v[32:35], v[28:31], v[80:95]
  ds_read_b128 v[48:51], v13 offset:4096
  ds_read_b64_tr_b16 v[56:57], v19 offset:12288
  ds_read_b64_tr_b16 v[58:59], v19 offset:13312
  s_add_u32 m0, s89, 2048
  s_mov_b32 s13, 8704
  buffer_load_dwordx4 v1, s[52:55], s13 offen lds
  v_mfma_f32_32x32x16_bf16 v[96:111], v[36:39], v[24:27], v[96:111]
  ds_read_b64_tr_b16 v[60:61], v20 offset:12288
  ds_read_b64_tr_b16 v[62:63], v20 offset:13312
  v_mfma_f32_32x32x16_bf16 v[112:127], v[36:39], v[28:31], v[112:127]
  s_add_u32 m0, s85, 17408
  s_mov_b32 s13, 512
  buffer_load_dwordx4 v4, s[56:59], s13 offen lds
  v_mfma_f32_32x32x16_bf16 v[128:143], v[40:43], v[24:27], v[128:143]
  v_mfma_f32_32x32x16_bf16 v[144:159], v[40:43], v[28:31], v[144:159]
  s_waitcnt lgkmcnt(0)
  s_waitcnt vmcnt(7)
  s_barrier
  v_mfma_f32_32x32x16_bf16 v[64:79], v[52:55], v[44:47], v[64:79]
  ds_read_b128 v[24:27], v10 offset:40960
  ds_read_b64_tr_b16 v[32:33], v18 offset:40960
  ds_read_b64_tr_b16 v[34:35], v18 offset:41984
  v_mfma_f32_32x32x16_bf16 v[80:95], v[52:55], v[48:51], v[80:95]
  ds_read_b128 v[28:31], v10 offset:45056
  ds_read_b64_tr_b16 v[36:37], v19 offset:40960
  ds_read_b64_tr_b16 v[38:39], v19 offset:41984
  s_add_u32 m0, s84, 26624
  s_mov_b32 s13, 946176
  buffer_load_dwordx4 v5, s[60:63], s13 offen lds
  v_mfma_f32_32x32x16_bf16 v[96:111], v[56:59], v[44:47], v[96:111]
  ds_read_b64_tr_b16 v[40:41], v20 offset:40960
  ds_read_b64_tr_b16 v[42:43], v20 offset:41984
  s_add_u32 m0, s89, 3072
  s_mov_b32 s13, 12800
  buffer_load_dwordx4 v2, s[52:55], s13 offen lds
  v_mfma_f32_32x32x16_bf16 v[112:127], v[56:59], v[48:51], v[112:127]
  v_mfma_f32_32x32x16_bf16 v[128:143], v[60:63], v[44:47], v[128:143]
  s_add_u32 m0, s84, 27648
  s_mov_b32 s13, 960512
  buffer_load_dwordx4 v5, s[60:63], s13 offen lds
  v_mfma_f32_32x32x16_bf16 v[144:159], v[60:63], v[48:51], v[144:159]
  s_waitcnt lgkmcnt(0)
  v_mfma_f32_32x32x16_bf16 v[64:79], v[32:35], v[24:27], v[64:79]
  ds_read_b128 v[44:47], v11 offset:40960
  ds_read_b64_tr_b16 v[52:53], v18 offset:45056
  ds_read_b64_tr_b16 v[54:55], v18 offset:46080
  v_mfma_f32_32x32x16_bf16 v[80:95], v[32:35], v[28:31], v[80:95]
  ds_read_b128 v[48:51], v11 offset:45056
  ds_read_b64_tr_b16 v[56:57], v19 offset:45056
  ds_read_b64_tr_b16 v[58:59], v19 offset:46080
  s_add_u32 m0, s89, 40960
  s_mov_b32 s13, 640
  buffer_load_dwordx4 v1, s[52:55], s13 offen lds
  v_mfma_f32_32x32x16_bf16 v[96:111], v[36:39], v[24:27], v[96:111]
  ds_read_b64_tr_b16 v[60:61], v20 offset:45056
  ds_read_b64_tr_b16 v[62:63], v20 offset:46080
  v_mfma_f32_32x32x16_bf16 v[112:127], v[36:39], v[28:31], v[112:127]
  s_add_u32 m0, s85, 57344
  s_mov_b32 s13, 640
  buffer_load_dwordx4 v3, s[56:59], s13 offen lds
  v_mfma_f32_32x32x16_bf16 v[128:143], v[40:43], v[24:27], v[128:143]
  v_mfma_f32_32x32x16_bf16 v[144:159], v[40:43], v[28:31], v[144:159]
  s_waitcnt lgkmcnt(0)
  v_mfma_f32_32x32x16_bf16 v[64:79], v[52:55], v[44:47], v[64:79]
  ds_read_b128 v[24:27], v12 offset:40960
  ds_read_b64_tr_b16 v[32:33], v18 offset:49152
  ds_read_b64_tr_b16 v[34:35], v18 offset:50176
  v_mfma_f32_32x32x16_bf16 v[80:95], v[52:55], v[48:51], v[80:95]
  ds_read_b128 v[28:31], v12 offset:45056
  ds_read_b64_tr_b16 v[36:37], v19 offset:49152
  ds_read_b64_tr_b16 v[38:39], v19 offset:50176
  s_add_u32 m0, s84, 65536
  s_mov_b32 s13, 1146880
  buffer_load_dwordx4 v5, s[60:63], s13 offen lds
  v_mfma_f32_32x32x16_bf16 v[96:111], v[56:59], v[44:47], v[96:111]
  ds_read_b64_tr_b16 v[40:41], v20 offset:49152
  ds_read_b64_tr_b16 v[42:43], v20 offset:50176
  s_add_u32 m0, s89, 41984
  s_mov_b32 s13, 4736
  buffer_load_dwordx4 v2, s[52:55], s13 offen lds
  v_mfma_f32_32x32x16_bf16 v[112:127], v[56:59], v[48:51], v[112:127]
  v_mfma_f32_32x32x16_bf16 v[128:143], v[60:63], v[44:47], v[128:143]
  s_add_u32 m0, s84, 66560
  s_mov_b32 s13, 1161216
  buffer_load_dwordx4 v5, s[60:63], s13 offen lds
  v_mfma_f32_32x32x16_bf16 v[144:159], v[60:63], v[48:51], v[144:159]
  s_waitcnt lgkmcnt(0)
  v_mfma_f32_32x32x16_bf16 v[64:79], v[32:35], v[24:27], v[64:79]
  ds_read_b128 v[44:47], v13 offset:40960
  ds_read_b64_tr_b16 v[52:53], v18 offset:53248
  ds_read_b64_tr_b16 v[54:55], v18 offset:54272
  v_mfma_f32_32x32x16_bf16 v[80:95], v[32:35], v[28:31], v[80:95]
  ds_read_b128 v[48:51], v13 offset:45056
  ds_read_b64_tr_b16 v[56:57], v19 offset:53248
  ds_read_b64_tr_b16 v[58:59], v19 offset:54272
  s_add_u32 m0, s89, 43008
  s_mov_b32 s13, 8832
  buffer_load_dwordx4 v1, s[52:55], s13 offen lds
  v_mfma_f32_32x32x16_bf16 v[96:111], v[36:39], v[24:27], v[96:111]
  ds_read_b64_tr_b16 v[60:61], v20 offset:53248
  ds_read_b64_tr_b16 v[62:63], v20 offset:54272
  v_mfma_f32_32x32x16_bf16 v[112:127], v[36:39], v[28:31], v[112:127]
  s_add_u32 m0, s85, 58368
  s_mov_b32 s13, 640
  buffer_load_dwordx4 v4, s[56:59], s13 offen lds
  v_mfma_f32_32x32x16_bf16 v[128:143], v[40:43], v[24:27], v[128:143]
  v_mfma_f32_32x32x16_bf16 v[144:159], v[40:43], v[28:31], v[144:159]
  s_waitcnt lgkmcnt(0)
  s_waitcnt vmcnt(7)
  s_barrier
  v_mfma_f32_32x32x16_bf16 v[64:79], v[52:55], v[44:47], v[64:79]
  ds_read_b128 v[24:27], v6 offset:0
  ds_read_b64_tr_b16 v[32:33], v14 offset:0
  ds_read_b64_tr_b16 v[34:35], v14 offset:1024
  v_mfma_f32_32x32x16_bf16 v[80:95], v[52:55], v[48:51], v[80:95]
  ds_read_b128 v[28:31], v6 offset:4096
  ds_read_b64_tr_b16 v[36:37], v15 offset:0
  ds_read_b64_tr_b16 v[38:39], v15 offset:1024
  s_add_u32 m0, s84, 67584
  s_mov_b32 s13, 1175552
  buffer_load_dwordx4 v5, s[60:63], s13 offen lds
  v_mfma_f32_32x32x16_bf16 v[96:111], v[56:59], v[44:47], v[96:111]
  ds_read_b64_tr_b16 v[40:41], v16 offset:0
  ds_read_b64_tr_b16 v[42:43], v16 offset:1024
  s_add_u32 m0, s89, 44032
  s_mov_b32 s13, 12928
  buffer_load_dwordx4 v2, s[52:55], s13 offen lds
  v_mfma_f32_32x32x16_bf16 v[112:127], v[56:59], v[48:51], v[112:127]
  v_mfma_f32_32x32x16_bf16 v[128:143], v[60:63], v[44:47], v[128:143]
  s_add_u32 m0, s84, 68608
  s_mov_b32 s13, 1189888
  buffer_load_dwordx4 v5, s[60:63], s13 offen lds
  v_mfma_f32_32x32x16_bf16 v[144:159], v[60:63], v[48:51], v[144:159]
  s_waitcnt lgkmcnt(0)
  v_mfma_f32_32x32x16_bf16 v[64:79], v[32:35], v[24:27], v[64:79]
  ds_read_b128 v[44:47], v7 offset:0
  ds_read_b64_tr_b16 v[52:53], v14 offset:4096
  ds_read_b64_tr_b16 v[54:55], v14 offset:5120
  v_mfma_f32_32x32x16_bf16 v[80:95], v[32:35], v[28:31], v[80:95]
  ds_read_b128 v[48:51], v7 offset:4096
  ds_read_b64_tr_b16 v[56:57], v15 offset:4096
  ds_read_b64_tr_b16 v[58:59], v15 offset:5120
  s_add_u32 m0, s89, 81920
  s_mov_b32 s13, 768
  buffer_load_dwordx4 v1, s[52:55], s13 offen lds
  v_mfma_f32_32x32x16_bf16 v[96:111], v[36:39], v[24:27], v[96:111]
  ds_read_b64_tr_b16 v[60:61], v16 offset:4096
  ds_read_b64_tr_b16 v[62:63], v16 offset:5120
  v_mfma_f32_32x32x16_bf16 v[112:127], v[36:39], v[28:31], v[112:127]
  s_add_u32 m0, s85, 98304
  s_mov_b32 s13, 768
  buffer_load_dwordx4 v3, s[56:59], s13 offen lds
  v_mfma_f32_32x32x16_bf16 v[128:143], v[40:43], v[24:27], v[128:143]
  v_mfma_f32_32x32x16_bf16 v[144:159], v[40:43], v[28:31], v[144:159]
  s_waitcnt lgkmcnt(0)
  v_mfma_f32_32x32x16_bf16 v[64:79], v[52:55], v[44:47], v[64:79]
  ds_read_b128 v[24:27], v8 offset:0
  ds_read_b64_tr_b16 v[32:33], v14 offset:8192
  ds_read_b64_tr_b16 v[34:35], v14 offset:9216
  v_mfma_f32_32x32x16_bf16 v[80:95], v[52:55], v[48:51], v[80:95]
  ds_read_b128 v[28:31], v8 offset:4096
  ds_read_b64_tr_b16 v[36:37], v15 offset:8192
  ds_read_b64_tr_b16 v[38:39], v15 offset:9216
  s_add_u32 m0, s84, 106496
  s_mov_b32 s13, 1376256
  buffer_load_dwordx4 v5, s[60:63], s13 offen lds
  v_mfma_f32_32x32x16_bf16 v[96:111], v[56:59], v[44:47], v[96:111]
  ds_read_b64_tr_b16 v[40:41], v16 offset:8192
  ds_read_b64_tr_b16 v[42:43], v16 offset:9216
  s_add_u32 m0, s89, 82944
  s_mov_b32 s13, 4864
  buffer_load_dwordx4 v2, s[52:55], s13 offen lds
  v_mfma_f32_32x32x16_bf16 v[112:127], v[56:59], v[48:51], v[112:127]
  s_add_u32 m0, s84, 107520
  s_mov_b32 s13, 1390592
  buffer_load_dwordx4 v5, s[60:63], s13 offen lds
  v_mfma_f32_32x32x16_bf16 v[128:143], v[60:63], v[44:47], v[128:143]
  s_cmp_eq_u32 s3, 3
  s_cbranch_scc1 L_fp_st
  v_lshlrev_b32 v248, 3, v0
  s_mul_i32 s10, s5, 24576
  s_lshl_b32 s11, s3, 9
  s_add_u32 s10, s10, s11
  s_add_u32 s10, s10, 65536
  s_add_u32 s13, s10, 0
  buffer_load_dwordx2 v[160:161], v248, s[64:67], s13 offen sc1
  s_add_u32 s13, s10, 1536
  buffer_load_dwordx2 v[162:163], v248, s[64:67], s13 offen sc1
  s_add_u32 s13, s10, 3072
  buffer_load_dwordx2 v[164:165], v248, s[64:67], s13 offen sc1
  s_add_u32 s13, s10, 4608
  buffer_load_dwordx2 v[166:167], v248, s[64:67], s13 offen sc1
  s_add_u32 s13, s10, 6144
  buffer_load_dwordx2 v[168:169], v248, s[64:67], s13 offen sc1
  s_add_u32 s13, s10, 7680
  buffer_load_dwordx2 v[170:171], v248, s[64:67], s13 offen sc1
  s_add_u32 s13, s10, 9216
  buffer_load_dwordx2 v[172:173], v248, s[64:67], s13 offen sc1
  s_add_u32 s13, s10, 10752
  buffer_load_dwordx2 v[174:175], v248, s[64:67], s13 offen sc1
  s_add_u32 s13, s10, 12288
  buffer_load_dwordx2 v[176:177], v248, s[64:67], s13 offen sc1
  s_add_u32 s13, s10, 13824
  buffer_load_dwordx2 v[178:179], v248, s[64:67], s13 offen sc1
  s_add_u32 s13, s10, 15360
  buffer_load_dwordx2 v[180:181], v248, s[64:67], s13 offen sc1
  s_add_u32 s13, s10, 16896
  buffer_load_dwordx2 v[182:183], v248, s[64:67], s13 offen sc1
  s_add_u32 s13, s10, 18432
  buffer_load_dwordx2 v[184:185], v248, s[64:67], s13 offen sc1
  s_add_u32 s13, s10, 19968
  buffer_load_dwordx2 v[186:187], v248, s[64:67], s13 offen sc1
  s_add_u32 s13, s10, 21504
  buffer_load_dwordx2 v[188:189], v248, s[64:67], s13 offen sc1
  s_add_u32 s13, s10, 23040
  buffer_load_dwordx2 v[190:191], v248, s[64:67], s13 offen sc1
  s_branch L_fp_j
L_fp_st:
  v_lshlrev_b32 v248, 4, v0
  s_lshl_b32 s10, s4, 11
  s_add_u32 s10, s10, 4096
  buffer_load_dwordx4 v[160:163], v248, s[64:67], s10 offen sc1
  buffer_load_dwordx4 v[164:167], v248, s[64:67], s10 offen offset:1024 sc1
  v_add_u32 v249, s88, v0
  v_lshlrev_b32 v249, 1, v249
  global_load_ushort v168, v249, s[38:39]
  global_load_ushort v169, v249, s[38:39] offset:128
L_fp_j:
  v_mfma_f32_32x32x16_bf16 v[144:159], v[60:63], v[48:51], v[144:159]
  s_waitcnt lgkmcnt(0)
  v_mfma_f32_32x32x16_bf16 v[64:79], v[32:35], v[24:27], v[64:79]
  ds_read_b128 v[44:47], v9 offset:0
  ds_read_b64_tr_b16 v[52:53], v14 offset:12288
  ds_read_b64_tr_b16 v[54:55], v14 offset:13312
  v_mfma_f32_32x32x16_bf16 v[80:95], v[32:35], v[28:31], v[80:95]
  ds_read_b128 v[48:51], v9 offset:4096
  ds_read_b64_tr_b16 v[56:57], v15 offset:12288
  ds_read_b64_tr_b16 v[58:59], v15 offset:13312
  s_add_u32 m0, s89, 83968
  s_mov_b32 s13, 8960
  buffer_load_dwordx4 v1, s[52:55], s13 offen lds
  v_mfma_f32_32x32x16_bf16 v[96:111], v[36:39], v[24:27], v[96:111]
  ds_read_b64_tr_b16 v[60:61], v16 offset:12288
  ds_read_b64_tr_b16 v[62:63], v16 offset:13312
  v_mfma_f32_32x32x16_bf16 v[112:127], v[36:39], v[28:31], v[112:127]
  s_add_u32 m0, s85, 99328
  s_mov_b32 s13, 768
  buffer_load_dwordx4 v4, s[56:59], s13 offen lds
  v_mfma_f32_32x32x16_bf16 v[128:143], v[40:43], v[24:27], v[128:143]
  v_mfma_f32_32x32x16_bf16 v[144:159], v[40:43], v[28:31], v[144:159]
  s_waitcnt lgkmcnt(0)
  s_waitcnt vmcnt(11)
  s_barrier
  v_mfma_f32_32x32x16_bf16 v[64:79], v[52:55], v[44:47], v[64:79]
  ds_read_b128 v[24:27], v6 offset:40960
  ds_read_b64_tr_b16 v[32:33], v14 offset:40960
  ds_read_b64_tr_b16 v[34:35], v14 offset:41984
  v_mfma_f32_32x32x16_bf16 v[80:95], v[52:55], v[48:51], v[80:95]
  ds_read_b128 v[28:31], v6 offset:45056
  ds_read_b64_tr_b16 v[36:37], v15 offset:40960
  ds_read_b64_tr_b16 v[38:39], v15 offset:41984
  s_add_u32 m0, s84, 108544
  s_mov_b32 s13, 1404928
  buffer_load_dwordx4 v5, s[60:63], s13 offen lds
  v_mfma_f32_32x32x16_bf16 v[96:111], v[56:59], v[44:47], v[96:111]
  ds_read_b64_tr_b16 v[40:41], v16 offset:40960
  ds_read_b64_tr_b16 v[42:43], v16 offset:41984
  s_add_u32 m0, s89, 84992
  s_mov_b32 s13, 13056
  buffer_load_dwordx4 v2, s[52:55], s13 offen lds
  v_mfma_f32_32x32x16_bf16 v[112:127], v[56:59], v[48:51], v[112:127]
  v_mfma_f32_32x32x16_bf16 v[128:143], v[60:63], v[44:47], v[128:143]
  s_add_u32 m0, s84, 109568
  s_mov_b32 s13, 1419264
  buffer_load_dwordx4 v5, s[60:63], s13 offen lds
  v_mfma_f32_32x32x16_bf16 v[144:159], v[60:63], v[48:51], v[144:159]
  s_waitcnt lgkmcnt(0)
  v_mfma_f32_32x32x16_bf16 v[64:79], v[32:35], v[24:27], v[64:79]
  ds_read_b128 v[44:47], v7 offset:40960
  ds_read_b64_tr_b16 v[52:53], v14 offset:45056
  ds_read_b64_tr_b16 v[54:55], v14 offset:46080
  v_mfma_f32_32x32x16_bf16 v[80:95], v[32:35], v[28:31], v[80:95]
  ds_read_b128 v[48:51], v7 offset:45056
  ds_read_b64_tr_b16 v[56:57], v15 offset:45056
  ds_read_b64_tr_b16 v[58:59], v15 offset:46080
  s_add_u32 m0, s89, 122880
  s_mov_b32 s13, 896
  buffer_load_dwordx4 v1, s[52:55], s13 offen lds
  v_mfma_f32_32x32x16_bf16 v[96:111], v[36:39], v[24:27], v[96:111]
  ds_read_b64_tr_b16 v[60:61], v16 offset:45056
  ds_read_b64_tr_b16 v[62:63], v16 offset:46080
  v_mfma_f32_32x32x16_bf16 v[112:127], v[36:39], v[28:31], v[112:127]
  s_add_u32 m0, s85, 139264
  s_mov_b32 s13, 896
  buffer_load_dwordx4 v3, s[56:59], s13 offen lds
  v_mfma_f32_32x32x16_bf16 v[128:143], v[40:43], v[24:27], v[128:143]
  v_mfma_f32_32x32x16_bf16 v[144:159], v[40:43], v[28:31], v[144:159]
  s_waitcnt lgkmcnt(0)
  v_mfma_f32_32x32x16_bf16 v[64:79], v[52:55], v[44:47], v[64:79]
  ds_read_b128 v[24:27], v8 offset:40960
  ds_read_b64_tr_b16 v[32:33], v14 offset:49152
  ds_read_b64_tr_b16 v[34:35], v14 offset:50176
  v_mfma_f32_32x32x16_bf16 v[80:95], v[52:55], v[48:51], v[80:95]
  ds_read_b128 v[28:31], v8 offset:45056
  ds_read_b64_tr_b16 v[36:37], v15 offset:49152
  ds_read_b64_tr_b16 v[38:39], v15 offset:50176
  s_add_u32 m0, s84, 147456
  s_mov_b32 s13, 1605632
  buffer_load_dwordx4 v5, s[60:63], s13 offen lds
  v_mfma_f32_32x32x16_bf16 v[96:111], v[56:59], v[44:47], v[96:111]
  ds_read_b64_tr_b16 v[40:41], v16 offset:49152
  ds_read_b64_tr_b16 v[42:43], v16 offset:50176
  s_add_u32 m0, s89, 123904
  s_mov_b32 s13, 4992
  buffer_load_dwordx4 v2, s[52:55], s13 offen lds
  v_mfma_f32_32x32x16_bf16 v[112:127], v[56:59], v[48:51], v[112:127]
  v_mfma_f32_32x32x16_bf16 v[128:143], v[60:63], v[44:47], v[128:143]
  s_add_u32 m0, s84, 148480
  s_mov_b32 s13, 1619968
  buffer_load_dwordx4 v5, s[60:63], s13 offen lds
  v_mfma_f32_32x32x16_bf16 v[144:159], v[60:63], v[48:51], v[144:159]
  s_waitcnt lgkmcnt(0)
  v_mfma_f32_32x32x16_bf16 v[64:79], v[32:35], v[24:27], v[64:79]
  ds_read_b128 v[44:47], v9 offset:40960
  ds_read_b64_tr_b16 v[52:53], v14 offset:53248
  ds_read_b64_tr_b16 v[54:55], v14 offset:54272
  v_mfma_f32_32x32x16_bf16 v[80:95], v[32:35], v[28:31], v[80:95]
  ds_read_b128 v[48:51], v9 offset:45056
  ds_read_b64_tr_b16 v[56:57], v15 offset:53248
  ds_read_b64_tr_b16 v[58:59], v15 offset:54272
  s_add_u32 m0, s89, 124928
  s_mov_b32 s13, 9088
  buffer_load_dwordx4 v1, s[52:55], s13 offen lds
  v_mfma_f32_32x32x16_bf16 v[96:111], v[36:39], v[24:27], v[96:111]
  ds_read_b64_tr_b16 v[60:61], v16 offset:53248
  ds_read_b64_tr_b16 v[62:63], v16 offset:54272
  s_add_u32 m0, s85, 140288
  s_mov_b32 s13, 896
  buffer_load_dwordx4 v4, s[56:59], s13 offen lds
  v_mfma_f32_32x32x16_bf16 v[112:127], v[36:39], v[28:31], v[112:127]
  v_mfma_f32_32x32x16_bf16 v[128:143], v[40:43], v[24:27], v[128:143]
  s_cmp_eq_u32 s3, 3
  s_cbranch_scc1 L_ff_st
  s_waitcnt vmcnt(12)
  s_mov_b32 s97, 0
P_csB_chk:
  v_cmp_ne_u32 vcc, s8, v161
  s_mov_b64 s[90:91], vcc
  v_cmp_ne_u32 vcc, s8, v163
  s_or_b64 s[90:91], s[90:91], vcc
  v_cmp_ne_u32 vcc, s8, v165
  s_or_b64 s[90:91], s[90:91], vcc
  v_cmp_ne_u32 vcc, s8, v167
  s_or_b64 s[90:91], s[90:91], vcc
  v_cmp_ne_u32 vcc, s8, v169
  s_or_b64 s[90:91], s[90:91], vcc
  v_cmp_ne_u32 vcc, s8, v171
  s_or_b64 s[90:91], s[90:91], vcc
  v_cmp_ne_u32 vcc, s8, v173
  s_or_b64 s[90:91], s[90:91], vcc
  v_cmp_ne_u32 vcc, s8, v175
  s_or_b64 s[90:91], s[90:91], vcc
  v_cmp_ne_u32 vcc, s8, v177
  s_or_b64 s[90:91], s[90:91], vcc
  v_cmp_ne_u32 vcc, s8, v179
  s_or_b64 s[90:91], s[90:91], vcc
  v_cmp_ne_u32 vcc, s8, v181
  s_or_b64 s[90:91], s[90:91], vcc
  v_cmp_ne_u32 vcc, s8, v183
  s_or_b64 s[90:91], s[90:91], vcc
  v_cmp_ne_u32 vcc, s8, v185
  s_or_b64 s[90:91], s[90:91], vcc
  v_cmp_ne_u32 vcc, s8, v187
  s_or_b64 s[90:91], s[90:91], vcc
  v_cmp_ne_u32 vcc, s8, v189
  s_or_b64 s[90:91], s[90:91], vcc
  v_cmp_ne_u32 vcc, s8, v191
  s_or_b64 s[90:91], s[90:91], vcc
  s_cmp_lg_u64 s[90:91], 0
  s_cbranch_scc0 P_csB_ok
  s_add_u32 s97, s97, 1
  s_cmp_gt_u32 s97, 20000
  s_cbranch_scc1 P_csB_ok
  s_sleep 2
  v_lshlrev_b32 v248, 3, v0
  s_mul_i32 s10, s5, 24576
  s_lshl_b32 s11, s3, 9
  s_add_u32 s10, s10, s11
  s_add_u32 s10, s10, 65536
  s_add_u32 s13, s10, 0
  buffer_load_dwordx2 v[160:161], v248, s[64:67], s13 offen sc1
  s_add_u32 s13, s10, 1536
  buffer_load_dwordx2 v[162:163], v248, s[64:67], s13 offen sc1
  s_add_u32 s13, s10, 3072
  buffer_load_dwordx2 v[164:165], v248, s[64:67], s13 offen sc1
  s_add_u32 s13, s10, 4608
  buffer_load_dwordx2 v[166:167], v248, s[64:67], s13 offen sc1
  s_add_u32 s13, s10, 6144
  buffer_load_dwordx2 v[168:169], v248, s[64:67], s13 offen sc1
  s_add_u32 s13, s10, 7680
  buffer_load_dwordx2 v[170:171], v248, s[64:67], s13 offen sc1
  s_add_u32 s13, s10, 9216
  buffer_load_dwordx2 v[172:173], v248, s[64:67], s13 offen sc1
  s_add_u32 s13, s10, 10752
  buffer_load_dwordx2 v[174:175], v248, s[64:67], s13 offen sc1
  s_add_u32 s13, s10, 12288
  buffer_load_dwordx2 v[176:177], v248, s[64:67], s13 offen sc1
  s_add_u32 s13, s10, 13824
  buffer_load_dwordx2 v[178:179], v248, s[64:67], s13 offen sc1
  s_add_u32 s13, s10, 15360
  buffer_load_dwordx2 v[180:181], v248, s[64:67], s13 offen sc1
  s_add_u32 s13, s10, 16896
  buffer_load_dwordx2 v[182:183], v248, s[64:67], s13 offen sc1
  s_add_u32 s13, s10, 18432
  buffer_load_dwordx2 v[184:185], v248, s[64:67], s13 offen sc1
  s_add_u32 s13, s10, 19968
  buffer_load_dwordx2 v[186:187], v248, s[64:67], s13 offen sc1
  s_add_u32 s13, s10, 21504
  buffer_load_dwordx2 v[188:189], v248, s[64:67], s13 offen sc1
  s_add_u32 s13, s10, 23040
  buffer_load_dwordx2 v[190:191], v248, s[64:67], s13 offen sc1
  s_waitcnt vmcnt(0)
  s_branch P_csB_chk
P_csB_ok:
  v_add_f32 v248, v160, v162
  v_add_f32 v248, v248, v164
  v_add_f32 v248, v248, v166
  v_add_f32 v248, v248, v168
  v_add_f32 v248, v248, v170
  v_add_f32 v248, v248, v172
  v_add_f32 v248, v248, v174
  v_add_f32 v248, v248, v176
  v_add_f32 v248, v248, v178
  v_add_f32 v248, v248, v180
  v_add_f32 v248, v248, v182
  v_add_f32 v248, v248, v184
  v_add_f32 v248, v248, v186
  v_add_f32 v248, v248, v188
  v_add_f32 v248, v248, v190
  v_lshlrev_b32 v249, 2, v0
  s_lshl_b32 s10, s3, 8
  v_add_u32 v249, s10, v249
  ds_write_b32 v249, v248 offset:32768
  s_branch L_ff_j
L_ff_st:
  s_waitcnt vmcnt(12)
  s_mov_b32 s97, 0
P_st_chk:
  v_cmp_ne_u32 vcc, s8, v161
  s_mov_b64 s[90:91], vcc
  v_cmp_ne_u32 vcc, s8, v163
  s_or_b64 s[90:91], s[90:91], vcc
  v_cmp_ne_u32 vcc, s8, v165
  s_or_b64 s[90:91], s[90:91], vcc
  v_cmp_ne_u32 vcc, s8, v167
  s_or_b64 s[90:91], s[90:91], vcc
  s_cmp_lg_u64 s[90:91], 0
  s_cbranch_scc0 P_st_ok
  s_add_u32 s97, s97, 1
  s_cmp_gt_u32 s97, 20000
  s_cbranch_scc1 P_st_ok
  s_sleep 2
  v_lshlrev_b32 v248, 4, v0
  s_lshl_b32 s10, s4, 11
  s_add_u32 s10, s10, 4096
  buffer_load_dwordx4 v[160:163], v248, s[64:67], s10 offen sc1
  buffer_load_dwordx4 v[164:167], v248, s[64:67], s10 offen offset:1024 sc1
  s_waitcnt vmcnt(0)
  s_branch P_st_chk
P_st_ok:
  v_lshlrev_b32 v249, 2, v0
  v_mul_f32 v248, v160, v162
  ds_write_b32 v249, v160 offset:34304
  ds_write_b32 v249, v162 offset:35328
  ds_write_b32 v249, v248 offset:34816
  v_lshlrev_b32 v250, 16, v168
  ds_write_b32 v249, v250 offset:33792
  v_mul_f32 v248, v164, v166
  ds_write_b32 v249, v164 offset:34560
  ds_write_b32 v249, v166 offset:35584
  ds_write_b32 v249, v248 offset:35072
  v_lshlrev_b32 v250, 16, v169
  ds_write_b32 v249, v250 offset:34048
  v_mov_b32 v250, 0
  ds_write_b32 v249, v250 offset:38912
L_ff_j:
  v_mfma_f32_32x32x16_bf16 v[144:159], v[40:43], v[28:31], v[144:159]
  s_waitcnt lgkmcnt(10)
  s_waitcnt vmcnt(7)
  s_barrier
  v_mfma_f32_32x32x16_bf16 v[64:79], v[52:55], v[44:47], v[64:79]
  ds_read_b128 v[24:27], v10 offset:0
  ds_read_b64_tr_b16 v[32:33], v18 offset:0
  ds_read_b64_tr_b16 v[34:35], v18 offset:1024
  v_mfma_f32_32x32x16_bf16 v[80:95], v[52:55], v[48:51], v[80:95]
  ds_read_b128 v[28:31], v10 offset:4096
  ds_read_b64_tr_b16 v[36:37], v19 offset:0
  ds_read_b64_tr_b16 v[38:39], v19 offset:1024
  s_add_u32 m0, s84, 149504
  s_mov_b32 s13, 1634304
  buffer_load_dwordx4 v5, s[60:63], s13 offen lds
  s_add_u32 m0, s89, 125952
  s_mov_b32 s13, 13184
  buffer_load_dwordx4 v2, s[52:55], s13 offen lds
  v_mfma_f32_32x32x16_bf16 v[96:111], v[56:59], v[44:47], v[96:111]
  ds_read_b64_tr_b16 v[40:41], v20 offset:0
  ds_read_b64_tr_b16 v[42:43], v20 offset:1024
  s_add_u32 m0, s84, 150528
  s_mov_b32 s13, 1648640
  buffer_load_dwordx4 v5, s[60:63], s13 offen lds
  v_mfma_f32_32x32x16_bf16 v[112:127], v[56:59], v[48:51], v[112:127]
  s_and_b32 s95, s5, 7
  s_lshr_b32 s96, s5, 3
  s_mul_i32 s94, s3, 458752
  v_lshrrev_b32 v250, 3, v0
  v_and_b32 v251, 7, v0
  v_bfe_u32 v252, v250, 1, 1
  v_lshlrev_b32 v252, 2, v252
  v_xor_b32 v252, v252, v251
  v_lshlrev_b32 v252, 4, v252
  v_lshl_add_u32 v1, v250, 10, v252
  s_lshl_b32 s10, s95, 7
  v_add_u32 v1, s10, v1
  v_mfma_f32_32x32x16_bf16 v[128:143], v[60:63], v[44:47], v[128:143]
  v_lshrrev_b32 v252, 1, v250
  v_xor_b32 v252, v252, v251
  v_lshlrev_b32 v252, 4, v252
  v_lshl_add_u32 v2, v250, 10, v252
  s_lshl_b32 s10, s95, 16
  s_lshl_b32 s11, s3, 8
  s_add_u32 s10, s10, s11
  v_add_u32 v2, s10, v2
  v_xor_b32 v3, 64, v2
  v_mfma_f32_32x32x16_bf16 v[144:159], v[60:63], v[48:51], v[144:159]
  s_mov_b32 s68, s40
  s_and_b32 s69, s41, 0xffff
  s_mov_b32 s70, 1835008
  s_mov_b32 s71, 0x20000
  s_mov_b32 s72, s26
  s_and_b32 s73, s27, 0xffff
  s_mov_b32 s74, 524288
  s_mov_b32 s75, 0x20000
  s_mov_b32 s76, s28
  s_and_b32 s77, s29, 0xffff
  s_mov_b32 s78, 524288
  s_mov_b32 s79, 0x20000
  s_waitcnt lgkmcnt(0)
  v_mfma_f32_32x32x16_bf16 v[64:79], v[32:35], v[24:27], v[64:79]
  ds_read_b128 v[44:47], v11 offset:0
  ds_read_b64_tr_b16 v[52:53], v18 offset:4096
  ds_read_b64_tr_b16 v[54:55], v18 offset:5120
  v_mfma_f32_32x32x16_bf16 v[80:95], v[32:35], v[28:31], v[80:95]
  ds_read_b128 v[48:51], v11 offset:4096
  ds_read_b64_tr_b16 v[56:57], v19 offset:4096
  ds_read_b64_tr_b16 v[58:59], v19 offset:5120
  s_add_u32 m0, s86, 0
  s_add_u32 s13, s94, 0
  buffer_load_dwordx4 v1, s[68:71], s13 offen lds
  v_mfma_f32_32x32x16_bf16 v[96:111], v[36:39], v[24:27], v[96:111]
  ds_read_b64_tr_b16 v[60:61], v20 offset:4096
  ds_read_b64_tr_b16 v[62:63], v20 offset:5120
  s_add_u32 m0, s86, 1024
  s_add_u32 s13, s94, 8192
  buffer_load_dwordx4 v1, s[68:71], s13 offen lds
  v_mfma_f32_32x32x16_bf16 v[112:127], v[36:39], v[28:31], v[112:127]
  s_add_u32 m0, s86, 2048
  s_add_u32 s13, s94, 16384
  buffer_load_dwordx4 v1, s[68:71], s13 offen lds
  v_mfma_f32_32x32x16_bf16 v[128:143], v[40:43], v[24:27], v[128:143]
  s_add_u32 m0, s86, 3072
  s_add_u32 s13, s94, 24576
  buffer_load_dwordx4 v1, s[68:71], s13 offen lds
  v_mfma_f32_32x32x16_bf16 v[144:159], v[40:43], v[28:31], v[144:159]
  s_waitcnt lgkmcnt(0)
  v_mfma_f32_32x32x16_bf16 v[64:79], v[52:55], v[44:47], v[64:79]
  ds_read_b128 v[24:27], v12 offset:0
  ds_read_b64_tr_b16 v[32:33], v18 offset:8192
  ds_read_b64_tr_b16 v[34:35], v18 offset:9216
  v_mfma_f32_32x32x16_bf16 v[80:95], v[52:55], v[48:51], v[80:95]
  ds_read_b128 v[28:31], v12 offset:4096
  ds_read_b64_tr_b16 v[36:37], v19 offset:8192
  ds_read_b64_tr_b16 v[38:39], v19 offset:9216
  s_add_u32 m0, s86, 4096
  s_add_u32 s13, s94, 32768
  buffer_load_dwordx4 v1, s[68:71], s13 offen lds
  v_mfma_f32_32x32x16_bf16 v[96:111], v[56:59], v[44:47], v[96:111]
  ds_read_b64_tr_b16 v[40:41], v20 offset:8192
  ds_read_b64_tr_b16 v[42:43], v20 offset:9216
  s_add_u32 m0, s86, 5120
  s_add_u32 s13, s94, 40960
  buffer_load_dwordx4 v1, s[68:71], s13 offen lds
  v_mfma_f32_32x32x16_bf16 v[112:127], v[56:59], v[48:51], v[112:127]
  s_add_u32 m0, s86, 6144
  s_add_u32 s13, s94, 49152
  buffer_load_dwordx4 v1, s[68:71], s13 offen lds
  v_mfma_f32_32x32x16_bf16 v[128:143], v[60:63], v[44:47], v[128:143]
  s_add_u32 m0, s86, 7168
  s_add_u32 s13, s94, 57344
  buffer_load_dwordx4 v1, s[68:71], s13 offen lds
  v_mfma_f32_32x32x16_bf16 v[144:159], v[60:63], v[48:51], v[144:159]
  s_waitcnt lgkmcnt(0)
  v_mfma_f32_32x32x16_bf16 v[64:79], v[32:35], v[24:27], v[64:79]
  ds_read_b128 v[44:47], v13 offset:0
  ds_read_b64_tr_b16 v[52:53], v18 offset:12288
  ds_read_b64_tr_b16 v[54:55], v18 offset:13312
  v_mfma_f32_32x32x16_bf16 v[80:95], v[32:35], v[28:31], v[80:95]
  ds_read_b128 v[48:51], v13 offset:4096
  ds_read_b64_tr_b16 v[56:57], v19 offset:12288
  ds_read_b64_tr_b16 v[58:59], v19 offset:13312
  s_add_u32 m0, s86, 40960
  s_add_u32 s13, s94, 65536
  buffer_load_dwordx4 v1, s[68:71], s13 offen lds
  v_mfma_f32_32x32x16_bf16 v[96:111], v[36:39], v[24:27], v[96:111]
  ds_read_b64_tr_b16 v[60:61], v20 offset:12288
  ds_read_b64_tr_b16 v[62:63], v20 offset:13312
  s_add_u32 m0, s86, 41984
  s_add_u32 s13, s94, 73728
  buffer_load_dwordx4 v1, s[68:71], s13 offen lds
  v_mfma_f32_32x32x16_bf16 v[112:127], v[36:39], v[28:31], v[112:127]
  s_add_u32 m0, s86, 43008
  s_add_u32 s13, s94, 81920
  buffer_load_dwordx4 v1, s[68:71], s13 offen lds
  v_mfma_f32_32x32x16_bf16 v[128:143], v[40:43], v[24:27], v[128:143]
  s_add_u32 m0, s86, 44032
  s_add_u32 s13, s94, 90112
  buffer_load_dwordx4 v1, s[68:71], s13 offen lds
  v_mfma_f32_32x32x16_bf16 v[144:159], v[40:43], v[28:31], v[144:159]
  s_waitcnt lgkmcnt(0)
  s_waitcnt vmcnt(12)
  s_barrier
  v_mfma_f32_32x32x16_bf16 v[64:79], v[52:55], v[44:47], v[64:79]
  ds_read_b128 v[24:27], v10 offset:40960
  ds_read_b64_tr_b16 v[32:33], v18 offset:40960
  ds_read_b64_tr_b16 v[34:35], v18 offset:41984
  v_mfma_f32_32x32x16_bf16 v[80:95], v[52:55], v[48:51], v[80:95]
  ds_read_b128 v[28:31], v10 offset:45056
  ds_read_b64_tr_b16 v[36:37], v19 offset:40960
  ds_read_b64_tr_b16 v[38:39], v19 offset:41984
  s_add_u32 m0, s86, 45056
  s_add_u32 s13, s94, 98304
  buffer_load_dwordx4 v1, s[68:71], s13 offen lds
  v_mfma_f32_32x32x16_bf16 v[96:111], v[56:59], v[44:47], v[96:111]
  ds_read_b64_tr_b16 v[40:41], v20 offset:40960
  ds_read_b64_tr_b16 v[42:43], v20 offset:41984
  s_add_u32 m0, s86, 46080
  s_add_u32 s13, s94, 106496
  buffer_load_dwordx4 v1, s[68:71], s13 offen lds
  v_mfma_f32_32x32x16_bf16 v[112:127], v[56:59], v[48:51], v[112:127]
  s_add_u32 m0, s86, 47104
  s_add_u32 s13, s94, 114688
  buffer_load_dwordx4 v1, s[68:71], s13 offen lds
  v_mfma_f32_32x32x16_bf16 v[128:143], v[60:63], v[44:47], v[128:143]
  s_add_u32 m0, s86, 48128
  s_add_u32 s13, s94, 122880
  buffer_load_dwordx4 v1, s[68:71], s13 offen lds
  v_mfma_f32_32x32x16_bf16 v[144:159], v[60:63], v[48:51], v[144:159]
  s_waitcnt lgkmcnt(0)
  v_mfma_f32_32x32x16_bf16 v[64:79], v[32:35], v[24:27], v[64:79]
  ds_read_b128 v[44:47], v11 offset:40960
  ds_read_b64_tr_b16 v[52:53], v18 offset:45056
  ds_read_b64_tr_b16 v[54:55], v18 offset:46080
  v_mfma_f32_32x32x16_bf16 v[80:95], v[32:35], v[28:31], v[80:95]
  ds_read_b128 v[48:51], v11 offset:45056
  ds_read_b64_tr_b16 v[56:57], v19 offset:45056
  ds_read_b64_tr_b16 v[58:59], v19 offset:46080
  s_add_u32 m0, s86, 81920
  s_add_u32 s13, s94, 131072
  buffer_load_dwordx4 v1, s[68:71], s13 offen lds
  v_mfma_f32_32x32x16_bf16 v[96:111], v[36:39], v[24:27], v[96:111]
  ds_read_b64_tr_b16 v[60:61], v20 offset:45056
  ds_read_b64_tr_b16 v[62:63], v20 offset:46080
  s_add_u32 m0, s86, 82944
  s_add_u32 s13, s94, 139264
  buffer_load_dwordx4 v1, s[68:71], s13 offen lds
  v_mfma_f32_32x32x16_bf16 v[112:127], v[36:39], v[28:31], v[112:127]
  v_mfma_f32_32x32x16_bf16 v[128:143], v[40:43], v[24:27], v[128:143]
  s_add_u32 m0, s86, 83968
  s_add_u32 s13, s94, 147456
  buffer_load_dwordx4 v1, s[68:71], s13 offen lds
  v_mfma_f32_32x32x16_bf16 v[144:159], v[40:43], v[28:31], v[144:159]
  s_waitcnt lgkmcnt(0)
  v_mfma_f32_32x32x16_bf16 v[64:79], v[52:55], v[44:47], v[64:79]
  ds_read_b128 v[24:27], v12 offset:40960
  ds_read_b64_tr_b16 v[32:33], v18 offset:49152
  ds_read_b64_tr_b16 v[34:35], v18 offset:50176
  v_mfma_f32_32x32x16_bf16 v[80:95], v[52:55], v[48:51], v[80:95]
  ds_read_b128 v[28:31], v12 offset:45056
  ds_read_b64_tr_b16 v[36:37], v19 offset:49152
  ds_read_b64_tr_b16 v[38:39], v19 offset:50176
  s_add_u32 m0, s86, 84992
  s_add_u32 s13, s94, 155648
  buffer_load_dwordx4 v1, s[68:71], s13 offen lds
  v_mfma_f32_32x32x16_bf16 v[96:111], v[56:59], v[44:47], v[96:111]
  ds_read_b64_tr_b16 v[40:41], v20 offset:49152
  ds_read_b64_tr_b16 v[42:43], v20 offset:50176
  s_add_u32 m0, s86, 86016
  s_add_u32 s13, s94, 163840
  buffer_load_dwordx4 v1, s[68:71], s13 offen lds
  v_mfma_f32_32x32x16_bf16 v[112:127], v[56:59], v[48:51], v[112:127]
  v_mfma_f32_32x32x16_bf16 v[128:143], v[60:63], v[44:47], v[128:143]
  s_add_u32 m0, s86, 87040
  s_add_u32 s13, s94, 172032
  buffer_load_dwordx4 v1, s[68:71], s13 offen lds
  v_mfma_f32_32x32x16_bf16 v[144:159], v[60:63], v[48:51], v[144:159]
  s_waitcnt lgkmcnt(0)
  v_mfma_f32_32x32x16_bf16 v[64:79], v[32:35], v[24:27], v[64:79]
  ds_read_b128 v[44:47], v13 offset:40960
  ds_read_b64_tr_b16 v[52:53], v18 offset:53248
  ds_read_b64_tr_b16 v[54:55], v18 offset:54272
  v_mfma_f32_32x32x16_bf16 v[80:95], v[32:35], v[28:31], v[80:95]
  ds_read_b128 v[48:51], v13 offset:45056
  ds_read_b64_tr_b16 v[56:57], v19 offset:53248
  ds_read_b64_tr_b16 v[58:59], v19 offset:54272
  s_add_u32 m0, s86, 88064
  s_add_u32 s13, s94, 180224
  buffer_load_dwordx4 v1, s[68:71], s13 offen lds
  v_mfma_f32_32x32x16_bf16 v[96:111], v[36:39], v[24:27], v[96:111]
  ds_read_b64_tr_b16 v[60:61], v20 offset:53248
  ds_read_b64_tr_b16 v[62:63], v20 offset:54272
  v_mfma_f32_32x32x16_bf16 v[112:127], v[36:39], v[28:31], v[112:127]
  s_add_u32 m0, s86, 89088
  s_add_u32 s13, s94, 188416
  buffer_load_dwordx4 v1, s[68:71], s13 offen lds
  v_mfma_f32_32x32x16_bf16 v[128:143], v[40:43], v[24:27], v[128:143]
  v_mfma_f32_32x32x16_bf16 v[144:159], v[40:43], v[28:31], v[144:159]
  s_waitcnt lgkmcnt(0)
  s_barrier
  v_mfma_f32_32x32x16_bf16 v[64:79], v[52:55], v[44:47], v[64:79]
  v_mfma_f32_32x32x16_bf16 v[80:95], v[52:55], v[48:51], v[80:95]
  s_add_u32 m0, s86, 122880
  s_add_u32 s13, s94, 196608
  buffer_load_dwordx4 v1, s[68:71], s13 offen lds
  s_add_u32 m0, s86, 123904
  s_add_u32 s13, s94, 204800
  buffer_load_dwordx4 v1, s[68:71], s13 offen lds
  v_mfma_f32_32x32x16_bf16 v[96:111], v[56:59], v[44:47], v[96:111]
  s_add_u32 m0, s86, 124928
  s_add_u32 s13, s94, 212992
  buffer_load_dwordx4 v1, s[68:71], s13 offen lds
  s_add_u32 m0, s86, 125952
  s_add_u32 s13, s94, 221184
  buffer_load_dwordx4 v1, s[68:71], s13 offen lds
  v_mfma_f32_32x32x16_bf16 v[112:127], v[56:59], v[48:51], v[112:127]
  s_add_u32 m0, s86, 126976
  s_add_u32 s13, s94, 229376
  buffer_load_dwordx4 v1, s[68:71], s13 offen lds
  v_mfma_f32_32x32x16_bf16 v[128:143], v[60:63], v[44:47], v[128:143]
  s_add_u32 m0, s86, 128000
  s_add_u32 s13, s94, 237568
  buffer_load_dwordx4 v1, s[68:71], s13 offen lds
  s_add_u32 m0, s86, 129024
  s_add_u32 s13, s94, 245760
  buffer_load_dwordx4 v1, s[68:71], s13 offen lds
  v_mfma_f32_32x32x16_bf16 v[144:159], v[60:63], v[48:51], v[144:159]
  s_add_u32 m0, s86, 130048
  s_add_u32 s13, s94, 253952
  buffer_load_dwordx4 v1, s[68:71], s13 offen lds
  s_nop 15
  v_lshrrev_b32 v13, 4, v0
  v_bfe_u32 v14, v0, 2, 2
  v_and_b32 v15, 3, v0
  v_lshrrev_b32 v16, 1, v13
  v_lshl_add_u32 v16, v16, 2, v14
  v_lshlrev_b32 v16, 7, v16
  v_and_b32 v13, 1, v13
  v_lshl_add_u32 v16, v13, 5, v16
  v_lshl_add_u32 v16, v15, 3, v16
  v_add_u32 v16, s86, v16
  v_bfe_u32 v14, v0, 3, 1
  v_xor_b32 v14, s6, v14
  v_lshl_add_u32 v4, v14, 6, v16
  v_xor_b32 v14, 1, v14
  v_lshl_add_u32 v5, v14, 6, v16
  v_and_b32 v13, 31, v0
  v_lshrrev_b32 v14, 5, v0
  v_lshrrev_b32 v15, 1, v13
  v_and_b32 v15, 7, v15
  v_xor_b32 v15, v15, v14
  v_lshlrev_b32 v15, 4, v15
  v_lshl_add_u32 v15, v13, 7, v15
  s_lshl_b32 s10, s6, 12
  s_add_u32 s10, s10, s86
  v_xor_b32 v16, 0, v15
  v_add_u32 v6, s10, v16
  v_xor_b32 v16, 32, v15
  v_add_u32 v7, s10, v16
  v_xor_b32 v16, 64, v15
  v_add_u32 v8, s10, v16
  v_xor_b32 v16, 96, v15
  v_add_u32 v9, s10, v16
  v_lshlrev_b32 v10, 4, v0
  s_lshl_b32 s10, s4, 2
  s_lshl_b32 s11, s6, 1
  s_add_u32 s10, s10, s11
  s_add_u32 s11, s10, s7
  s_xor_b32 s12, s11, 1
  s_lshr_b32 s13, s5, 2
  s_mul_i32 s13, s13, 45056
  s_add_u32 s13, s13, 1048576
  s_mul_i32 s11, s11, 180224
  s_mul_i32 s12, s12, 180224
  s_add_u32 s97, s11, s13
  s_add_u32 s98, s12, s13
  s_bfe_u32 s10, s5, 0x10001
  s_mul_i32 s99, s10, 7
  s_waitcnt vmcnt(24)
  v_add_u32 v11, 0, v4
  v_add_u32 v12, 0, v5
  ds_read_b64_tr_b16 a[0:1], v11 offset:0
  ds_read_b64_tr_b16 a[2:3], v11 offset:1024
  ds_read_b64_tr_b16 a[4:5], v12 offset:0
  ds_read_b64_tr_b16 a[6:7], v12 offset:1024
  ds_read_b64_tr_b16 a[8:9], v11 offset:2048
  ds_read_b64_tr_b16 a[10:11], v11 offset:3072
  ds_read_b64_tr_b16 a[12:13], v12 offset:2048
  ds_read_b64_tr_b16 a[14:15], v12 offset:3072
  ds_read_b64_tr_b16 a[16:17], v11 offset:4096
  ds_read_b64_tr_b16 a[18:19], v11 offset:5120
  ds_read_b64_tr_b16 a[20:21], v12 offset:4096
  ds_read_b64_tr_b16 a[22:23], v12 offset:5120
  ds_read_b64_tr_b16 a[24:25], v11 offset:6144
  ds_read_b64_tr_b16 a[26:27], v11 offset:7168
  ds_read_b64_tr_b16 a[28:29], v12 offset:6144
  ds_read_b64_tr_b16 a[30:31], v12 offset:7168
  s_waitcnt vmcnt(16)
  v_add_u32 v11, 40960, v4
  v_add_u32 v12, 40960, v5
  ds_read_b64_tr_b16 a[32:33], v11 offset:0
  ds_read_b64_tr_b16 a[34:35], v11 offset:1024
  ds_read_b64_tr_b16 a[36:37], v12 offset:0
  ds_read_b64_tr_b16 a[38:39], v12 offset:1024
  ds_read_b64_tr_b16 a[40:41], v11 offset:2048
  ds_read_b64_tr_b16 a[42:43], v11 offset:3072
  ds_read_b64_tr_b16 a[44:45], v12 offset:2048
  ds_read_b64_tr_b16 a[46:47], v12 offset:3072
  ds_read_b64_tr_b16 a[48:49], v11 offset:4096
  ds_read_b64_tr_b16 a[50:51], v11 offset:5120
  ds_read_b64_tr_b16 a[52:53], v12 offset:4096
  ds_read_b64_tr_b16 a[54:55], v12 offset:5120
  ds_read_b64_tr_b16 a[56:57], v11 offset:6144
  ds_read_b64_tr_b16 a[58:59], v11 offset:7168
  ds_read_b64_tr_b16 a[60:61], v12 offset:6144
  ds_read_b64_tr_b16 a[62:63], v12 offset:7168
  s_waitcnt vmcnt(8)
  v_add_u32 v11, 81920, v4
  v_add_u32 v12, 81920, v5
  ds_read_b64_tr_b16 a[64:65], v11 offset:0
  ds_read_b64_tr_b16 a[66:67], v11 offset:1024
  ds_read_b64_tr_b16 a[68:69], v12 offset:0
  ds_read_b64_tr_b16 a[70:71], v12 offset:1024
  ds_read_b64_tr_b16 a[72:73], v11 offset:2048
  ds_read_b64_tr_b16 a[74:75], v11 offset:3072
  ds_read_b64_tr_b16 a[76:77], v12 offset:2048
  ds_read_b64_tr_b16 a[78:79], v12 offset:3072
  ds_read_b64_tr_b16 a[80:81], v11 offset:4096
  ds_read_b64_tr_b16 a[82:83], v11 offset:5120
  ds_read_b64_tr_b16 a[84:85], v12 offset:4096
  ds_read_b64_tr_b16 a[86:87], v12 offset:5120
  ds_read_b64_tr_b16 a[88:89], v11 offset:6144
  ds_read_b64_tr_b16 a[90:91], v11 offset:7168
  ds_read_b64_tr_b16 a[92:93], v12 offset:6144
  ds_read_b64_tr_b16 a[94:95], v12 offset:7168
  s_waitcnt vmcnt(0)
  v_add_u32 v11, 122880, v4
  v_add_u32 v12, 122880, v5
  ds_read_b64_tr_b16 a[96:97], v11 offset:0
  ds_read_b64_tr_b16 a[98:99], v11 offset:1024
  ds_read_b64_tr_b16 a[100:101], v12 offset:0
  ds_read_b64_tr_b16 a[102:103], v12 offset:1024
  ds_read_b64_tr_b16 a[104:105], v11 offset:2048
  ds_read_b64_tr_b16 a[106:107], v11 offset:3072
  ds_read_b64_tr_b16 a[108:109], v12 offset:2048
  ds_read_b64_tr_b16 a[110:111], v12 offset:3072
  ds_read_b64_tr_b16 a[112:113], v11 offset:4096
  ds_read_b64_tr_b16 a[114:115], v11 offset:5120
  ds_read_b64_tr_b16 a[116:117], v12 offset:4096
  ds_read_b64_tr_b16 a[118:119], v12 offset:5120
  ds_read_b64_tr_b16 a[120:121], v11 offset:6144
  ds_read_b64_tr_b16 a[122:123], v11 offset:7168
  ds_read_b64_tr_b16 a[124:125], v12 offset:6144
  ds_read_b64_tr_b16 a[126:127], v12 offset:7168
  s_waitcnt lgkmcnt(0)
  v_mov_b32 v16, 0xbdd2d3e8
  v_mov_b32 v17, 0xc0135761
  v_and_b32 v13, 31, v0
  v_bfe_u32 v14, v13, 2, 1
  v_lshlrev_b32 v14, 4, v14
  v_lshrrev_b32 v15, 3, v13
  v_lshl_add_u32 v14, v15, 2, v14
  v_and_b32 v15, 3, v13
  v_add_u32 v14, v14, v15
  s_lshl_b32 s10, s6, 1
  s_xor_b32 s11, s7, 0
  s_add_u32 s10, s10, s11
  s_lshl_b32 s10, s10, 5
  v_add_u32 v14, s10, v14
  v_lshlrev_b32 v23, 2, v14
  ds_read_b32 v18, v23 offset:34304
  ds_read_b32 v19, v23 offset:34816
  v_and_b32 v13, 31, v0
  v_bfe_u32 v14, v13, 2, 1
  v_lshlrev_b32 v14, 4, v14
  v_lshrrev_b32 v15, 3, v13
  v_lshl_add_u32 v14, v15, 2, v14
  v_and_b32 v15, 3, v13
  v_add_u32 v14, v14, v15
  s_lshl_b32 s10, s6, 1
  s_xor_b32 s11, s7, 1
  s_add_u32 s10, s10, s11
  s_lshl_b32 s10, s10, 5
  v_add_u32 v14, s10, v14
  v_lshlrev_b32 v23, 2, v14
  ds_read_b32 v20, v23 offset:34304
  ds_read_b32 v21, v23 offset:34816
  v_lshrrev_b32 v13, 5, v0
  v_lshlrev_b32 v13, 4, v13
  s_lshl_b32 s10, s7, 7
  v_add_u32 v22, s10, v13
  s_waitcnt lgkmcnt(0)
  v_sub_f32 v19, 0, v19
  v_sub_f32 v21, 0, v21
  s_lshl_b32 s10, s7, 2
  s_add_u32 s10, s10, s99
  s_lshl_b32 s10, s10, 11
  s_add_u32 s14, s97, s10
  s_add_u32 s15, s98, s10
  ds_read_b128 v[24:27], v22 offset:32768
  ds_read_b128 v[40:43], v22 offset:33792
  ds_read_b128 v[28:31], v22 offset:32800
  ds_read_b128 v[44:47], v22 offset:33824
  ds_read_b128 v[32:35], v22 offset:32832
  ds_read_b128 v[48:51], v22 offset:33856
  ds_read_b128 v[36:39], v22 offset:32864
  ds_read_b128 v[52:55], v22 offset:33888
  s_waitcnt lgkmcnt(0)
  v_pk_fma_f32 v[56:57], v[24:25], v[18:19], v[40:41] op_sel:[0,1,0] op_sel_hi:[1,1,1]
  v_pk_fma_f32 v[58:59], v[26:27], v[18:19], v[42:43] op_sel:[0,1,0] op_sel_hi:[1,1,1]
  v_pk_fma_f32 v[60:61], v[28:29], v[18:19], v[44:45] op_sel:[0,1,0] op_sel_hi:[1,1,1]
  v_pk_fma_f32 v[62:63], v[30:31], v[18:19], v[46:47] op_sel:[0,1,0] op_sel_hi:[1,1,1]
  v_pk_fma_f32 v[64:65], v[64:65], v[18:19], v[56:57] op_sel:[0,0,0] op_sel_hi:[1,0,1]
  v_pk_fma_f32 v[66:67], v[66:67], v[18:19], v[58:59] op_sel:[0,0,0] op_sel_hi:[1,0,1]
  v_pk_fma_f32 v[68:69], v[68:69], v[18:19], v[60:61] op_sel:[0,0,0] op_sel_hi:[1,0,1]
  v_pk_fma_f32 v[70:71], v[70:71], v[18:19], v[62:63] op_sel:[0,0,0] op_sel_hi:[1,0,1]
  s_add_u32 m0, s86, 0
  s_add_u32 s13, s94, 262144
  buffer_load_dwordx4 v1, s[68:71], s13 offen lds
  v_pk_mul_f32 v[56:57], v[64:65], v[64:65]
  v_pk_mul_f32 v[58:59], v[66:67], v[66:67]
  v_pk_mul_f32 v[60:61], v[68:69], v[68:69]
  v_pk_mul_f32 v[62:63], v[70:71], v[70:71]
  v_pk_fma_f32 v[56:57], v[56:57], v[16:17], v[16:17] op_sel:[0,0,1] op_sel_hi:[1,0,1]
  v_pk_fma_f32 v[58:59], v[58:59], v[16:17], v[16:17] op_sel:[0,0,1] op_sel_hi:[1,0,1]
  v_pk_fma_f32 v[60:61], v[60:61], v[16:17], v[16:17] op_sel:[0,0,1] op_sel_hi:[1,0,1]
  v_pk_fma_f32 v[62:63], v[62:63], v[16:17], v[16:17] op_sel:[0,0,1] op_sel_hi:[1,0,1]
  v_pk_mul_f32 v[56:57], v[56:57], v[64:65]
  v_pk_mul_f32 v[58:59], v[58:59], v[66:67]
  v_pk_mul_f32 v[60:61], v[60:61], v[68:69]
  v_pk_mul_f32 v[62:63], v[62:63], v[70:71]
  s_add_u32 m0, s86, 1024
  s_add_u32 s13, s94, 270336
  buffer_load_dwordx4 v1, s[68:71], s13 offen lds
  v_exp_f32 v56, v56
  v_exp_f32 v57, v57
  v_exp_f32 v58, v58
  v_exp_f32 v59, v59
  v_exp_f32 v60, v60
  v_exp_f32 v61, v61
  v_exp_f32 v62, v62
  v_exp_f32 v63, v63
  s_add_u32 m0, s86, 2048
  s_add_u32 s13, s94, 278528
  buffer_load_dwordx4 v1, s[68:71], s13 offen lds
  v_pk_add_f32 v[56:57], v[56:57], 1.0
  v_pk_add_f32 v[58:59], v[58:59], 1.0
  v_pk_add_f32 v[60:61], v[60:61], 1.0
  v_pk_add_f32 v[62:63], v[62:63], 1.0
  v_rcp_f32 v56, v56
  v_rcp_f32 v57, v57
  v_rcp_f32 v58, v58
  v_rcp_f32 v59, v59
  s_add_u32 m0, s86, 3072
  s_add_u32 s13, s94, 286720
  buffer_load_dwordx4 v1, s[68:71], s13 offen lds
  v_rcp_f32 v60, v60
  v_rcp_f32 v61, v61
  v_rcp_f32 v62, v62
  v_rcp_f32 v63, v63
  v_pk_mul_f32 v[56:57], v[56:57], v[64:65]
  v_pk_mul_f32 v[58:59], v[58:59], v[66:67]
  v_pk_mul_f32 v[60:61], v[60:61], v[68:69]
  v_pk_mul_f32 v[62:63], v[62:63], v[70:71]
  s_add_u32 m0, s86, 4096
  s_add_u32 s13, s94, 294912
  buffer_load_dwordx4 v1, s[68:71], s13 offen lds
  v_cvt_pk_bf16_f32 v64, v56, v57
  v_cvt_pk_bf16_f32 v65, v58, v59
  v_cvt_pk_bf16_f32 v66, v60, v61
  v_cvt_pk_bf16_f32 v67, v62, v63
  v_pk_fma_f32 v[56:57], v[32:33], v[18:19], v[48:49] op_sel:[0,1,0] op_sel_hi:[1,1,1]
  v_pk_fma_f32 v[58:59], v[34:35], v[18:19], v[50:51] op_sel:[0,1,0] op_sel_hi:[1,1,1]
  v_pk_fma_f32 v[60:61], v[36:37], v[18:19], v[52:53] op_sel:[0,1,0] op_sel_hi:[1,1,1]
  v_pk_fma_f32 v[62:63], v[38:39], v[18:19], v[54:55] op_sel:[0,1,0] op_sel_hi:[1,1,1]
  v_pk_fma_f32 v[72:73], v[72:73], v[18:19], v[56:57] op_sel:[0,0,0] op_sel_hi:[1,0,1]
  v_pk_fma_f32 v[74:75], v[74:75], v[18:19], v[58:59] op_sel:[0,0,0] op_sel_hi:[1,0,1]
  v_pk_fma_f32 v[76:77], v[76:77], v[18:19], v[60:61] op_sel:[0,0,0] op_sel_hi:[1,0,1]
  v_pk_fma_f32 v[78:79], v[78:79], v[18:19], v[62:63] op_sel:[0,0,0] op_sel_hi:[1,0,1]
  s_add_u32 m0, s86, 5120
  s_add_u32 s13, s94, 303104
  buffer_load_dwordx4 v1, s[68:71], s13 offen lds
  v_pk_mul_f32 v[56:57], v[72:73], v[72:73]
  v_pk_mul_f32 v[58:59], v[74:75], v[74:75]
  v_pk_mul_f32 v[60:61], v[76:77], v[76:77]
  v_pk_mul_f32 v[62:63], v[78:79], v[78:79]
  v_pk_fma_f32 v[56:57], v[56:57], v[16:17], v[16:17] op_sel:[0,0,1] op_sel_hi:[1,0,1]
  v_pk_fma_f32 v[58:59], v[58:59], v[16:17], v[16:17] op_sel:[0,0,1] op_sel_hi:[1,0,1]
  v_pk_fma_f32 v[60:61], v[60:61], v[16:17], v[16:17] op_sel:[0,0,1] op_sel_hi:[1,0,1]
  v_pk_fma_f32 v[62:63], v[62:63], v[16:17], v[16:17] op_sel:[0,0,1] op_sel_hi:[1,0,1]
  v_pk_mul_f32 v[56:57], v[56:57], v[72:73]
  v_pk_mul_f32 v[58:59], v[58:59], v[74:75]
  v_pk_mul_f32 v[60:61], v[60:61], v[76:77]
  v_pk_mul_f32 v[62:63], v[62:63], v[78:79]
  s_add_u32 m0, s86, 6144
  s_add_u32 s13, s94, 311296
  buffer_load_dwordx4 v1, s[68:71], s13 offen lds
  v_exp_f32 v56, v56
  v_exp_f32 v57, v57
  v_exp_f32 v58, v58
  v_exp_f32 v59, v59
  v_exp_f32 v60, v60
  v_exp_f32 v61, v61
  v_exp_f32 v62, v62
  v_exp_f32 v63, v63
  s_add_u32 m0, s86, 7168
  s_add_u32 s13, s94, 319488
  buffer_load_dwordx4 v1, s[68:71], s13 offen lds
  v_pk_add_f32 v[56:57], v[56:57], 1.0
  v_pk_add_f32 v[58:59], v[58:59], 1.0
  v_pk_add_f32 v[60:61], v[60:61], 1.0
  v_pk_add_f32 v[62:63], v[62:63], 1.0
  v_rcp_f32 v56, v56
  v_rcp_f32 v57, v57
  v_rcp_f32 v58, v58
  v_rcp_f32 v59, v59
  s_add_u32 m0, s86, 40960
  s_add_u32 s13, s94, 327680
  buffer_load_dwordx4 v1, s[68:71], s13 offen lds
  v_rcp_f32 v60, v60
  v_rcp_f32 v61, v61
  v_rcp_f32 v62, v62
  v_rcp_f32 v63, v63
  v_pk_mul_f32 v[56:57], v[56:57], v[72:73]
  v_pk_mul_f32 v[58:59], v[58:59], v[74:75]
  v_pk_mul_f32 v[60:61], v[60:61], v[76:77]
  v_pk_mul_f32 v[62:63], v[62:63], v[78:79]
  s_add_u32 m0, s86, 41984
  s_add_u32 s13, s94, 335872
  buffer_load_dwordx4 v1, s[68:71], s13 offen lds
  v_cvt_pk_bf16_f32 v68, v56, v57
  v_cvt_pk_bf16_f32 v69, v58, v59
  v_cvt_pk_bf16_f32 v70, v60, v61
  v_cvt_pk_bf16_f32 v71, v62, v63
  v_pk_fma_f32 v[56:57], v[24:25], v[20:21], v[40:41] op_sel:[0,1,0] op_sel_hi:[1,1,1]
  v_pk_fma_f32 v[58:59], v[26:27], v[20:21], v[42:43] op_sel:[0,1,0] op_sel_hi:[1,1,1]
  v_pk_fma_f32 v[60:61], v[28:29], v[20:21], v[44:45] op_sel:[0,1,0] op_sel_hi:[1,1,1]
  v_pk_fma_f32 v[62:63], v[30:31], v[20:21], v[46:47] op_sel:[0,1,0] op_sel_hi:[1,1,1]
  v_pk_fma_f32 v[80:81], v[80:81], v[20:21], v[56:57] op_sel:[0,0,0] op_sel_hi:[1,0,1]
  v_pk_fma_f32 v[82:83], v[82:83], v[20:21], v[58:59] op_sel:[0,0,0] op_sel_hi:[1,0,1]
  v_pk_fma_f32 v[84:85], v[84:85], v[20:21], v[60:61] op_sel:[0,0,0] op_sel_hi:[1,0,1]
  v_pk_fma_f32 v[86:87], v[86:87], v[20:21], v[62:63] op_sel:[0,0,0] op_sel_hi:[1,0,1]
  s_add_u32 m0, s86, 43008
  s_add_u32 s13, s94, 344064
  buffer_load_dwordx4 v1, s[68:71], s13 offen lds
  v_pk_mul_f32 v[56:57], v[80:81], v[80:81]
  v_pk_mul_f32 v[58:59], v[82:83], v[82:83]
  v_pk_mul_f32 v[60:61], v[84:85], v[84:85]
  v_pk_mul_f32 v[62:63], v[86:87], v[86:87]
  v_pk_fma_f32 v[56:57], v[56:57], v[16:17], v[16:17] op_sel:[0,0,1] op_sel_hi:[1,0,1]
  v_pk_fma_f32 v[58:59], v[58:59], v[16:17], v[16:17] op_sel:[0,0,1] op_sel_hi:[1,0,1]
  v_pk_fma_f32 v[60:61], v[60:61], v[16:17], v[16:17] op_sel:[0,0,1] op_sel_hi:[1,0,1]
  v_pk_fma_f32 v[62:63], v[62:63], v[16:17], v[16:17] op_sel:[0,0,1] op_sel_hi:[1,0,1]
  v_pk_mul_f32 v[56:57], v[56:57], v[80:81]
  v_pk_mul_f32 v[58:59], v[58:59], v[82:83]
  v_pk_mul_f32 v[60:61], v[60:61], v[84:85]
  v_pk_mul_f32 v[62:63], v[62:63], v[86:87]
  s_add_u32 m0, s86, 44032
  s_add_u32 s13, s94, 352256
  buffer_load_dwordx4 v1, s[68:71], s13 offen lds
  v_exp_f32 v56, v56
  v_exp_f32 v57, v57
  v_exp_f32 v58, v58
  v_exp_f32 v59, v59
  v_exp_f32 v60, v60
  v_exp_f32 v61, v61
  v_exp_f32 v62, v62
  v_exp_f32 v63, v63
  s_add_u32 m0, s86, 45056
  s_add_u32 s13, s94, 360448
  buffer_load_dwordx4 v1, s[68:71], s13 offen lds
  v_pk_add_f32 v[56:57], v[56:57], 1.0
  v_pk_add_f32 v[58:59], v[58:59], 1.0
  v_pk_add_f32 v[60:61], v[60:61], 1.0
  v_pk_add_f32 v[62:63], v[62:63], 1.0
  v_rcp_f32 v56, v56
  v_rcp_f32 v57, v57
  v_rcp_f32 v58, v58
  v_rcp_f32 v59, v59
  s_add_u32 m0, s86, 46080
  s_add_u32 s13, s94, 368640
  buffer_load_dwordx4 v1, s[68:71], s13 offen lds
  v_rcp_f32 v60, v60
  v_rcp_f32 v61, v61
  v_rcp_f32 v62, v62
  v_rcp_f32 v63, v63
  v_pk_mul_f32 v[56:57], v[56:57], v[80:81]
  v_pk_mul_f32 v[58:59], v[58:59], v[82:83]
  v_pk_mul_f32 v[60:61], v[60:61], v[84:85]
  v_pk_mul_f32 v[62:63], v[62:63], v[86:87]
  s_add_u32 m0, s86, 47104
  s_add_u32 s13, s94, 376832
  buffer_load_dwordx4 v1, s[68:71], s13 offen lds
  v_cvt_pk_bf16_f32 v80, v56, v57
  v_cvt_pk_bf16_f32 v81, v58, v59
  v_cvt_pk_bf16_f32 v82, v60, v61
  v_cvt_pk_bf16_f32 v83, v62, v63
  v_pk_fma_f32 v[56:57], v[32:33], v[20:21], v[48:49] op_sel:[0,1,0] op_sel_hi:[1,1,1]
  v_pk_fma_f32 v[58:59], v[34:35], v[20:21], v[50:51] op_sel:[0,1,0] op_sel_hi:[1,1,1]
  v_pk_fma_f32 v[60:61], v[36:37], v[20:21], v[52:53] op_sel:[0,1,0] op_sel_hi:[1,1,1]
  v_pk_fma_f32 v[62:63], v[38:39], v[20:21], v[54:55] op_sel:[0,1,0] op_sel_hi:[1,1,1]
  v_pk_fma_f32 v[88:89], v[88:89], v[20:21], v[56:57] op_sel:[0,0,0] op_sel_hi:[1,0,1]
  v_pk_fma_f32 v[90:91], v[90:91], v[20:21], v[58:59] op_sel:[0,0,0] op_sel_hi:[1,0,1]
  v_pk_fma_f32 v[92:93], v[92:93], v[20:21], v[60:61] op_sel:[0,0,0] op_sel_hi:[1,0,1]
  v_pk_fma_f32 v[94:95], v[94:95], v[20:21], v[62:63] op_sel:[0,0,0] op_sel_hi:[1,0,1]
  s_add_u32 m0, s86, 48128
  s_add_u32 s13, s94, 385024
  buffer_load_dwordx4 v1, s[68:71], s13 offen lds
  v_pk_mul_f32 v[56:57], v[88:89], v[88:89]
  v_pk_mul_f32 v[58:59], v[90:91], v[90:91]
  v_pk_mul_f32 v[60:61], v[92:93], v[92:93]
  v_pk_mul_f32 v[62:63], v[94:95], v[94:95]
  v_pk_fma_f32 v[56:57], v[56:57], v[16:17], v[16:17] op_sel:[0,0,1] op_sel_hi:[1,0,1]
  v_pk_fma_f32 v[58:59], v[58:59], v[16:17], v[16:17] op_sel:[0,0,1] op_sel_hi:[1,0,1]
  v_pk_fma_f32 v[60:61], v[60:61], v[16:17], v[16:17] op_sel:[0,0,1] op_sel_hi:[1,0,1]
  v_pk_fma_f32 v[62:63], v[62:63], v[16:17], v[16:17] op_sel:[0,0,1] op_sel_hi:[1,0,1]
  v_pk_mul_f32 v[56:57], v[56:57], v[88:89]
  v_pk_mul_f32 v[58:59], v[58:59], v[90:91]
  v_pk_mul_f32 v[60:61], v[60:61], v[92:93]
  v_pk_mul_f32 v[62:63], v[62:63], v[94:95]
  s_add_u32 m0, s86, 81920
  s_add_u32 s13, s94, 393216
  buffer_load_dwordx4 v1, s[68:71], s13 offen lds
  v_exp_f32 v56, v56
  v_exp_f32 v57, v57
  v_exp_f32 v58, v58
  v_exp_f32 v59, v59
  v_exp_f32 v60, v60
  v_exp_f32 v61, v61
  v_exp_f32 v62, v62
  v_exp_f32 v63, v63
  s_add_u32 m0, s86, 82944
  s_add_u32 s13, s94, 401408
  buffer_load_dwordx4 v1, s[68:71], s13 offen lds
  v_pk_add_f32 v[56:57], v[56:57], 1.0
  v_pk_add_f32 v[58:59], v[58:59], 1.0
  v_pk_add_f32 v[60:61], v[60:61], 1.0
  v_pk_add_f32 v[62:63], v[62:63], 1.0
  v_rcp_f32 v56, v56
  v_rcp_f32 v57, v57
  v_rcp_f32 v58, v58
  v_rcp_f32 v59, v59
  s_add_u32 m0, s86, 83968
  s_add_u32 s13, s94, 409600
  buffer_load_dwordx4 v1, s[68:71], s13 offen lds
  v_rcp_f32 v60, v60
  v_rcp_f32 v61, v61
  v_rcp_f32 v62, v62
  v_rcp_f32 v63, v63
  v_pk_mul_f32 v[56:57], v[56:57], v[88:89]
  v_pk_mul_f32 v[58:59], v[58:59], v[90:91]
  v_pk_mul_f32 v[60:61], v[60:61], v[92:93]
  v_pk_mul_f32 v[62:63], v[62:63], v[94:95]
  s_add_u32 m0, s86, 84992
  s_add_u32 s13, s94, 417792
  buffer_load_dwordx4 v1, s[68:71], s13 offen lds
  v_cvt_pk_bf16_f32 v84, v56, v57
  v_cvt_pk_bf16_f32 v85, v58, v59
  v_cvt_pk_bf16_f32 v86, v60, v61
  v_cvt_pk_bf16_f32 v87, v62, v63
  ds_read_b128 v[24:27], v22 offset:32896
  ds_read_b128 v[40:43], v22 offset:33920
  ds_read_b128 v[28:31], v22 offset:32928
  ds_read_b128 v[44:47], v22 offset:33952
  ds_read_b128 v[32:35], v22 offset:32960
  ds_read_b128 v[48:51], v22 offset:33984
  ds_read_b128 v[36:39], v22 offset:32992
  ds_read_b128 v[52:55], v22 offset:34016
  s_waitcnt lgkmcnt(0)
  v_pk_fma_f32 v[56:57], v[24:25], v[18:19], v[40:41] op_sel:[0,1,0] op_sel_hi:[1,1,1]
  v_pk_fma_f32 v[58:59], v[26:27], v[18:19], v[42:43] op_sel:[0,1,0] op_sel_hi:[1,1,1]
  v_pk_fma_f32 v[60:61], v[28:29], v[18:19], v[44:45] op_sel:[0,1,0] op_sel_hi:[1,1,1]
  v_pk_fma_f32 v[62:63], v[30:31], v[18:19], v[46:47] op_sel:[0,1,0] op_sel_hi:[1,1,1]
  v_pk_fma_f32 v[96:97], v[96:97], v[18:19], v[56:57] op_sel:[0,0,0] op_sel_hi:[1,0,1]
  v_pk_fma_f32 v[98:99], v[98:99], v[18:19], v[58:59] op_sel:[0,0,0] op_sel_hi:[1,0,1]
  v_pk_fma_f32 v[100:101], v[100:101], v[18:19], v[60:61] op_sel:[0,0,0] op_sel_hi:[1,0,1]
  v_pk_fma_f32 v[102:103], v[102:103], v[18:19], v[62:63] op_sel:[0,0,0] op_sel_hi:[1,0,1]
  s_add_u32 m0, s86, 86016
  s_add_u32 s13, s94, 425984
  buffer_load_dwordx4 v1, s[68:71], s13 offen lds
  v_pk_mul_f32 v[56:57], v[96:97], v[96:97]
  v_pk_mul_f32 v[58:59], v[98:99], v[98:99]
  v_pk_mul_f32 v[60:61], v[100:101], v[100:101]
  v_pk_mul_f32 v[62:63], v[102:103], v[102:103]
  v_pk_fma_f32 v[56:57], v[56:57], v[16:17], v[16:17] op_sel:[0,0,1] op_sel_hi:[1,0,1]
  v_pk_fma_f32 v[58:59], v[58:59], v[16:17], v[16:17] op_sel:[0,0,1] op_sel_hi:[1,0,1]
  v_pk_fma_f32 v[60:61], v[60:61], v[16:17], v[16:17] op_sel:[0,0,1] op_sel_hi:[1,0,1]
  v_pk_fma_f32 v[62:63], v[62:63], v[16:17], v[16:17] op_sel:[0,0,1] op_sel_hi:[1,0,1]
  v_pk_mul_f32 v[56:57], v[56:57], v[96:97]
  v_pk_mul_f32 v[58:59], v[58:59], v[98:99]
  v_pk_mul_f32 v[60:61], v[60:61], v[100:101]
  v_pk_mul_f32 v[62:63], v[62:63], v[102:103]
  s_add_u32 m0, s86, 87040
  s_add_u32 s13, s94, 434176
  buffer_load_dwordx4 v1, s[68:71], s13 offen lds
  v_exp_f32 v56, v56
  v_exp_f32 v57, v57
  v_exp_f32 v58, v58
  v_exp_f32 v59, v59
  v_exp_f32 v60, v60
  v_exp_f32 v61, v61
  v_exp_f32 v62, v62
  v_exp_f32 v63, v63
  s_add_u32 m0, s86, 88064
  s_add_u32 s13, s94, 442368
  buffer_load_dwordx4 v1, s[68:71], s13 offen lds
  v_pk_add_f32 v[56:57], v[56:57], 1.0
  v_pk_add_f32 v[58:59], v[58:59], 1.0
  v_pk_add_f32 v[60:61], v[60:61], 1.0
  v_pk_add_f32 v[62:63], v[62:63], 1.0
  v_rcp_f32 v56, v56
  v_rcp_f32 v57, v57
  v_rcp_f32 v58, v58
  v_rcp_f32 v59, v59
  s_add_u32 m0, s86, 89088
  s_add_u32 s13, s94, 450560
  buffer_load_dwordx4 v1, s[68:71], s13 offen lds
  v_rcp_f32 v60, v60
  v_rcp_f32 v61, v61
  v_rcp_f32 v62, v62
  v_rcp_f32 v63, v63
  v_pk_mul_f32 v[56:57], v[56:57], v[96:97]
  v_pk_mul_f32 v[58:59], v[58:59], v[98:99]
  v_pk_mul_f32 v[60:61], v[60:61], v[100:101]
  v_pk_mul_f32 v[62:63], v[62:63], v[102:103]
  s_add_u32 m0, s86, 122880
  s_mov_b32 s13, 0
  buffer_load_dwordx4 v2, s[72:75], s13 offen lds
  v_cvt_pk_bf16_f32 v96, v56, v57
  v_cvt_pk_bf16_f32 v97, v58, v59
  v_cvt_pk_bf16_f32 v98, v60, v61
  v_cvt_pk_bf16_f32 v99, v62, v63
  v_pk_fma_f32 v[56:57], v[32:33], v[18:19], v[48:49] op_sel:[0,1,0] op_sel_hi:[1,1,1]
  v_pk_fma_f32 v[58:59], v[34:35], v[18:19], v[50:51] op_sel:[0,1,0] op_sel_hi:[1,1,1]
  v_pk_fma_f32 v[60:61], v[36:37], v[18:19], v[52:53] op_sel:[0,1,0] op_sel_hi:[1,1,1]
  v_pk_fma_f32 v[62:63], v[38:39], v[18:19], v[54:55] op_sel:[0,1,0] op_sel_hi:[1,1,1]
  v_pk_fma_f32 v[104:105], v[104:105], v[18:19], v[56:57] op_sel:[0,0,0] op_sel_hi:[1,0,1]
  v_pk_fma_f32 v[106:107], v[106:107], v[18:19], v[58:59] op_sel:[0,0,0] op_sel_hi:[1,0,1]
  v_pk_fma_f32 v[108:109], v[108:109], v[18:19], v[60:61] op_sel:[0,0,0] op_sel_hi:[1,0,1]
  v_pk_fma_f32 v[110:111], v[110:111], v[18:19], v[62:63] op_sel:[0,0,0] op_sel_hi:[1,0,1]
  s_add_u32 m0, s86, 123904
  s_mov_b32 s13, 8192
  buffer_load_dwordx4 v3, s[72:75], s13 offen lds
  v_pk_mul_f32 v[56:57], v[104:105], v[104:105]
  v_pk_mul_f32 v[58:59], v[106:107], v[106:107]
  v_pk_mul_f32 v[60:61], v[108:109], v[108:109]
  v_pk_mul_f32 v[62:63], v[110:111], v[110:111]
  v_pk_fma_f32 v[56:57], v[56:57], v[16:17], v[16:17] op_sel:[0,0,1] op_sel_hi:[1,0,1]
  v_pk_fma_f32 v[58:59], v[58:59], v[16:17], v[16:17] op_sel:[0,0,1] op_sel_hi:[1,0,1]
  v_pk_fma_f32 v[60:61], v[60:61], v[16:17], v[16:17] op_sel:[0,0,1] op_sel_hi:[1,0,1]
  v_pk_fma_f32 v[62:63], v[62:63], v[16:17], v[16:17] op_sel:[0,0,1] op_sel_hi:[1,0,1]
  v_pk_mul_f32 v[56:57], v[56:57], v[104:105]
  v_pk_mul_f32 v[58:59], v[58:59], v[106:107]
  v_pk_mul_f32 v[60:61], v[60:61], v[108:109]
  v_pk_mul_f32 v[62:63], v[62:63], v[110:111]
  s_add_u32 m0, s86, 124928
  s_mov_b32 s13, 16384
  buffer_load_dwordx4 v2, s[72:75], s13 offen lds
  v_exp_f32 v56, v56
  v_exp_f32 v57, v57
  v_exp_f32 v58, v58
  v_exp_f32 v59, v59
  v_exp_f32 v60, v60
  v_exp_f32 v61, v61
  v_exp_f32 v62, v62
  v_exp_f32 v63, v63
  s_add_u32 m0, s86, 125952
  s_mov_b32 s13, 24576
  buffer_load_dwordx4 v3, s[72:75], s13 offen lds
  v_pk_add_f32 v[56:57], v[56:57], 1.0
  v_pk_add_f32 v[58:59], v[58:59], 1.0
  v_pk_add_f32 v[60:61], v[60:61], 1.0
  v_pk_add_f32 v[62:63], v[62:63], 1.0
  v_rcp_f32 v56, v56
  v_rcp_f32 v57, v57
  v_rcp_f32 v58, v58
  v_rcp_f32 v59, v59
  s_add_u32 m0, s86, 126976
  s_mov_b32 s13, 32768
  buffer_load_dwordx4 v2, s[72:75], s13 offen lds
  v_rcp_f32 v60, v60
  v_rcp_f32 v61, v61
  v_rcp_f32 v62, v62
  v_rcp_f32 v63, v63
  v_pk_mul_f32 v[56:57], v[56:57], v[104:105]
  v_pk_mul_f32 v[58:59], v[58:59], v[106:107]
  v_pk_mul_f32 v[60:61], v[60:61], v[108:109]
  v_pk_mul_f32 v[62:63], v[62:63], v[110:111]
  s_add_u32 m0, s86, 128000
  s_mov_b32 s13, 40960
  buffer_load_dwordx4 v3, s[72:75], s13 offen lds
  v_cvt_pk_bf16_f32 v100, v56, v57
  v_cvt_pk_bf16_f32 v101, v58, v59
  v_cvt_pk_bf16_f32 v102, v60, v61
  v_cvt_pk_bf16_f32 v103, v62, v63
  v_pk_fma_f32 v[56:57], v[24:25], v[20:21], v[40:41] op_sel:[0,1,0] op_sel_hi:[1,1,1]
  v_pk_fma_f32 v[58:59], v[26:27], v[20:21], v[42:43] op_sel:[0,1,0] op_sel_hi:[1,1,1]
  v_pk_fma_f32 v[60:61], v[28:29], v[20:21], v[44:45] op_sel:[0,1,0] op_sel_hi:[1,1,1]
  v_pk_fma_f32 v[62:63], v[30:31], v[20:21], v[46:47] op_sel:[0,1,0] op_sel_hi:[1,1,1]
  v_pk_fma_f32 v[112:113], v[112:113], v[20:21], v[56:57] op_sel:[0,0,0] op_sel_hi:[1,0,1]
  v_pk_fma_f32 v[114:115], v[114:115], v[20:21], v[58:59] op_sel:[0,0,0] op_sel_hi:[1,0,1]
  v_pk_fma_f32 v[116:117], v[116:117], v[20:21], v[60:61] op_sel:[0,0,0] op_sel_hi:[1,0,1]
  v_pk_fma_f32 v[118:119], v[118:119], v[20:21], v[62:63] op_sel:[0,0,0] op_sel_hi:[1,0,1]
  v_pk_mul_f32 v[56:57], v[112:113], v[112:113]
  v_pk_mul_f32 v[58:59], v[114:115], v[114:115]
  v_pk_mul_f32 v[60:61], v[116:117], v[116:117]
  v_pk_mul_f32 v[62:63], v[118:119], v[118:119]
  v_pk_fma_f32 v[56:57], v[56:57], v[16:17], v[16:17] op_sel:[0,0,1] op_sel_hi:[1,0,1]
  v_pk_fma_f32 v[58:59], v[58:59], v[16:17], v[16:17] op_sel:[0,0,1] op_sel_hi:[1,0,1]
  v_pk_fma_f32 v[60:61], v[60:61], v[16:17], v[16:17] op_sel:[0,0,1] op_sel_hi:[1,0,1]
  v_pk_fma_f32 v[62:63], v[62:63], v[16:17], v[16:17] op_sel:[0,0,1] op_sel_hi:[1,0,1]
  v_pk_mul_f32 v[56:57], v[56:57], v[112:113]
  v_pk_mul_f32 v[58:59], v[58:59], v[114:115]
  v_pk_mul_f32 v[60:61], v[60:61], v[116:117]
  v_pk_mul_f32 v[62:63], v[62:63], v[118:119]
  s_add_u32 s13, s14, 0
  buffer_store_dwordx4 v[64:67], v10, s[64:67], s13 offen sc1
  v_exp_f32 v56, v56
  v_exp_f32 v57, v57
  v_exp_f32 v58, v58
  v_exp_f32 v59, v59
  v_exp_f32 v60, v60
  v_exp_f32 v61, v61
  v_exp_f32 v62, v62
  v_exp_f32 v63, v63
  v_pk_add_f32 v[56:57], v[56:57], 1.0
  v_pk_add_f32 v[58:59], v[58:59], 1.0
  v_pk_add_f32 v[60:61], v[60:61], 1.0
  v_pk_add_f32 v[62:63], v[62:63], 1.0
  v_rcp_f32 v56, v56
  v_rcp_f32 v57, v57
  v_rcp_f32 v58, v58
  v_rcp_f32 v59, v59
  s_add_u32 s13, s14, 1024
  buffer_store_dwordx4 v[68:71], v10, s[64:67], s13 offen sc1
  v_rcp_f32 v60, v60
  v_rcp_f32 v61, v61
  v_rcp_f32 v62, v62
  v_rcp_f32 v63, v63
  v_pk_mul_f32 v[56:57], v[56:57], v[112:113]
  v_pk_mul_f32 v[58:59], v[58:59], v[114:115]
  v_pk_mul_f32 v[60:61], v[60:61], v[116:117]
  v_pk_mul_f32 v[62:63], v[62:63], v[118:119]
  v_cvt_pk_bf16_f32 v112, v56, v57
  v_cvt_pk_bf16_f32 v113, v58, v59
  v_cvt_pk_bf16_f32 v114, v60, v61
  v_cvt_pk_bf16_f32 v115, v62, v63
  v_pk_fma_f32 v[56:57], v[32:33], v[20:21], v[48:49] op_sel:[0,1,0] op_sel_hi:[1,1,1]
  v_pk_fma_f32 v[58:59], v[34:35], v[20:21], v[50:51] op_sel:[0,1,0] op_sel_hi:[1,1,1]
  v_pk_fma_f32 v[60:61], v[36:37], v[20:21], v[52:53] op_sel:[0,1,0] op_sel_hi:[1,1,1]
  v_pk_fma_f32 v[62:63], v[38:39], v[20:21], v[54:55] op_sel:[0,1,0] op_sel_hi:[1,1,1]
  v_pk_fma_f32 v[120:121], v[120:121], v[20:21], v[56:57] op_sel:[0,0,0] op_sel_hi:[1,0,1]
  v_pk_fma_f32 v[122:123], v[122:123], v[20:21], v[58:59] op_sel:[0,0,0] op_sel_hi:[1,0,1]
  v_pk_fma_f32 v[124:125], v[124:125], v[20:21], v[60:61] op_sel:[0,0,0] op_sel_hi:[1,0,1]
  v_pk_fma_f32 v[126:127], v[126:127], v[20:21], v[62:63] op_sel:[0,0,0] op_sel_hi:[1,0,1]
  s_add_u32 s13, s15, 0
  buffer_store_dwordx4 v[80:83], v10, s[64:67], s13 offen sc1
  v_pk_mul_f32 v[56:57], v[120:121], v[120:121]
  v_pk_mul_f32 v[58:59], v[122:123], v[122:123]
  v_pk_mul_f32 v[60:61], v[124:125], v[124:125]
  v_pk_mul_f32 v[62:63], v[126:127], v[126:127]
  v_pk_fma_f32 v[56:57], v[56:57], v[16:17], v[16:17] op_sel:[0,0,1] op_sel_hi:[1,0,1]
  v_pk_fma_f32 v[58:59], v[58:59], v[16:17], v[16:17] op_sel:[0,0,1] op_sel_hi:[1,0,1]
  v_pk_fma_f32 v[60:61], v[60:61], v[16:17], v[16:17] op_sel:[0,0,1] op_sel_hi:[1,0,1]
  v_pk_fma_f32 v[62:63], v[62:63], v[16:17], v[16:17] op_sel:[0,0,1] op_sel_hi:[1,0,1]
  v_pk_mul_f32 v[56:57], v[56:57], v[120:121]
  v_pk_mul_f32 v[58:59], v[58:59], v[122:123]
  v_pk_mul_f32 v[60:61], v[60:61], v[124:125]
  v_pk_mul_f32 v[62:63], v[62:63], v[126:127]
  v_exp_f32 v56, v56
  v_exp_f32 v57, v57
  v_exp_f32 v58, v58
  v_exp_f32 v59, v59
  v_exp_f32 v60, v60
  v_exp_f32 v61, v61
  v_exp_f32 v62, v62
  v_exp_f32 v63, v63
  s_add_u32 s13, s15, 1024
  buffer_store_dwordx4 v[84:87], v10, s[64:67], s13 offen sc1
  v_pk_add_f32 v[56:57], v[56:57], 1.0
  v_pk_add_f32 v[58:59], v[58:59], 1.0
  v_pk_add_f32 v[60:61], v[60:61], 1.0
  v_pk_add_f32 v[62:63], v[62:63], 1.0
  v_rcp_f32 v56, v56
  v_rcp_f32 v57, v57
  v_rcp_f32 v58, v58
  v_rcp_f32 v59, v59
  v_rcp_f32 v60, v60
  v_rcp_f32 v61, v61
  v_rcp_f32 v62, v62
  v_rcp_f32 v63, v63
  v_pk_mul_f32 v[56:57], v[56:57], v[120:121]
  v_pk_mul_f32 v[58:59], v[58:59], v[122:123]
  v_pk_mul_f32 v[60:61], v[60:61], v[124:125]
  v_pk_mul_f32 v[62:63], v[62:63], v[126:127]
  s_add_u32 s13, s14, 2048
  buffer_store_dwordx4 v[96:99], v10, s[64:67], s13 offen sc1
  v_cvt_pk_bf16_f32 v116, v56, v57
  v_cvt_pk_bf16_f32 v117, v58, v59
  v_cvt_pk_bf16_f32 v118, v60, v61
  v_cvt_pk_bf16_f32 v119, v62, v63
  ds_read_b128 v[24:27], v22 offset:33024
  ds_read_b128 v[40:43], v22 offset:34048
  ds_read_b128 v[28:31], v22 offset:33056
  ds_read_b128 v[44:47], v22 offset:34080
  ds_read_b128 v[32:35], v22 offset:33088
  ds_read_b128 v[48:51], v22 offset:34112
  ds_read_b128 v[36:39], v22 offset:33120
  ds_read_b128 v[52:55], v22 offset:34144
  s_waitcnt lgkmcnt(0)
  v_pk_fma_f32 v[56:57], v[24:25], v[18:19], v[40:41] op_sel:[0,1,0] op_sel_hi:[1,1,1]
  v_pk_fma_f32 v[58:59], v[26:27], v[18:19], v[42:43] op_sel:[0,1,0] op_sel_hi:[1,1,1]
  v_pk_fma_f32 v[60:61], v[28:29], v[18:19], v[44:45] op_sel:[0,1,0] op_sel_hi:[1,1,1]
  v_pk_fma_f32 v[62:63], v[30:31], v[18:19], v[46:47] op_sel:[0,1,0] op_sel_hi:[1,1,1]
  v_pk_fma_f32 v[128:129], v[128:129], v[18:19], v[56:57] op_sel:[0,0,0] op_sel_hi:[1,0,1]
  v_pk_fma_f32 v[130:131], v[130:131], v[18:19], v[58:59] op_sel:[0,0,0] op_sel_hi:[1,0,1]
  v_pk_fma_f32 v[132:133], v[132:133], v[18:19], v[60:61] op_sel:[0,0,0] op_sel_hi:[1,0,1]
  v_pk_fma_f32 v[134:135], v[134:135], v[18:19], v[62:63] op_sel:[0,0,0] op_sel_hi:[1,0,1]
  v_pk_mul_f32 v[56:57], v[128:129], v[128:129]
  v_pk_mul_f32 v[58:59], v[130:131], v[130:131]
  v_pk_mul_f32 v[60:61], v[132:133], v[132:133]
  v_pk_mul_f32 v[62:63], v[134:135], v[134:135]
  v_pk_fma_f32 v[56:57], v[56:57], v[16:17], v[16:17] op_sel:[0,0,1] op_sel_hi:[1,0,1]
  v_pk_fma_f32 v[58:59], v[58:59], v[16:17], v[16:17] op_sel:[0,0,1] op_sel_hi:[1,0,1]
  v_pk_fma_f32 v[60:61], v[60:61], v[16:17], v[16:17] op_sel:[0,0,1] op_sel_hi:[1,0,1]
  v_pk_fma_f32 v[62:63], v[62:63], v[16:17], v[16:17] op_sel:[0,0,1] op_sel_hi:[1,0,1]
  v_pk_mul_f32 v[56:57], v[56:57], v[128:129]
  v_pk_mul_f32 v[58:59], v[58:59], v[130:131]
  v_pk_mul_f32 v[60:61], v[60:61], v[132:133]
  v_pk_mul_f32 v[62:63], v[62:63], v[134:135]
  s_add_u32 s13, s14, 3072
  buffer_store_dwordx4 v[100:103], v10, s[64:67], s13 offen sc1
  v_exp_f32 v56, v56
  v_exp_f32 v57, v57
  v_exp_f32 v58, v58
  v_exp_f32 v59, v59
  v_exp_f32 v60, v60
  v_exp_f32 v61, v61
  v_exp_f32 v62, v62
  v_exp_f32 v63, v63
  v_pk_add_f32 v[56:57], v[56:57], 1.0
  v_pk_add_f32 v[58:59], v[58:59], 1.0
  v_pk_add_f32 v[60:61], v[60:61], 1.0
  v_pk_add_f32 v[62:63], v[62:63], 1.0
  v_rcp_f32 v56, v56
  v_rcp_f32 v57, v57
  v_rcp_f32 v58, v58
  v_rcp_f32 v59, v59
  s_add_u32 s13, s15, 2048
  buffer_store_dwordx4 v[112:115], v10, s[64:67], s13 offen sc1
  v_rcp_f32 v60, v60
  v_rcp_f32 v61, v61
  v_rcp_f32 v62, v62
  v_rcp_f32 v63, v63
  v_pk_mul_f32 v[56:57], v[56:57], v[128:129]
  v_pk_mul_f32 v[58:59], v[58:59], v[130:131]
  v_pk_mul_f32 v[60:61], v[60:61], v[132:133]
  v_pk_mul_f32 v[62:63], v[62:63], v[134:135]
  v_cvt_pk_bf16_f32 v128, v56, v57
  v_cvt_pk_bf16_f32 v129, v58, v59
  v_cvt_pk_bf16_f32 v130, v60, v61
  v_cvt_pk_bf16_f32 v131, v62, v63
  v_pk_fma_f32 v[56:57], v[32:33], v[18:19], v[48:49] op_sel:[0,1,0] op_sel_hi:[1,1,1]
  v_pk_fma_f32 v[58:59], v[34:35], v[18:19], v[50:51] op_sel:[0,1,0] op_sel_hi:[1,1,1]
  v_pk_fma_f32 v[60:61], v[36:37], v[18:19], v[52:53] op_sel:[0,1,0] op_sel_hi:[1,1,1]
  v_pk_fma_f32 v[62:63], v[38:39], v[18:19], v[54:55] op_sel:[0,1,0] op_sel_hi:[1,1,1]
  v_pk_fma_f32 v[136:137], v[136:137], v[18:19], v[56:57] op_sel:[0,0,0] op_sel_hi:[1,0,1]
  v_pk_fma_f32 v[138:139], v[138:139], v[18:19], v[58:59] op_sel:[0,0,0] op_sel_hi:[1,0,1]
  v_pk_fma_f32 v[140:141], v[140:141], v[18:19], v[60:61] op_sel:[0,0,0] op_sel_hi:[1,0,1]
  v_pk_fma_f32 v[142:143], v[142:143], v[18:19], v[62:63] op_sel:[0,0,0] op_sel_hi:[1,0,1]
  s_add_u32 s13, s15, 3072
  buffer_store_dwordx4 v[116:119], v10, s[64:67], s13 offen sc1
  v_pk_mul_f32 v[56:57], v[136:137], v[136:137]
  v_pk_mul_f32 v[58:59], v[138:139], v[138:139]
  v_pk_mul_f32 v[60:61], v[140:141], v[140:141]
  v_pk_mul_f32 v[62:63], v[142:143], v[142:143]
  v_pk_fma_f32 v[56:57], v[56:57], v[16:17], v[16:17] op_sel:[0,0,1] op_sel_hi:[1,0,1]
  v_pk_fma_f32 v[58:59], v[58:59], v[16:17], v[16:17] op_sel:[0,0,1] op_sel_hi:[1,0,1]
  v_pk_fma_f32 v[60:61], v[60:61], v[16:17], v[16:17] op_sel:[0,0,1] op_sel_hi:[1,0,1]
  v_pk_fma_f32 v[62:63], v[62:63], v[16:17], v[16:17] op_sel:[0,0,1] op_sel_hi:[1,0,1]
  v_pk_mul_f32 v[56:57], v[56:57], v[136:137]
  v_pk_mul_f32 v[58:59], v[58:59], v[138:139]
  v_pk_mul_f32 v[60:61], v[60:61], v[140:141]
  v_pk_mul_f32 v[62:63], v[62:63], v[142:143]
  v_exp_f32 v56, v56
  v_exp_f32 v57, v57
  v_exp_f32 v58, v58
  v_exp_f32 v59, v59
  v_exp_f32 v60, v60
  v_exp_f32 v61, v61
  v_exp_f32 v62, v62
  v_exp_f32 v63, v63
  s_add_u32 s13, s14, 4096
  buffer_store_dwordx4 v[128:131], v10, s[64:67], s13 offen sc1
  v_pk_add_f32 v[56:57], v[56:57], 1.0
  v_pk_add_f32 v[58:59], v[58:59], 1.0
  v_pk_add_f32 v[60:61], v[60:61], 1.0
  v_pk_add_f32 v[62:63], v[62:63], 1.0
  v_rcp_f32 v56, v56
  v_rcp_f32 v57, v57
  v_rcp_f32 v58, v58
  v_rcp_f32 v59, v59
  v_rcp_f32 v60, v60
  v_rcp_f32 v61, v61
  v_rcp_f32 v62, v62
  v_rcp_f32 v63, v63
  v_pk_mul_f32 v[56:57], v[56:57], v[136:137]
  v_pk_mul_f32 v[58:59], v[58:59], v[138:139]
  v_pk_mul_f32 v[60:61], v[60:61], v[140:141]
  v_pk_mul_f32 v[62:63], v[62:63], v[142:143]
  v_cvt_pk_bf16_f32 v132, v56, v57
  v_cvt_pk_bf16_f32 v133, v58, v59
  v_cvt_pk_bf16_f32 v134, v60, v61
  v_cvt_pk_bf16_f32 v135, v62, v63
  v_pk_fma_f32 v[56:57], v[24:25], v[20:21], v[40:41] op_sel:[0,1,0] op_sel_hi:[1,1,1]
  v_pk_fma_f32 v[58:59], v[26:27], v[20:21], v[42:43] op_sel:[0,1,0] op_sel_hi:[1,1,1]
  v_pk_fma_f32 v[60:61], v[28:29], v[20:21], v[44:45] op_sel:[0,1,0] op_sel_hi:[1,1,1]
  v_pk_fma_f32 v[62:63], v[30:31], v[20:21], v[46:47] op_sel:[0,1,0] op_sel_hi:[1,1,1]
  v_pk_fma_f32 v[144:145], v[144:145], v[20:21], v[56:57] op_sel:[0,0,0] op_sel_hi:[1,0,1]
  v_pk_fma_f32 v[146:147], v[146:147], v[20:21], v[58:59] op_sel:[0,0,0] op_sel_hi:[1,0,1]
  v_pk_fma_f32 v[148:149], v[148:149], v[20:21], v[60:61] op_sel:[0,0,0] op_sel_hi:[1,0,1]
  v_pk_fma_f32 v[150:151], v[150:151], v[20:21], v[62:63] op_sel:[0,0,0] op_sel_hi:[1,0,1]
  v_pk_mul_f32 v[56:57], v[144:145], v[144:145]
  v_pk_mul_f32 v[58:59], v[146:147], v[146:147]
  v_pk_mul_f32 v[60:61], v[148:149], v[148:149]
  v_pk_mul_f32 v[62:63], v[150:151], v[150:151]
  v_pk_fma_f32 v[56:57], v[56:57], v[16:17], v[16:17] op_sel:[0,0,1] op_sel_hi:[1,0,1]
  v_pk_fma_f32 v[58:59], v[58:59], v[16:17], v[16:17] op_sel:[0,0,1] op_sel_hi:[1,0,1]
  v_pk_fma_f32 v[60:61], v[60:61], v[16:17], v[16:17] op_sel:[0,0,1] op_sel_hi:[1,0,1]
  v_pk_fma_f32 v[62:63], v[62:63], v[16:17], v[16:17] op_sel:[0,0,1] op_sel_hi:[1,0,1]
  v_pk_mul_f32 v[56:57], v[56:57], v[144:145]
  v_pk_mul_f32 v[58:59], v[58:59], v[146:147]
  v_pk_mul_f32 v[60:61], v[60:61], v[148:149]
  v_pk_mul_f32 v[62:63], v[62:63], v[150:151]
  s_add_u32 s13, s14, 5120
  buffer_store_dwordx4 v[132:135], v10, s[64:67], s13 offen sc1
  v_exp_f32 v56, v56
  v_exp_f32 v57, v57
  v_exp_f32 v58, v58
  v_exp_f32 v59, v59
  v_exp_f32 v60, v60
  v_exp_f32 v61, v61
  v_exp_f32 v62, v62
  v_exp_f32 v63, v63
  v_pk_add_f32 v[56:57], v[56:57], 1.0
  v_pk_add_f32 v[58:59], v[58:59], 1.0
  v_pk_add_f32 v[60:61], v[60:61], 1.0
  v_pk_add_f32 v[62:63], v[62:63], 1.0
  v_rcp_f32 v56, v56
  v_rcp_f32 v57, v57
  v_rcp_f32 v58, v58
  v_rcp_f32 v59, v59
  v_rcp_f32 v60, v60
  v_rcp_f32 v61, v61
  v_rcp_f32 v62, v62
  v_rcp_f32 v63, v63
  v_pk_mul_f32 v[56:57], v[56:57], v[144:145]
  v_pk_mul_f32 v[58:59], v[58:59], v[146:147]
  v_pk_mul_f32 v[60:61], v[60:61], v[148:149]
  v_pk_mul_f32 v[62:63], v[62:63], v[150:151]
  v_cvt_pk_bf16_f32 v144, v56, v57
  v_cvt_pk_bf16_f32 v145, v58, v59
  v_cvt_pk_bf16_f32 v146, v60, v61
  v_cvt_pk_bf16_f32 v147, v62, v63
  v_pk_fma_f32 v[56:57], v[32:33], v[20:21], v[48:49] op_sel:[0,1,0] op_sel_hi:[1,1,1]
  v_pk_fma_f32 v[58:59], v[34:35], v[20:21], v[50:51] op_sel:[0,1,0] op_sel_hi:[1,1,1]
  v_pk_fma_f32 v[60:61], v[36:37], v[20:21], v[52:53] op_sel:[0,1,0] op_sel_hi:[1,1,1]
  v_pk_fma_f32 v[62:63], v[38:39], v[20:21], v[54:55] op_sel:[0,1,0] op_sel_hi:[1,1,1]
  v_pk_fma_f32 v[152:153], v[152:153], v[20:21], v[56:57] op_sel:[0,0,0] op_sel_hi:[1,0,1]
  v_pk_fma_f32 v[154:155], v[154:155], v[20:21], v[58:59] op_sel:[0,0,0] op_sel_hi:[1,0,1]
  v_pk_fma_f32 v[156:157], v[156:157], v[20:21], v[60:61] op_sel:[0,0,0] op_sel_hi:[1,0,1]
  v_pk_fma_f32 v[158:159], v[158:159], v[20:21], v[62:63] op_sel:[0,0,0] op_sel_hi:[1,0,1]
  s_add_u32 s13, s15, 4096
  buffer_store_dwordx4 v[144:147], v10, s[64:67], s13 offen sc1
  v_pk_mul_f32 v[56:57], v[152:153], v[152:153]
  v_pk_mul_f32 v[58:59], v[154:155], v[154:155]
  v_pk_mul_f32 v[60:61], v[156:157], v[156:157]
  v_pk_mul_f32 v[62:63], v[158:159], v[158:159]
  v_pk_fma_f32 v[56:57], v[56:57], v[16:17], v[16:17] op_sel:[0,0,1] op_sel_hi:[1,0,1]
  v_pk_fma_f32 v[58:59], v[58:59], v[16:17], v[16:17] op_sel:[0,0,1] op_sel_hi:[1,0,1]
  v_pk_fma_f32 v[60:61], v[60:61], v[16:17], v[16:17] op_sel:[0,0,1] op_sel_hi:[1,0,1]
  v_pk_fma_f32 v[62:63], v[62:63], v[16:17], v[16:17] op_sel:[0,0,1] op_sel_hi:[1,0,1]
  v_pk_mul_f32 v[56:57], v[56:57], v[152:153]
  v_pk_mul_f32 v[58:59], v[58:59], v[154:155]
  v_pk_mul_f32 v[60:61], v[60:61], v[156:157]
  v_pk_mul_f32 v[62:63], v[62:63], v[158:159]
  v_exp_f32 v56, v56
  v_exp_f32 v57, v57
  v_exp_f32 v58, v58
  v_exp_f32 v59, v59
  v_exp_f32 v60, v60
  v_exp_f32 v61, v61
  v_exp_f32 v62, v62
  v_exp_f32 v63, v63
  v_pk_add_f32 v[56:57], v[56:57], 1.0
  v_pk_add_f32 v[58:59], v[58:59], 1.0
  v_pk_add_f32 v[60:61], v[60:61], 1.0
  v_pk_add_f32 v[62:63], v[62:63], 1.0
  v_rcp_f32 v56, v56
  v_rcp_f32 v57, v57
  v_rcp_f32 v58, v58
  v_rcp_f32 v59, v59
  v_rcp_f32 v60, v60
  v_rcp_f32 v61, v61
  v_rcp_f32 v62, v62
  v_rcp_f32 v63, v63
  v_pk_mul_f32 v[56:57], v[56:57], v[152:153]
  v_pk_mul_f32 v[58:59], v[58:59], v[154:155]
  v_pk_mul_f32 v[60:61], v[60:61], v[156:157]
  v_pk_mul_f32 v[62:63], v[62:63], v[158:159]
  v_cvt_pk_bf16_f32 v148, v56, v57
  v_cvt_pk_bf16_f32 v149, v58, v59
  v_cvt_pk_bf16_f32 v150, v60, v61
  v_cvt_pk_bf16_f32 v151, v62, v63
  s_add_u32 s13, s15, 5120
  buffer_store_dwordx4 v[148:151], v10, s[64:67], s13 offen sc1
  s_mov_b32 s52, s16
  s_and_b32 s53, s17, 0xffff
  s_mov_b32 s54, 2097152
  s_mov_b32 s55, 0x20000
  s_mov_b32 s80, s44
  s_and_b32 s81, s45, 0xffff
  s_mov_b32 s82, 4194304
  s_mov_b32 s83, 0x20000
  s_lshl_b32 s10, s95, 6
  s_lshl_b32 s11, s6, 5
  s_add_u32 s10, s10, s11
  v_and_b32 v13, 31, v0
  v_add_u32 v13, s10, v13
  v_lshrrev_b32 v14, 5, v0
  v_lshlrev_b32 v15, 1, v13
  v_lshl_add_u32 v16, v14, 14, v15
  v_lshlrev_b32 v17, 2, v13
  v_lshl_add_u32 v17, v14, 15, v17
  s_lshl_b32 s10, s4, 7
  s_lshl_b32 s11, s96, 6
  s_add_u32 s10, s10, s11
  s_lshr_b32 s11, s3, 1
  s_lshl_b32 s11, s11, 5
  s_add_u32 s12, s10, s11
  global_load_ushort v18, v15, s[42:43]
  global_load_ushort v19, v15, s[32:33]
  s_lshl_b32 s10, s12, 10
  s_add_u32 s13, s10, 0
  buffer_load_ushort v144, v16, s[52:55], s13 offen
  s_add_u32 s13, s10, 1024
  buffer_load_ushort v145, v16, s[52:55], s13 offen
  s_add_u32 s13, s10, 2048
  buffer_load_ushort v146, v16, s[52:55], s13 offen
  s_add_u32 s13, s10, 3072
  buffer_load_ushort v147, v16, s[52:55], s13 offen
  s_add_u32 s13, s10, 4096
  buffer_load_ushort v148, v16, s[52:55], s13 offen
  s_add_u32 s13, s10, 5120
  buffer_load_ushort v149, v16, s[52:55], s13 offen
  s_add_u32 s13, s10, 6144
  buffer_load_ushort v150, v16, s[52:55], s13 offen
  s_add_u32 s13, s10, 7168
  buffer_load_ushort v151, v16, s[52:55], s13 offen
  s_add_u32 s13, s10, 8192
  buffer_load_ushort v152, v16, s[52:55], s13 offen
  s_add_u32 s13, s10, 9216
  buffer_load_ushort v153, v16, s[52:55], s13 offen
  s_add_u32 s13, s10, 10240
  buffer_load_ushort v154, v16, s[52:55], s13 offen
  s_add_u32 s13, s10, 11264
  buffer_load_ushort v155, v16, s[52:55], s13 offen
  s_add_u32 s13, s10, 12288
  buffer_load_ushort v156, v16, s[52:55], s13 offen
  s_add_u32 s13, s10, 13312
  buffer_load_ushort v157, v16, s[52:55], s13 offen
  s_add_u32 s13, s10, 14336
  buffer_load_ushort v158, v16, s[52:55], s13 offen
  s_add_u32 s13, s10, 15360
  buffer_load_ushort v159, v16, s[52:55], s13 offen
  s_lshl_b32 s10, s96, 6
  s_lshr_b32 s11, s3, 1
  s_lshl_b32 s11, s11, 5
  s_add_u32 s10, s10, s11
  s_lshl_b32 s10, s10, 2
  v_lshlrev_b32 v20, 6, v14
  v_add_u32 v20, s10, v20
  ds_read_b128 v[24:27], v20 offset:34304
  ds_read_b128 v[40:43], v20 offset:35328
  ds_read_b128 v[28:31], v20 offset:34320
  ds_read_b128 v[44:47], v20 offset:35344
  ds_read_b128 v[32:35], v20 offset:34336
  ds_read_b128 v[48:51], v20 offset:35360
  ds_read_b128 v[36:39], v20 offset:34352
  ds_read_b128 v[52:55], v20 offset:35376
  s_waitcnt vmcnt(18)
  s_lshl_b32 s10, s4, 1
  s_add_u32 s10, s10, s6
  s_lshl_b32 s10, s10, 2
  s_lshr_b32 s11, s5, 2
  s_add_u32 s10, s10, s11
  s_lshl_b32 s10, s10, 7
  s_and_b32 s11, s5, 3
  s_lshl_b32 s11, s11, 4
  s_add_u32 s10, s10, s11
  s_add_u32 s10, s10, 655364
  v_mov_b32 v13, 0
  v_mov_b32 v14, s8
  s_mov_b32 exec_lo, 0x1
  s_mov_b32 exec_hi, 0x0
  buffer_store_dword v14, v13, s[64:67], s10 offen sc1
  s_mov_b64 exec, -1
  s_add_u32 m0, s86, 129024
  s_mov_b32 s13, 49152
  buffer_load_dwordx4 v2, s[72:75], s13 offen lds
  s_add_u32 m0, s86, 130048
  s_mov_b32 s13, 57344
  buffer_load_dwordx4 v3, s[72:75], s13 offen lds
  s_waitcnt vmcnt(55)
  v_add_u32 v11, 0, v4
  v_add_u32 v12, 0, v5
  ds_read_b64_tr_b16 a[128:129], v11 offset:0
  ds_read_b64_tr_b16 a[130:131], v11 offset:1024
  ds_read_b64_tr_b16 a[132:133], v12 offset:0
  ds_read_b64_tr_b16 a[134:135], v12 offset:1024
  ds_read_b64_tr_b16 a[136:137], v11 offset:2048
  ds_read_b64_tr_b16 a[138:139], v11 offset:3072
  ds_read_b64_tr_b16 a[140:141], v12 offset:2048
  ds_read_b64_tr_b16 a[142:143], v12 offset:3072
  ds_read_b64_tr_b16 a[144:145], v11 offset:4096
  ds_read_b64_tr_b16 a[146:147], v11 offset:5120
  ds_read_b64_tr_b16 a[148:149], v12 offset:4096
  ds_read_b64_tr_b16 a[150:151], v12 offset:5120
  ds_read_b64_tr_b16 a[152:153], v11 offset:6144
  ds_read_b64_tr_b16 a[154:155], v11 offset:7168
  ds_read_b64_tr_b16 a[156:157], v12 offset:6144
  ds_read_b64_tr_b16 a[158:159], v12 offset:7168
  s_waitcnt vmcnt(47)
  v_add_u32 v11, 40960, v4
  v_add_u32 v12, 40960, v5
  ds_read_b64_tr_b16 a[160:161], v11 offset:0
  ds_read_b64_tr_b16 a[162:163], v11 offset:1024
  ds_read_b64_tr_b16 a[164:165], v12 offset:0
  ds_read_b64_tr_b16 a[166:167], v12 offset:1024
  ds_read_b64_tr_b16 a[168:169], v11 offset:2048
  ds_read_b64_tr_b16 a[170:171], v11 offset:3072
  ds_read_b64_tr_b16 a[172:173], v12 offset:2048
  ds_read_b64_tr_b16 a[174:175], v12 offset:3072
  ds_read_b64_tr_b16 a[176:177], v11 offset:4096
  ds_read_b64_tr_b16 a[178:179], v11 offset:5120
  ds_read_b64_tr_b16 a[180:181], v12 offset:4096
  ds_read_b64_tr_b16 a[182:183], v12 offset:5120
  ds_read_b64_tr_b16 a[184:185], v11 offset:6144
  ds_read_b64_tr_b16 a[186:187], v11 offset:7168
  ds_read_b64_tr_b16 a[188:189], v12 offset:6144
  ds_read_b64_tr_b16 a[190:191], v12 offset:7168
  s_waitcnt vmcnt(39)
  v_add_u32 v11, 81920, v4
  v_add_u32 v12, 81920, v5
  ds_read_b64_tr_b16 a[192:193], v11 offset:0
  ds_read_b64_tr_b16 a[194:195], v11 offset:1024
  ds_read_b64_tr_b16 a[196:197], v12 offset:0
  ds_read_b64_tr_b16 a[198:199], v12 offset:1024
  ds_read_b64_tr_b16 a[200:201], v11 offset:2048
  ds_read_b64_tr_b16 a[202:203], v11 offset:3072
  ds_read_b64_tr_b16 a[204:205], v12 offset:2048
  ds_read_b64_tr_b16 a[206:207], v12 offset:3072
  ds_read_b64_tr_b16 a[208:209], v11 offset:4096
  ds_read_b64_tr_b16 a[210:211], v11 offset:5120
  ds_read_b64_tr_b16 a[212:213], v12 offset:4096
  ds_read_b64_tr_b16 a[214:215], v12 offset:5120
  ds_read_b64_tr_b16 a[216:217], v11 offset:6144
  ds_read_b64_tr_b16 a[218:219], v11 offset:7168
  ds_read_b64_tr_b16 a[220:221], v12 offset:6144
  ds_read_b64_tr_b16 a[222:223], v12 offset:7168
  s_waitcnt vmcnt(0)
  v_add_u32 v11, 122880, v6
  v_xor_b32 v12, 4096, v11
  ds_read_b128 a[224:227], v11
  ds_read_b128 a[228:231], v12
  v_add_u32 v11, 122880, v7
  v_xor_b32 v12, 4096, v11
  ds_read_b128 a[232:235], v11
  ds_read_b128 a[236:239], v12
  v_add_u32 v11, 122880, v8
  v_xor_b32 v12, 4096, v11
  ds_read_b128 a[240:243], v11
  ds_read_b128 a[244:247], v12
  v_add_u32 v11, 122880, v9
  v_xor_b32 v12, 4096, v11
  ds_read_b128 a[248:251], v11
  ds_read_b128 a[252:255], v12
  s_waitcnt lgkmcnt(0)
  s_add_u32 m0, s86, 0
  s_mov_b32 s13, 128
  buffer_load_dwordx4 v2, s[72:75], s13 offen lds
  s_add_u32 m0, s86, 1024
  s_mov_b32 s13, 8320
  buffer_load_dwordx4 v3, s[72:75], s13 offen lds
  s_add_u32 m0, s86, 2048
  s_mov_b32 s13, 16512
  buffer_load_dwordx4 v2, s[72:75], s13 offen lds
  s_add_u32 m0, s86, 3072
  s_mov_b32 s13, 24704
  buffer_load_dwordx4 v3, s[72:75], s13 offen lds
  s_add_u32 m0, s86, 4096
  s_mov_b32 s13, 32896
  buffer_load_dwordx4 v2, s[72:75], s13 offen lds
  s_add_u32 m0, s86, 5120
  s_mov_b32 s13, 41088
  buffer_load_dwordx4 v3, s[72:75], s13 offen lds
  s_add_u32 m0, s86, 6144
  s_mov_b32 s13, 49280
  buffer_load_dwordx4 v2, s[72:75], s13 offen lds
  s_add_u32 m0, s86, 7168
  s_mov_b32 s13, 57472
  buffer_load_dwordx4 v3, s[72:75], s13 offen lds
  s_add_u32 m0, s86, 40960
  s_mov_b32 s13, 0
  buffer_load_dwordx4 v2, s[76:79], s13 offen lds
  s_add_u32 m0, s86, 41984
  s_mov_b32 s13, 8192
  buffer_load_dwordx4 v3, s[76:79], s13 offen lds
  s_add_u32 m0, s86, 43008
  s_mov_b32 s13, 16384
  buffer_load_dwordx4 v2, s[76:79], s13 offen lds
  s_add_u32 m0, s86, 44032
  s_mov_b32 s13, 24576
  buffer_load_dwordx4 v3, s[76:79], s13 offen lds
  s_add_u32 m0, s86, 45056
  s_mov_b32 s13, 32768
  buffer_load_dwordx4 v2, s[76:79], s13 offen lds
  s_add_u32 m0, s86, 46080
  s_mov_b32 s13, 40960
  buffer_load_dwordx4 v3, s[76:79], s13 offen lds
  s_add_u32 m0, s86, 47104
  s_mov_b32 s13, 49152
  buffer_load_dwordx4 v2, s[76:79], s13 offen lds
  s_add_u32 m0, s86, 48128
  s_mov_b32 s13, 57344
  buffer_load_dwordx4 v3, s[76:79], s13 offen lds
  s_add_u32 m0, s86, 81920
  s_mov_b32 s13, 128
  buffer_load_dwordx4 v2, s[76:79], s13 offen lds
  s_add_u32 m0, s86, 82944
  s_mov_b32 s13, 8320
  buffer_load_dwordx4 v3, s[76:79], s13 offen lds
  s_add_u32 m0, s86, 83968
  s_mov_b32 s13, 16512
  buffer_load_dwordx4 v2, s[76:79], s13 offen lds
  s_add_u32 m0, s86, 84992
  s_mov_b32 s13, 24704
  buffer_load_dwordx4 v3, s[76:79], s13 offen lds
  s_add_u32 m0, s86, 86016
  s_mov_b32 s13, 32896
  buffer_load_dwordx4 v2, s[76:79], s13 offen lds
  s_add_u32 m0, s86, 87040
  s_mov_b32 s13, 41088
  buffer_load_dwordx4 v3, s[76:79], s13 offen lds
  s_add_u32 m0, s86, 88064
  s_mov_b32 s13, 49280
  buffer_load_dwordx4 v2, s[76:79], s13 offen lds
  s_add_u32 m0, s86, 89088
  s_mov_b32 s13, 57472
  buffer_load_dwordx4 v3, s[76:79], s13 offen lds
  s_waitcnt vmcnt(27)
  s_waitcnt lgkmcnt(0)
  v_lshlrev_b32 v18, 16, v18
  v_lshlrev_b32 v19, 16, v19
  v_lshlrev_b32 v144, 16, v144
  v_lshlrev_b32 v145, 16, v145
  v_lshlrev_b32 v146, 16, v146
  v_lshlrev_b32 v147, 16, v147
  v_sub_f32 v128, v144, v40
  v_sub_f32 v129, v145, v41
  v_sub_f32 v130, v146, v42
  v_sub_f32 v131, v147, v43
  v_cvt_pk_bf16_f32 v128, v128, v128
  v_cvt_pk_bf16_f32 v129, v129, v129
  v_cvt_pk_bf16_f32 v130, v130, v130
  v_cvt_pk_bf16_f32 v131, v131, v131
  v_lshlrev_b32 v128, 16, v128
  v_lshlrev_b32 v129, 16, v129
  v_lshlrev_b32 v130, 16, v130
  v_lshlrev_b32 v131, 16, v131
  v_mul_f32 v128, v128, v24
  v_mul_f32 v129, v129, v25
  v_mul_f32 v130, v130, v26
  v_mul_f32 v131, v131, v27
  v_cvt_pk_bf16_f32 v128, v128, v128
  v_cvt_pk_bf16_f32 v129, v129, v129
  v_cvt_pk_bf16_f32 v130, v130, v130
  v_cvt_pk_bf16_f32 v131, v131, v131
  v_lshlrev_b32 v128, 16, v128
  v_lshlrev_b32 v129, 16, v129
  v_lshlrev_b32 v130, 16, v130
  v_lshlrev_b32 v131, 16, v131
  v_mul_f32 v128, v128, v19
  v_mul_f32 v129, v129, v19
  v_mul_f32 v130, v130, v19
  v_mul_f32 v131, v131, v19
  v_cvt_pk_bf16_f32 v128, v128, v128
  v_cvt_pk_bf16_f32 v129, v129, v129
  v_cvt_pk_bf16_f32 v130, v130, v130
  v_cvt_pk_bf16_f32 v131, v131, v131
  v_lshlrev_b32 v128, 16, v128
  v_lshlrev_b32 v129, 16, v129
  v_lshlrev_b32 v130, 16, v130
  v_lshlrev_b32 v131, 16, v131
  v_add_f32 v128, v128, v144
  v_add_f32 v129, v129, v145
  v_add_f32 v130, v130, v146
  v_add_f32 v131, v131, v147
  v_add_f32 v128, v128, v18
  v_add_f32 v129, v129, v18
  v_add_f32 v130, v130, v18
  v_add_f32 v131, v131, v18
  v_lshlrev_b32 v148, 16, v148
  v_lshlrev_b32 v149, 16, v149
  v_lshlrev_b32 v150, 16, v150
  v_lshlrev_b32 v151, 16, v151
  v_sub_f32 v132, v148, v44
  v_sub_f32 v133, v149, v45
  v_sub_f32 v134, v150, v46
  v_sub_f32 v135, v151, v47
  v_cvt_pk_bf16_f32 v132, v132, v132
  v_cvt_pk_bf16_f32 v133, v133, v133
  v_cvt_pk_bf16_f32 v134, v134, v134
  v_cvt_pk_bf16_f32 v135, v135, v135
  v_lshlrev_b32 v132, 16, v132
  v_lshlrev_b32 v133, 16, v133
  v_lshlrev_b32 v134, 16, v134
  v_lshlrev_b32 v135, 16, v135
  v_mul_f32 v132, v132, v28
  v_mul_f32 v133, v133, v29
  v_mul_f32 v134, v134, v30
  v_mul_f32 v135, v135, v31
  v_cvt_pk_bf16_f32 v132, v132, v132
  v_cvt_pk_bf16_f32 v133, v133, v133
  v_cvt_pk_bf16_f32 v134, v134, v134
  v_cvt_pk_bf16_f32 v135, v135, v135
  v_lshlrev_b32 v132, 16, v132
  v_lshlrev_b32 v133, 16, v133
  v_lshlrev_b32 v134, 16, v134
  v_lshlrev_b32 v135, 16, v135
  v_mul_f32 v132, v132, v19
  v_mul_f32 v133, v133, v19
  v_mul_f32 v134, v134, v19
  v_mul_f32 v135, v135, v19
  v_cvt_pk_bf16_f32 v132, v132, v132
  v_cvt_pk_bf16_f32 v133, v133, v133
  v_cvt_pk_bf16_f32 v134, v134, v134
  v_cvt_pk_bf16_f32 v135, v135, v135
  v_lshlrev_b32 v132, 16, v132
  v_lshlrev_b32 v133, 16, v133
  v_lshlrev_b32 v134, 16, v134
  v_lshlrev_b32 v135, 16, v135
  v_add_f32 v132, v132, v148
  v_add_f32 v133, v133, v149
  v_add_f32 v134, v134, v150
  v_add_f32 v135, v135, v151
  v_add_f32 v132, v132, v18
  v_add_f32 v133, v133, v18
  v_add_f32 v134, v134, v18
  v_add_f32 v135, v135, v18
  v_lshlrev_b32 v152, 16, v152
  v_lshlrev_b32 v153, 16, v153
  v_lshlrev_b32 v154, 16, v154
  v_lshlrev_b32 v155, 16, v155
  v_sub_f32 v136, v152, v48
  v_sub_f32 v137, v153, v49
  v_sub_f32 v138, v154, v50
  v_sub_f32 v139, v155, v51
  v_cvt_pk_bf16_f32 v136, v136, v136
  v_cvt_pk_bf16_f32 v137, v137, v137
  v_cvt_pk_bf16_f32 v138, v138, v138
  v_cvt_pk_bf16_f32 v139, v139, v139
  v_lshlrev_b32 v136, 16, v136
  v_lshlrev_b32 v137, 16, v137
  v_lshlrev_b32 v138, 16, v138
  v_lshlrev_b32 v139, 16, v139
  v_mul_f32 v136, v136, v32
  v_mul_f32 v137, v137, v33
  v_mul_f32 v138, v138, v34
  v_mul_f32 v139, v139, v35
  v_cvt_pk_bf16_f32 v136, v136, v136
  v_cvt_pk_bf16_f32 v137, v137, v137
  v_cvt_pk_bf16_f32 v138, v138, v138
  v_cvt_pk_bf16_f32 v139, v139, v139
  v_lshlrev_b32 v136, 16, v136
  v_lshlrev_b32 v137, 16, v137
  v_lshlrev_b32 v138, 16, v138
  v_lshlrev_b32 v139, 16, v139
  v_mul_f32 v136, v136, v19
  v_mul_f32 v137, v137, v19
  v_mul_f32 v138, v138, v19
  v_mul_f32 v139, v139, v19
  v_cvt_pk_bf16_f32 v136, v136, v136
  v_cvt_pk_bf16_f32 v137, v137, v137
  v_cvt_pk_bf16_f32 v138, v138, v138
  v_cvt_pk_bf16_f32 v139, v139, v139
  v_lshlrev_b32 v136, 16, v136
  v_lshlrev_b32 v137, 16, v137
  v_lshlrev_b32 v138, 16, v138
  v_lshlrev_b32 v139, 16, v139
  v_add_f32 v136, v136, v152
  v_add_f32 v137, v137, v153
  v_add_f32 v138, v138, v154
  v_add_f32 v139, v139, v155
  v_add_f32 v136, v136, v18
  v_add_f32 v137, v137, v18
  v_add_f32 v138, v138, v18
  v_add_f32 v139, v139, v18
  v_lshlrev_b32 v156, 16, v156
  v_lshlrev_b32 v157, 16, v157
  v_lshlrev_b32 v158, 16, v158
  v_lshlrev_b32 v159, 16, v159
  v_sub_f32 v140, v156, v52
  v_sub_f32 v141, v157, v53
  v_sub_f32 v142, v158, v54
  v_sub_f32 v143, v159, v55
  v_cvt_pk_bf16_f32 v140, v140, v140
  v_cvt_pk_bf16_f32 v141, v141, v141
  v_cvt_pk_bf16_f32 v142, v142, v142
  v_cvt_pk_bf16_f32 v143, v143, v143
  v_lshlrev_b32 v140, 16, v140
  v_lshlrev_b32 v141, 16, v141
  v_lshlrev_b32 v142, 16, v142
  v_lshlrev_b32 v143, 16, v143
  v_mul_f32 v140, v140, v36
  v_mul_f32 v141, v141, v37
  v_mul_f32 v142, v142, v38
  v_mul_f32 v143, v143, v39
  v_cvt_pk_bf16_f32 v140, v140, v140
  v_cvt_pk_bf16_f32 v141, v141, v141
  v_cvt_pk_bf16_f32 v142, v142, v142
  v_cvt_pk_bf16_f32 v143, v143, v143
  v_lshlrev_b32 v140, 16, v140
  v_lshlrev_b32 v141, 16, v141
  v_lshlrev_b32 v142, 16, v142
  v_lshlrev_b32 v143, 16, v143
  v_mul_f32 v140, v140, v19
  v_mul_f32 v141, v141, v19
  v_mul_f32 v142, v142, v19
  v_mul_f32 v143, v143, v19
  v_cvt_pk_bf16_f32 v140, v140, v140
  v_cvt_pk_bf16_f32 v141, v141, v141
  v_cvt_pk_bf16_f32 v142, v142, v142
  v_cvt_pk_bf16_f32 v143, v143, v143
  v_lshlrev_b32 v140, 16, v140
  v_lshlrev_b32 v141, 16, v141
  v_lshlrev_b32 v142, 16, v142
  v_lshlrev_b32 v143, 16, v143
  v_add_f32 v140, v140, v156
  v_add_f32 v141, v141, v157
  v_add_f32 v142, v142, v158
  v_add_f32 v143, v143, v159
  v_add_f32 v140, v140, v18
  v_add_f32 v141, v141, v18
  v_add_f32 v142, v142, v18
  v_add_f32 v143, v143, v18
  v_mov_b32 v1, v17
L_PHASE2:
  s_lshl_b32 s10, s4, 1
  s_add_u32 s10, s10, s96
  s_lshl_b32 s10, s10, 2
  s_add_u32 s10, s10, s3
  s_lshl_b32 s10, s10, 7
  s_add_u32 s10, s10, 655360
  s_mov_b32 s97, s10
  v_and_b32 v13, 15, v0
  v_lshlrev_b32 v13, 2, v13
  s_mov_b32 s9, 0
L2_a_poll:
  buffer_load_dword v14, v13, s[64:67], s97 offen sc1
  s_waitcnt vmcnt(0)
  v_cmp_ne_u32 vcc, s8, v14
  s_and_b32 s10, vcc_lo, 0x6666
  s_cmp_eq_u32 s10, 0
  s_cbranch_scc1 L2_a_go
  s_add_u32 s9, s9, 1
  s_cmp_gt_u32 s9, 20000
  s_cbranch_scc1 L2_a_go
  s_sleep 1
  s_branch L2_a_poll
L2_a_go:
  s_lshl_b32 s10, s4, 2
  s_lshl_b32 s11, s96, 1
  s_add_u32 s10, s10, s11
  s_lshr_b32 s11, s3, 1
  s_add_u32 s14, s10, s11
  s_xor_b32 s15, s14, 1
  s_mul_i32 s11, s3, 45056
  s_add_u32 s11, s11, 1048576
  s_mul_i32 s14, s14, 180224
  s_mul_i32 s15, s15, 180224
  s_add_u32 s14, s14, s11
  s_add_u32 s15, s15, s11
  s_add_u32 s13, s14, 0
  buffer_load_dwordx4 v[80:83], v10, s[64:67], s13 offen offset:0 sc1
  s_add_u32 s13, s15, 0
  buffer_load_dwordx4 v[84:87], v10, s[64:67], s13 offen offset:0 sc1
  s_add_u32 s13, s14, 0
  buffer_load_dwordx4 v[88:91], v10, s[64:67], s13 offen offset:1024 sc1
  s_add_u32 s13, s15, 0
  buffer_load_dwordx4 v[92:95], v10, s[64:67], s13 offen offset:1024 sc1
  s_add_u32 s13, s14, 0
  buffer_load_dwordx4 v[96:99], v10, s[64:67], s13 offen offset:2048 sc1
  s_add_u32 s13, s15, 0
  buffer_load_dwordx4 v[100:103], v10, s[64:67], s13 offen offset:2048 sc1
  s_add_u32 s13, s14, 0
  buffer_load_dwordx4 v[104:107], v10, s[64:67], s13 offen offset:3072 sc1
  s_add_u32 s13, s15, 0
  buffer_load_dwordx4 v[108:111], v10, s[64:67], s13 offen offset:3072 sc1
  s_add_u32 s13, s14, 4096
  buffer_load_dwordx4 v[112:115], v10, s[64:67], s13 offen offset:0 sc1
  s_add_u32 s13, s15, 4096
  buffer_load_dwordx4 v[116:119], v10, s[64:67], s13 offen offset:0 sc1
  s_add_u32 s13, s14, 4096
  buffer_load_dwordx4 v[120:123], v10, s[64:67], s13 offen offset:1024 sc1
  s_add_u32 s13, s15, 4096
  buffer_load_dwordx4 v[124:127], v10, s[64:67], s13 offen offset:1024 sc1
  s_waitcnt vmcnt(10)
  v_mfma_f32_32x32x16_bf16 v[16:31], v[80:83], a[0:3], v[128:143]
  v_mfma_f32_32x32x16_bf16 v[32:47], v[80:83], a[4:7], 0
  v_mfma_f32_32x32x16_bf16 v[48:63], v[84:87], a[0:3], 0
  v_mfma_f32_32x32x16_bf16 v[64:79], v[84:87], a[4:7], 0
  s_add_u32 s13, s14, 4096
  buffer_load_dwordx4 v[80:83], v10, s[64:67], s13 offen offset:2048 sc1
  s_add_u32 s13, s15, 4096
  buffer_load_dwordx4 v[84:87], v10, s[64:67], s13 offen offset:2048 sc1
  s_waitcnt vmcnt(10)
  v_mfma_f32_32x32x16_bf16 v[16:31], v[88:91], a[8:11], v[16:31]
  v_mfma_f32_32x32x16_bf16 v[32:47], v[88:91], a[12:15], v[32:47]
  v_mfma_f32_32x32x16_bf16 v[48:63], v[92:95], a[8:11], v[48:63]
  v_mfma_f32_32x32x16_bf16 v[64:79], v[92:95], a[12:15], v[64:79]
  s_add_u32 s13, s14, 4096
  buffer_load_dwordx4 v[88:91], v10, s[64:67], s13 offen offset:3072 sc1
  s_add_u32 s13, s15, 4096
  buffer_load_dwordx4 v[92:95], v10, s[64:67], s13 offen offset:3072 sc1
  s_waitcnt vmcnt(10)
  v_mfma_f32_32x32x16_bf16 v[16:31], v[96:99], a[16:19], v[16:31]
  v_mfma_f32_32x32x16_bf16 v[32:47], v[96:99], a[20:23], v[32:47]
  v_mfma_f32_32x32x16_bf16 v[48:63], v[100:103], a[16:19], v[48:63]
  v_mfma_f32_32x32x16_bf16 v[64:79], v[100:103], a[20:23], v[64:79]
  s_add_u32 s13, s14, 8192
  buffer_load_dwordx4 v[96:99], v10, s[64:67], s13 offen offset:0 sc1
  s_add_u32 s13, s15, 8192
  buffer_load_dwordx4 v[100:103], v10, s[64:67], s13 offen offset:0 sc1
  s_waitcnt vmcnt(10)
  v_mfma_f32_32x32x16_bf16 v[16:31], v[104:107], a[24:27], v[16:31]
  v_mfma_f32_32x32x16_bf16 v[32:47], v[104:107], a[28:31], v[32:47]
  v_mfma_f32_32x32x16_bf16 v[48:63], v[108:111], a[24:27], v[48:63]
  v_mfma_f32_32x32x16_bf16 v[64:79], v[108:111], a[28:31], v[64:79]
  s_add_u32 s13, s14, 8192
  buffer_load_dwordx4 v[104:107], v10, s[64:67], s13 offen offset:1024 sc1
  s_add_u32 s13, s15, 8192
  buffer_load_dwordx4 v[108:111], v10, s[64:67], s13 offen offset:1024 sc1
  s_waitcnt vmcnt(10)
  v_mfma_f32_32x32x16_bf16 v[16:31], v[112:115], a[32:35], v[16:31]
  v_mfma_f32_32x32x16_bf16 v[32:47], v[112:115], a[36:39], v[32:47]
  v_mfma_f32_32x32x16_bf16 v[48:63], v[116:119], a[32:35], v[48:63]
  v_mfma_f32_32x32x16_bf16 v[64:79], v[116:119], a[36:39], v[64:79]
  s_add_u32 s13, s14, 8192
  buffer_load_dwordx4 v[112:115], v10, s[64:67], s13 offen offset:2048 sc1
  s_add_u32 s13, s15, 8192
  buffer_load_dwordx4 v[116:119], v10, s[64:67], s13 offen offset:2048 sc1
  s_waitcnt vmcnt(10)
  v_mfma_f32_32x32x16_bf16 v[16:31], v[120:123], a[40:43], v[16:31]
  v_mfma_f32_32x32x16_bf16 v[32:47], v[120:123], a[44:47], v[32:47]
  v_mfma_f32_32x32x16_bf16 v[48:63], v[124:127], a[40:43], v[48:63]
  v_mfma_f32_32x32x16_bf16 v[64:79], v[124:127], a[44:47], v[64:79]
  s_add_u32 s13, s14, 8192
  buffer_load_dwordx4 v[120:123], v10, s[64:67], s13 offen offset:3072 sc1
  s_add_u32 s13, s15, 8192
  buffer_load_dwordx4 v[124:127], v10, s[64:67], s13 offen offset:3072 sc1
  s_waitcnt vmcnt(10)
  v_mfma_f32_32x32x16_bf16 v[16:31], v[80:83], a[48:51], v[16:31]
  v_mfma_f32_32x32x16_bf16 v[32:47], v[80:83], a[52:55], v[32:47]
  v_mfma_f32_32x32x16_bf16 v[48:63], v[84:87], a[48:51], v[48:63]
  v_mfma_f32_32x32x16_bf16 v[64:79], v[84:87], a[52:55], v[64:79]
  s_add_u32 s13, s14, 12288
  buffer_load_dwordx4 v[80:83], v10, s[64:67], s13 offen offset:0 sc1
  s_add_u32 s13, s15, 12288
  buffer_load_dwordx4 v[84:87], v10, s[64:67], s13 offen offset:0 sc1
  s_waitcnt vmcnt(10)
  v_mfma_f32_32x32x16_bf16 v[16:31], v[88:91], a[56:59], v[16:31]
  v_mfma_f32_32x32x16_bf16 v[32:47], v[88:91], a[60:63], v[32:47]
  v_mfma_f32_32x32x16_bf16 v[48:63], v[92:95], a[56:59], v[48:63]
  v_mfma_f32_32x32x16_bf16 v[64:79], v[92:95], a[60:63], v[64:79]
  s_add_u32 s13, s14, 12288
  buffer_load_dwordx4 v[88:91], v10, s[64:67], s13 offen offset:1024 sc1
  s_add_u32 s13, s15, 12288
  buffer_load_dwordx4 v[92:95], v10, s[64:67], s13 offen offset:1024 sc1
  s_waitcnt vmcnt(44)
  v_add_u32 v11, 0, v6
  v_xor_b32 v12, 4096, v11
  ds_read_b128 v[160:163], v11
  ds_read_b128 v[164:167], v12
  v_add_u32 v11, 0, v7
  v_xor_b32 v12, 4096, v11
  ds_read_b128 v[168:171], v11
  ds_read_b128 v[172:175], v12
  v_add_u32 v11, 0, v8
  v_xor_b32 v12, 4096, v11
  ds_read_b128 v[176:179], v11
  ds_read_b128 v[180:183], v12
  v_add_u32 v11, 0, v9
  v_xor_b32 v12, 4096, v11
  ds_read_b128 v[184:187], v11
  ds_read_b128 v[188:191], v12
  s_waitcnt vmcnt(10)
  v_mfma_f32_32x32x16_bf16 v[16:31], v[96:99], a[64:67], v[16:31]
  v_mfma_f32_32x32x16_bf16 v[32:47], v[96:99], a[68:71], v[32:47]
  v_mfma_f32_32x32x16_bf16 v[48:63], v[100:103], a[64:67], v[48:63]
  v_mfma_f32_32x32x16_bf16 v[64:79], v[100:103], a[68:71], v[64:79]
  s_add_u32 s13, s14, 12288
  buffer_load_dwordx4 v[96:99], v10, s[64:67], s13 offen offset:2048 sc1
  s_add_u32 s13, s15, 12288
  buffer_load_dwordx4 v[100:103], v10, s[64:67], s13 offen offset:2048 sc1
  s_waitcnt vmcnt(10)
  v_mfma_f32_32x32x16_bf16 v[16:31], v[104:107], a[72:75], v[16:31]
  v_mfma_f32_32x32x16_bf16 v[32:47], v[104:107], a[76:79], v[32:47]
  v_mfma_f32_32x32x16_bf16 v[48:63], v[108:111], a[72:75], v[48:63]
  v_mfma_f32_32x32x16_bf16 v[64:79], v[108:111], a[76:79], v[64:79]
  s_add_u32 s13, s14, 12288
  buffer_load_dwordx4 v[104:107], v10, s[64:67], s13 offen offset:3072 sc1
  s_add_u32 s13, s15, 12288
  buffer_load_dwordx4 v[108:111], v10, s[64:67], s13 offen offset:3072 sc1
  s_waitcnt vmcnt(10)
  v_mfma_f32_32x32x16_bf16 v[16:31], v[112:115], a[80:83], v[16:31]
  v_mfma_f32_32x32x16_bf16 v[32:47], v[112:115], a[84:87], v[32:47]
  v_mfma_f32_32x32x16_bf16 v[48:63], v[116:119], a[80:83], v[48:63]
  v_mfma_f32_32x32x16_bf16 v[64:79], v[116:119], a[84:87], v[64:79]
  s_add_u32 s13, s14, 16384
  buffer_load_dwordx4 v[112:115], v10, s[64:67], s13 offen offset:0 sc1
  s_add_u32 s13, s15, 16384
  buffer_load_dwordx4 v[116:119], v10, s[64:67], s13 offen offset:0 sc1
  s_waitcnt vmcnt(10)
  v_mfma_f32_32x32x16_bf16 v[16:31], v[120:123], a[88:91], v[16:31]
  v_mfma_f32_32x32x16_bf16 v[32:47], v[120:123], a[92:95], v[32:47]
  v_mfma_f32_32x32x16_bf16 v[48:63], v[124:127], a[88:91], v[48:63]
  v_mfma_f32_32x32x16_bf16 v[64:79], v[124:127], a[92:95], v[64:79]
  s_add_u32 s13, s14, 16384
  buffer_load_dwordx4 v[120:123], v10, s[64:67], s13 offen offset:1024 sc1
  s_add_u32 s13, s15, 16384
  buffer_load_dwordx4 v[124:127], v10, s[64:67], s13 offen offset:1024 sc1
  s_waitcnt vmcnt(10)
  v_mfma_f32_32x32x16_bf16 v[16:31], v[80:83], a[96:99], v[16:31]
  v_mfma_f32_32x32x16_bf16 v[32:47], v[80:83], a[100:103], v[32:47]
  v_mfma_f32_32x32x16_bf16 v[48:63], v[84:87], a[96:99], v[48:63]
  v_mfma_f32_32x32x16_bf16 v[64:79], v[84:87], a[100:103], v[64:79]
  s_add_u32 s13, s14, 16384
  buffer_load_dwordx4 v[80:83], v10, s[64:67], s13 offen offset:2048 sc1
  s_add_u32 s13, s15, 16384
  buffer_load_dwordx4 v[84:87], v10, s[64:67], s13 offen offset:2048 sc1
  s_waitcnt vmcnt(10)
  v_mfma_f32_32x32x16_bf16 v[16:31], v[88:91], a[104:107], v[16:31]
  v_mfma_f32_32x32x16_bf16 v[32:47], v[88:91], a[108:111], v[32:47]
  v_mfma_f32_32x32x16_bf16 v[48:63], v[92:95], a[104:107], v[48:63]
  v_mfma_f32_32x32x16_bf16 v[64:79], v[92:95], a[108:111], v[64:79]
  s_add_u32 s13, s14, 16384
  buffer_load_dwordx4 v[88:91], v10, s[64:67], s13 offen offset:3072 sc1
  s_add_u32 s13, s15, 16384
  buffer_load_dwordx4 v[92:95], v10, s[64:67], s13 offen offset:3072 sc1
  s_waitcnt vmcnt(48)
  v_add_u32 v11, 40960, v6
  v_xor_b32 v12, 4096, v11
  ds_read_b128 v[192:195], v11
  ds_read_b128 v[196:199], v12
  v_add_u32 v11, 40960, v7
  v_xor_b32 v12, 4096, v11
  ds_read_b128 v[200:203], v11
  ds_read_b128 v[204:207], v12
  v_add_u32 v11, 40960, v8
  v_xor_b32 v12, 4096, v11
  ds_read_b128 v[208:211], v11
  ds_read_b128 v[212:215], v12
  v_add_u32 v11, 40960, v9
  v_xor_b32 v12, 4096, v11
  ds_read_b128 v[216:219], v11
  ds_read_b128 v[220:223], v12
  s_waitcnt vmcnt(10)
  v_mfma_f32_32x32x16_bf16 v[16:31], v[96:99], a[112:115], v[16:31]
  v_mfma_f32_32x32x16_bf16 v[32:47], v[96:99], a[116:119], v[32:47]
  v_mfma_f32_32x32x16_bf16 v[48:63], v[100:103], a[112:115], v[48:63]
  v_mfma_f32_32x32x16_bf16 v[64:79], v[100:103], a[116:119], v[64:79]
  s_add_u32 s13, s14, 20480
  buffer_load_dwordx4 v[96:99], v10, s[64:67], s13 offen offset:0 sc1
  s_add_u32 s13, s15, 20480
  buffer_load_dwordx4 v[100:103], v10, s[64:67], s13 offen offset:0 sc1
  s_waitcnt vmcnt(10)
  v_mfma_f32_32x32x16_bf16 v[16:31], v[104:107], a[120:123], v[16:31]
  v_mfma_f32_32x32x16_bf16 v[32:47], v[104:107], a[124:127], v[32:47]
  v_mfma_f32_32x32x16_bf16 v[48:63], v[108:111], a[120:123], v[48:63]
  v_mfma_f32_32x32x16_bf16 v[64:79], v[108:111], a[124:127], v[64:79]
  s_add_u32 s13, s14, 20480
  buffer_load_dwordx4 v[104:107], v10, s[64:67], s13 offen offset:1024 sc1
  s_add_u32 s13, s15, 20480
  buffer_load_dwordx4 v[108:111], v10, s[64:67], s13 offen offset:1024 sc1
  s_waitcnt vmcnt(10)
  v_mfma_f32_32x32x16_bf16 v[16:31], v[112:115], a[128:131], v[16:31]
  v_mfma_f32_32x32x16_bf16 v[32:47], v[112:115], a[132:135], v[32:47]
  v_mfma_f32_32x32x16_bf16 v[48:63], v[116:119], a[128:131], v[48:63]
  v_mfma_f32_32x32x16_bf16 v[64:79], v[116:119], a[132:135], v[64:79]
  s_add_u32 s13, s14, 20480
  buffer_load_dwordx4 v[112:115], v10, s[64:67], s13 offen offset:2048 sc1
  s_add_u32 s13, s15, 20480
  buffer_load_dwordx4 v[116:119], v10, s[64:67], s13 offen offset:2048 sc1
  s_waitcnt vmcnt(10)
  v_mfma_f32_32x32x16_bf16 v[16:31], v[120:123], a[136:139], v[16:31]
  v_mfma_f32_32x32x16_bf16 v[32:47], v[120:123], a[140:143], v[32:47]
  v_mfma_f32_32x32x16_bf16 v[48:63], v[124:127], a[136:139], v[48:63]
  v_mfma_f32_32x32x16_bf16 v[64:79], v[124:127], a[140:143], v[64:79]
  s_add_u32 s13, s14, 20480
  buffer_load_dwordx4 v[120:123], v10, s[64:67], s13 offen offset:3072 sc1
  s_add_u32 s13, s15, 20480
  buffer_load_dwordx4 v[124:127], v10, s[64:67], s13 offen offset:3072 sc1
  s_waitcnt vmcnt(10)
  v_mfma_f32_32x32x16_bf16 v[16:31], v[80:83], a[144:147], v[16:31]
  v_mfma_f32_32x32x16_bf16 v[32:47], v[80:83], a[148:151], v[32:47]
  v_mfma_f32_32x32x16_bf16 v[48:63], v[84:87], a[144:147], v[48:63]
  v_mfma_f32_32x32x16_bf16 v[64:79], v[84:87], a[148:151], v[64:79]
  s_add_u32 s13, s14, 24576
  buffer_load_dwordx4 v[80:83], v10, s[64:67], s13 offen offset:0 sc1
  s_add_u32 s13, s15, 24576
  buffer_load_dwordx4 v[84:87], v10, s[64:67], s13 offen offset:0 sc1
  s_waitcnt vmcnt(10)
  v_mfma_f32_32x32x16_bf16 v[16:31], v[88:91], a[152:155], v[16:31]
  v_mfma_f32_32x32x16_bf16 v[32:47], v[88:91], a[156:159], v[32:47]
  v_mfma_f32_32x32x16_bf16 v[48:63], v[92:95], a[152:155], v[48:63]
  v_mfma_f32_32x32x16_bf16 v[64:79], v[92:95], a[156:159], v[64:79]
  s_add_u32 s13, s14, 24576
  buffer_load_dwordx4 v[88:91], v10, s[64:67], s13 offen offset:1024 sc1
  s_add_u32 s13, s15, 24576
  buffer_load_dwordx4 v[92:95], v10, s[64:67], s13 offen offset:1024 sc1
  s_waitcnt vmcnt(52)
  v_add_u32 v11, 81920, v6
  v_xor_b32 v12, 4096, v11
  ds_read_b128 v[224:227], v11
  ds_read_b128 v[228:231], v12
  v_add_u32 v11, 81920, v7
  v_xor_b32 v12, 4096, v11
  ds_read_b128 v[232:235], v11
  ds_read_b128 v[236:239], v12
  v_add_u32 v11, 81920, v8
  v_xor_b32 v12, 4096, v11
  ds_read_b128 v[240:243], v11
  ds_read_b128 v[244:247], v12
  v_add_u32 v11, 81920, v9
  v_xor_b32 v12, 4096, v11
  ds_read_b128 v[248:251], v11
  ds_read_b128 v[252:255], v12
  s_waitcnt vmcnt(10)
  v_mfma_f32_32x32x16_bf16 v[16:31], v[96:99], a[160:163], v[16:31]
  v_mfma_f32_32x32x16_bf16 v[32:47], v[96:99], a[164:167], v[32:47]
  v_mfma_f32_32x32x16_bf16 v[48:63], v[100:103], a[160:163], v[48:63]
  v_mfma_f32_32x32x16_bf16 v[64:79], v[100:103], a[164:167], v[64:79]
  s_add_u32 s13, s14, 24576
  buffer_load_dwordx4 v[96:99], v10, s[64:67], s13 offen offset:2048 sc1
  s_add_u32 s13, s15, 24576
  buffer_load_dwordx4 v[100:103], v10, s[64:67], s13 offen offset:2048 sc1
  s_waitcnt vmcnt(10)
  v_mfma_f32_32x32x16_bf16 v[16:31], v[104:107], a[168:171], v[16:31]
  v_mfma_f32_32x32x16_bf16 v[32:47], v[104:107], a[172:175], v[32:47]
  v_mfma_f32_32x32x16_bf16 v[48:63], v[108:111], a[168:171], v[48:63]
  v_mfma_f32_32x32x16_bf16 v[64:79], v[108:111], a[172:175], v[64:79]
  s_add_u32 s13, s14, 24576
  buffer_load_dwordx4 v[104:107], v10, s[64:67], s13 offen offset:3072 sc1
  s_add_u32 s13, s15, 24576
  buffer_load_dwordx4 v[108:111], v10, s[64:67], s13 offen offset:3072 sc1
  s_waitcnt vmcnt(10)
  v_mfma_f32_32x32x16_bf16 v[16:31], v[112:115], a[176:179], v[16:31]
  v_mfma_f32_32x32x16_bf16 v[32:47], v[112:115], a[180:183], v[32:47]
  v_mfma_f32_32x32x16_bf16 v[48:63], v[116:119], a[176:179], v[48:63]
  v_mfma_f32_32x32x16_bf16 v[64:79], v[116:119], a[180:183], v[64:79]
  v_and_b32 v13, 15, v0
  v_lshlrev_b32 v13, 2, v13
  s_mov_b32 s9, 0
L2_b_poll:
  buffer_load_dword v14, v13, s[64:67], s97 offen sc1
  s_waitcnt vmcnt(0)
  v_cmp_ne_u32 vcc, s8, v14
  s_and_b32 s10, vcc_lo, 0x1111
  s_cmp_eq_u32 s10, 0
  s_cbranch_scc1 L2_b_go
  s_add_u32 s9, s9, 1
  s_cmp_gt_u32 s9, 20000
  s_cbranch_scc1 L2_b_go
  s_sleep 1
  s_branch L2_b_poll
L2_b_go:
  s_add_u32 s13, s14, 28672
  buffer_load_dwordx4 v[112:115], v10, s[64:67], s13 offen offset:0 sc1
  s_add_u32 s13, s15, 28672
  buffer_load_dwordx4 v[116:119], v10, s[64:67], s13 offen offset:0 sc1
  s_waitcnt vmcnt(10)
  v_mfma_f32_32x32x16_bf16 v[16:31], v[120:123], a[184:187], v[16:31]
  v_mfma_f32_32x32x16_bf16 v[32:47], v[120:123], a[188:191], v[32:47]
  v_mfma_f32_32x32x16_bf16 v[48:63], v[124:127], a[184:187], v[48:63]
  v_mfma_f32_32x32x16_bf16 v[64:79], v[124:127], a[188:191], v[64:79]
  s_add_u32 s13, s14, 28672
  buffer_load_dwordx4 v[120:123], v10, s[64:67], s13 offen offset:1024 sc1
  s_add_u32 s13, s15, 28672
  buffer_load_dwordx4 v[124:127], v10, s[64:67], s13 offen offset:1024 sc1
  s_waitcnt vmcnt(10)
  v_mfma_f32_32x32x16_bf16 v[16:31], v[80:83], a[192:195], v[16:31]
  v_mfma_f32_32x32x16_bf16 v[32:47], v[80:83], a[196:199], v[32:47]
  v_mfma_f32_32x32x16_bf16 v[48:63], v[84:87], a[192:195], v[48:63]
  v_mfma_f32_32x32x16_bf16 v[64:79], v[84:87], a[196:199], v[64:79]
  s_add_u32 s13, s14, 28672
  buffer_load_dwordx4 v[80:83], v10, s[64:67], s13 offen offset:2048 sc1
  s_add_u32 s13, s15, 28672
  buffer_load_dwordx4 v[84:87], v10, s[64:67], s13 offen offset:2048 sc1
  s_waitcnt vmcnt(10)
  v_mfma_f32_32x32x16_bf16 v[16:31], v[88:91], a[200:203], v[16:31]
  v_mfma_f32_32x32x16_bf16 v[32:47], v[88:91], a[204:207], v[32:47]
  v_mfma_f32_32x32x16_bf16 v[48:63], v[92:95], a[200:203], v[48:63]
  v_mfma_f32_32x32x16_bf16 v[64:79], v[92:95], a[204:207], v[64:79]
  s_add_u32 s13, s14, 28672
  buffer_load_dwordx4 v[88:91], v10, s[64:67], s13 offen offset:3072 sc1
  s_add_u32 s13, s15, 28672
  buffer_load_dwordx4 v[92:95], v10, s[64:67], s13 offen offset:3072 sc1
  s_waitcnt vmcnt(10)
  v_mfma_f32_32x32x16_bf16 v[16:31], v[96:99], a[208:211], v[16:31]
  v_mfma_f32_32x32x16_bf16 v[32:47], v[96:99], a[212:215], v[32:47]
  v_mfma_f32_32x32x16_bf16 v[48:63], v[100:103], a[208:211], v[48:63]
  v_mfma_f32_32x32x16_bf16 v[64:79], v[100:103], a[212:215], v[64:79]
  s_add_u32 s13, s14, 32768
  buffer_load_dwordx4 v[96:99], v10, s[64:67], s13 offen offset:0 sc1
  s_add_u32 s13, s15, 32768
  buffer_load_dwordx4 v[100:103], v10, s[64:67], s13 offen offset:0 sc1
  s_waitcnt vmcnt(10)
  v_mfma_f32_32x32x16_bf16 v[16:31], v[104:107], a[216:219], v[16:31]
  v_mfma_f32_32x32x16_bf16 v[32:47], v[104:107], a[220:223], v[32:47]
  v_mfma_f32_32x32x16_bf16 v[48:63], v[108:111], a[216:219], v[48:63]
  v_mfma_f32_32x32x16_bf16 v[64:79], v[108:111], a[220:223], v[64:79]
  s_add_u32 s13, s14, 32768
  buffer_load_dwordx4 v[104:107], v10, s[64:67], s13 offen offset:1024 sc1
  s_add_u32 s13, s15, 32768
  buffer_load_dwordx4 v[108:111], v10, s[64:67], s13 offen offset:1024 sc1
  s_waitcnt vmcnt(10)
  v_mfma_f32_32x32x16_bf16 v[16:31], v[112:115], a[224:227], v[16:31]
  v_mfma_f32_32x32x16_bf16 v[32:47], v[112:115], a[228:231], v[32:47]
  v_mfma_f32_32x32x16_bf16 v[48:63], v[116:119], a[224:227], v[48:63]
  v_mfma_f32_32x32x16_bf16 v[64:79], v[116:119], a[228:231], v[64:79]
  s_add_u32 s13, s14, 32768
  buffer_load_dwordx4 v[112:115], v10, s[64:67], s13 offen offset:2048 sc1
  s_add_u32 s13, s15, 32768
  buffer_load_dwordx4 v[116:119], v10, s[64:67], s13 offen offset:2048 sc1
  s_waitcnt vmcnt(10)
  v_mfma_f32_32x32x16_bf16 v[16:31], v[120:123], a[232:235], v[16:31]
  v_mfma_f32_32x32x16_bf16 v[32:47], v[120:123], a[236:239], v[32:47]
  v_mfma_f32_32x32x16_bf16 v[48:63], v[124:127], a[232:235], v[48:63]
  v_mfma_f32_32x32x16_bf16 v[64:79], v[124:127], a[236:239], v[64:79]
  s_add_u32 s13, s14, 32768
  buffer_load_dwordx4 v[120:123], v10, s[64:67], s13 offen offset:3072 sc1
  s_add_u32 s13, s15, 32768
  buffer_load_dwordx4 v[124:127], v10, s[64:67], s13 offen offset:3072 sc1
  s_waitcnt lgkmcnt(0)
  s_waitcnt vmcnt(10)
  v_mfma_f32_32x32x16_bf16 v[16:31], v[80:83], a[240:243], v[16:31]
  v_mfma_f32_32x32x16_bf16 v[32:47], v[80:83], a[244:247], v[32:47]
  v_mfma_f32_32x32x16_bf16 v[48:63], v[84:87], a[240:243], v[48:63]
  v_mfma_f32_32x32x16_bf16 v[64:79], v[84:87], a[244:247], v[64:79]
  s_add_u32 s13, s14, 36864
  buffer_load_dwordx4 v[80:83], v10, s[64:67], s13 offen offset:0 sc1
  s_add_u32 s13, s15, 36864
  buffer_load_dwordx4 v[84:87], v10, s[64:67], s13 offen offset:0 sc1
  s_waitcnt vmcnt(10)
  v_mfma_f32_32x32x16_bf16 v[16:31], v[88:91], a[248:251], v[16:31]
  v_mfma_f32_32x32x16_bf16 v[32:47], v[88:91], a[252:255], v[32:47]
  v_mfma_f32_32x32x16_bf16 v[48:63], v[92:95], a[248:251], v[48:63]
  v_mfma_f32_32x32x16_bf16 v[64:79], v[92:95], a[252:255], v[64:79]
  s_add_u32 s13, s14, 36864
  buffer_load_dwordx4 v[88:91], v10, s[64:67], s13 offen offset:1024 sc1
  s_add_u32 s13, s15, 36864
  buffer_load_dwordx4 v[92:95], v10, s[64:67], s13 offen offset:1024 sc1
  s_waitcnt vmcnt(10)
  v_mfma_f32_32x32x16_bf16 v[16:31], v[96:99], v[160:163], v[16:31]
  v_mfma_f32_32x32x16_bf16 v[32:47], v[96:99], v[164:167], v[32:47]
  v_mfma_f32_32x32x16_bf16 v[48:63], v[100:103], v[160:163], v[48:63]
  v_mfma_f32_32x32x16_bf16 v[64:79], v[100:103], v[164:167], v[64:79]
  s_add_u32 s13, s14, 36864
  buffer_load_dwordx4 v[96:99], v10, s[64:67], s13 offen offset:2048 sc1
  s_add_u32 s13, s15, 36864
  buffer_load_dwordx4 v[100:103], v10, s[64:67], s13 offen offset:2048 sc1
  s_waitcnt vmcnt(10)
  v_mfma_f32_32x32x16_bf16 v[16:31], v[104:107], v[168:171], v[16:31]
  v_mfma_f32_32x32x16_bf16 v[32:47], v[104:107], v[172:175], v[32:47]
  v_mfma_f32_32x32x16_bf16 v[48:63], v[108:111], v[168:171], v[48:63]
  v_mfma_f32_32x32x16_bf16 v[64:79], v[108:111], v[172:175], v[64:79]
  s_add_u32 s13, s14, 36864
  buffer_load_dwordx4 v[104:107], v10, s[64:67], s13 offen offset:3072 sc1
  s_add_u32 s13, s15, 36864
  buffer_load_dwordx4 v[108:111], v10, s[64:67], s13 offen offset:3072 sc1
  s_waitcnt vmcnt(10)
  v_mfma_f32_32x32x16_bf16 v[16:31], v[112:115], v[176:179], v[16:31]
  v_mfma_f32_32x32x16_bf16 v[32:47], v[112:115], v[180:183], v[32:47]
  v_mfma_f32_32x32x16_bf16 v[48:63], v[116:119], v[176:179], v[48:63]
  v_mfma_f32_32x32x16_bf16 v[64:79], v[116:119], v[180:183], v[64:79]
  s_add_u32 s13, s14, 40960
  buffer_load_dwordx4 v[112:115], v10, s[64:67], s13 offen offset:0 sc1
  s_add_u32 s13, s15, 40960
  buffer_load_dwordx4 v[116:119], v10, s[64:67], s13 offen offset:0 sc1
  s_waitcnt vmcnt(10)
  v_mfma_f32_32x32x16_bf16 v[16:31], v[120:123], v[184:187], v[16:31]
  v_mfma_f32_32x32x16_bf16 v[32:47], v[120:123], v[188:191], v[32:47]
  v_mfma_f32_32x32x16_bf16 v[48:63], v[124:127], v[184:187], v[48:63]
  v_mfma_f32_32x32x16_bf16 v[64:79], v[124:127], v[188:191], v[64:79]
  s_add_u32 s13, s14, 40960
  buffer_load_dwordx4 v[120:123], v10, s[64:67], s13 offen offset:1024 sc1
  s_add_u32 s13, s15, 40960
  buffer_load_dwordx4 v[124:127], v10, s[64:67], s13 offen offset:1024 sc1
  s_waitcnt vmcnt(10)
  v_mfma_f32_32x32x16_bf16 v[16:31], v[80:83], v[192:195], v[16:31]
  v_mfma_f32_32x32x16_bf16 v[32:47], v[80:83], v[196:199], v[32:47]
  v_mfma_f32_32x32x16_bf16 v[48:63], v[84:87], v[192:195], v[48:63]
  v_mfma_f32_32x32x16_bf16 v[64:79], v[84:87], v[196:199], v[64:79]
  s_add_u32 s13, s14, 40960
  buffer_load_dwordx4 v[80:83], v10, s[64:67], s13 offen offset:2048 sc1
  s_add_u32 s13, s15, 40960
  buffer_load_dwordx4 v[84:87], v10, s[64:67], s13 offen offset:2048 sc1
  s_waitcnt vmcnt(10)
  v_mfma_f32_32x32x16_bf16 v[16:31], v[88:91], v[200:203], v[16:31]
  v_mfma_f32_32x32x16_bf16 v[32:47], v[88:91], v[204:207], v[32:47]
  v_mfma_f32_32x32x16_bf16 v[48:63], v[92:95], v[200:203], v[48:63]
  v_mfma_f32_32x32x16_bf16 v[64:79], v[92:95], v[204:207], v[64:79]
  s_add_u32 s13, s14, 40960
  buffer_load_dwordx4 v[88:91], v10, s[64:67], s13 offen offset:3072 sc1
  s_add_u32 s13, s15, 40960
  buffer_load_dwordx4 v[92:95], v10, s[64:67], s13 offen offset:3072 sc1
  s_waitcnt vmcnt(10)
  v_mfma_f32_32x32x16_bf16 v[16:31], v[96:99], v[208:211], v[16:31]
  v_mfma_f32_32x32x16_bf16 v[32:47], v[96:99], v[212:215], v[32:47]
  v_mfma_f32_32x32x16_bf16 v[48:63], v[100:103], v[208:211], v[48:63]
  v_mfma_f32_32x32x16_bf16 v[64:79], v[100:103], v[212:215], v[64:79]
  s_waitcnt vmcnt(8)
  v_mfma_f32_32x32x16_bf16 v[16:31], v[104:107], v[216:219], v[16:31]
  v_mfma_f32_32x32x16_bf16 v[32:47], v[104:107], v[220:223], v[32:47]
  v_mfma_f32_32x32x16_bf16 v[48:63], v[108:111], v[216:219], v[48:63]
  v_mfma_f32_32x32x16_bf16 v[64:79], v[108:111], v[220:223], v[64:79]
  s_waitcnt vmcnt(6)
  v_mfma_f32_32x32x16_bf16 v[16:31], v[112:115], v[224:227], v[16:31]
  v_mfma_f32_32x32x16_bf16 v[32:47], v[112:115], v[228:231], v[32:47]
  v_mfma_f32_32x32x16_bf16 v[48:63], v[116:119], v[224:227], v[48:63]
  v_mfma_f32_32x32x16_bf16 v[64:79], v[116:119], v[228:231], v[64:79]
  s_waitcnt vmcnt(4)
  v_mfma_f32_32x32x16_bf16 v[16:31], v[120:123], v[232:235], v[16:31]
  v_mfma_f32_32x32x16_bf16 v[32:47], v[120:123], v[236:239], v[32:47]
  v_mfma_f32_32x32x16_bf16 v[48:63], v[124:127], v[232:235], v[48:63]
  v_mfma_f32_32x32x16_bf16 v[64:79], v[124:127], v[236:239], v[64:79]
  s_waitcnt vmcnt(2)
  v_mfma_f32_32x32x16_bf16 v[16:31], v[80:83], v[240:243], v[16:31]
  v_mfma_f32_32x32x16_bf16 v[32:47], v[80:83], v[244:247], v[32:47]
  v_mfma_f32_32x32x16_bf16 v[48:63], v[84:87], v[240:243], v[48:63]
  v_mfma_f32_32x32x16_bf16 v[64:79], v[84:87], v[244:247], v[64:79]
  s_waitcnt vmcnt(0)
  v_mfma_f32_32x32x16_bf16 v[16:31], v[88:91], v[248:251], v[16:31]
  v_mfma_f32_32x32x16_bf16 v[32:47], v[88:91], v[252:255], v[32:47]
  v_mfma_f32_32x32x16_bf16 v[48:63], v[92:95], v[248:251], v[48:63]
  v_mfma_f32_32x32x16_bf16 v[64:79], v[92:95], v[252:255], v[64:79]
  s_xor_b32 s10, s3, 1
  s_mul_i32 s10, s10, 12288
  s_add_u32 s10, s10, 40960
  v_add_u32 v2, s10, v10
  s_xor_b32 s10, s3, 2
  s_mul_i32 s10, s10, 12288
  s_add_u32 s10, s10, 45056
  v_add_u32 v3, s10, v10
  s_xor_b32 s10, s3, 3
  s_mul_i32 s10, s10, 12288
  s_add_u32 s10, s10, 49152
  v_add_u32 v4, s10, v10
  s_barrier
  s_nop 7
  ds_write_b128 v2, v[32:35] offset:0
  ds_write_b128 v2, v[36:39] offset:1024
  ds_write_b128 v2, v[40:43] offset:2048
  ds_write_b128 v2, v[44:47] offset:3072
  ds_write_b128 v3, v[48:51] offset:0
  ds_write_b128 v3, v[52:55] offset:1024
  ds_write_b128 v3, v[56:59] offset:2048
  ds_write_b128 v3, v[60:63] offset:3072
  ds_write_b128 v4, v[64:67] offset:0
  ds_write_b128 v4, v[68:71] offset:1024
  ds_write_b128 v4, v[72:75] offset:2048
  ds_write_b128 v4, v[76:79] offset:3072
  s_mul_i32 s10, s3, 12288
  s_add_u32 s10, s10, 40960
  v_add_u32 v8, s10, v10
  s_waitcnt lgkmcnt(0)
  s_barrier
  ds_read_b128 v[80:83], v8 offset:0
  ds_read_b128 v[84:87], v8 offset:1024
  ds_read_b128 v[88:91], v8 offset:2048
  ds_read_b128 v[92:95], v8 offset:3072
  ds_read_b128 v[96:99], v8 offset:4096
  ds_read_b128 v[100:103], v8 offset:5120
  ds_read_b128 v[104:107], v8 offset:6144
  ds_read_b128 v[108:111], v8 offset:7168
  ds_read_b128 v[112:115], v8 offset:8192
  ds_read_b128 v[116:119], v8 offset:9216
  ds_read_b128 v[120:123], v8 offset:10240
  ds_read_b128 v[124:127], v8 offset:11264
  s_lshl_b32 s10, s4, 6
  s_lshl_b32 s11, s5, 2
  s_add_u32 s10, s10, s11
  s_add_u32 s10, s10, s3
  s_cmp_lg_u32 s10, 960
  s_cbranch_scc1 L2_noep
  v_mov_b32 v9, 0
  v_mov_b32 v11, s8
  s_mov_b32 exec_lo, 0x1
  s_mov_b32 exec_hi, 0x0
  buffer_store_dword v11, v9, s[64:67], 0 offen sc1
  s_mov_b64 exec, -1
L2_noep:
  s_lshl_b32 s10, s12, 11
  s_waitcnt lgkmcnt(0)
  v_add_f32 v80, v80, v96
  v_add_f32 v16, v16, v112
  v_add_f32 v80, v80, v16
  s_add_u32 s13, s10, 0
  buffer_store_dword v80, v1, s[80:83], s13 offen
  v_add_f32 v81, v81, v97
  v_add_f32 v17, v17, v113
  v_add_f32 v81, v81, v17
  s_add_u32 s13, s10, 2048
  buffer_store_dword v81, v1, s[80:83], s13 offen
  v_add_f32 v82, v82, v98
  v_add_f32 v18, v18, v114
  v_add_f32 v82, v82, v18
  s_add_u32 s13, s10, 4096
  buffer_store_dword v82, v1, s[80:83], s13 offen
  v_add_f32 v83, v83, v99
  v_add_f32 v19, v19, v115
  v_add_f32 v83, v83, v19
  s_add_u32 s13, s10, 6144
  buffer_store_dword v83, v1, s[80:83], s13 offen
  v_add_f32 v84, v84, v100
  v_add_f32 v20, v20, v116
  v_add_f32 v84, v84, v20
  s_add_u32 s13, s10, 8192
  buffer_store_dword v84, v1, s[80:83], s13 offen
  v_add_f32 v85, v85, v101
  v_add_f32 v21, v21, v117
  v_add_f32 v85, v85, v21
  s_add_u32 s13, s10, 10240
  buffer_store_dword v85, v1, s[80:83], s13 offen
  v_add_f32 v86, v86, v102
  v_add_f32 v22, v22, v118
  v_add_f32 v86, v86, v22
  s_add_u32 s13, s10, 12288
  buffer_store_dword v86, v1, s[80:83], s13 offen
  v_add_f32 v87, v87, v103
  v_add_f32 v23, v23, v119
  v_add_f32 v87, v87, v23
  s_add_u32 s13, s10, 14336
  buffer_store_dword v87, v1, s[80:83], s13 offen
  v_add_f32 v88, v88, v104
  v_add_f32 v24, v24, v120
  v_add_f32 v88, v88, v24
  s_add_u32 s13, s10, 16384
  buffer_store_dword v88, v1, s[80:83], s13 offen
  v_add_f32 v89, v89, v105
  v_add_f32 v25, v25, v121
  v_add_f32 v89, v89, v25
  s_add_u32 s13, s10, 18432
  buffer_store_dword v89, v1, s[80:83], s13 offen
  v_add_f32 v90, v90, v106
  v_add_f32 v26, v26, v122
  v_add_f32 v90, v90, v26
  s_add_u32 s13, s10, 20480
  buffer_store_dword v90, v1, s[80:83], s13 offen
  v_add_f32 v91, v91, v107
  v_add_f32 v27, v27, v123
  v_add_f32 v91, v91, v27
  s_add_u32 s13, s10, 22528
  buffer_store_dword v91, v1, s[80:83], s13 offen
  v_add_f32 v92, v92, v108
  v_add_f32 v28, v28, v124
  v_add_f32 v92, v92, v28
  s_add_u32 s13, s10, 24576
  buffer_store_dword v92, v1, s[80:83], s13 offen
  v_add_f32 v93, v93, v109
  v_add_f32 v29, v29, v125
  v_add_f32 v93, v93, v29
  s_add_u32 s13, s10, 26624
  buffer_store_dword v93, v1, s[80:83], s13 offen
  v_add_f32 v94, v94, v110
  v_add_f32 v30, v30, v126
  v_add_f32 v94, v94, v30
  s_add_u32 s13, s10, 28672
  buffer_store_dword v94, v1, s[80:83], s13 offen
  v_add_f32 v95, v95, v111
  v_add_f32 v31, v31, v127
  v_add_f32 v95, v95, v31
  s_add_u32 s13, s10, 30720
  buffer_store_dword v95, v1, s[80:83], s13 offen
  s_endpgm
L_END:
  s_endpgm
L_CODE_END:
.section .rodata,"a"
.p2align 6
.amdhsa_kernel parallel_sum__ssm_conv_s5__dense_activation_gelu__prompt_kernel
  .amdhsa_next_free_vgpr 512
  .amdhsa_next_free_sgpr 102
  .amdhsa_accum_offset 256
  .amdhsa_group_segment_fixed_size 0
  .amdhsa_kernarg_size 136
  .amdhsa_user_sgpr_count 2
  .amdhsa_user_sgpr_kernarg_segment_ptr 1
  .amdhsa_system_sgpr_workgroup_id_x 1
  .amdhsa_float_denorm_mode_32 3
  .amdhsa_float_denorm_mode_16_64 3
.end_amdhsa_kernel
```
